```python
import torch

def _softmax(x, axis=-1):
    return torch.softmax(x, dim=axis)
def _gelu(x):
    return torch.nn.functional.gelu(x, approximate="tanh")
def _silu(x):
    return torch.nn.functional.silu(x)
def _sigmoid(x):
    return torch.sigmoid(x)
def _layernorm(x, axis=-1, eps=1e-5):
    m = x.mean(dim=axis, keepdim=True)
    v = x.var(dim=axis, keepdim=True, unbiased=False)
    return (x - m) / torch.sqrt(v + eps)
def _scatter_add(tgt, idx, src, axis=0):
    return tgt.clone().index_add_(axis, idx, src)
def _segment_sum(src, seg, n):
    out = torch.zeros((n,) + src.shape[1:], dtype=src.dtype)
    return out.index_add_(0, seg, src)
def _pad(x, pw):
    flat = tuple(v for pair in reversed(pw) for v in pair)
    return torch.nn.functional.pad(x, flat)

kernel_name = 'sequential_preLN__linear_attn_block__geglu_ffn__prompt'

def setup_inputs():

    _w = (lambda a: (lambda t: t.to(torch.bfloat16) if t.is_floating_point() else t)(torch.as_tensor(a)))
    def _A_setup():
        B, S, D = 1, 2048, 640
        return {
            "x": _w((lambda *s: torch.randn(*s, dtype=torch.bfloat16) * 0.05)(B, S, D)),
            "wqkv": _w((lambda *s: torch.randn(*s, dtype=torch.bfloat16) * 0.05)(D, 3 * D)),
            "wo": _w((lambda *s: torch.randn(*s, dtype=torch.bfloat16) * 0.05)(D, D)),
        }
    _A_in = _A_setup()

    def _B_setup():
        B, S, D, F = 1, 2048, 640, 1728
        return {
            "x": _w((lambda *s: torch.randn(*s, dtype=torch.bfloat16) * 0.05)(B, S, D)),
            "w_gate": _w((lambda *s: torch.randn(*s, dtype=torch.bfloat16) * 0.05)(D, F)),
            "w_up": _w((lambda *s: torch.randn(*s, dtype=torch.bfloat16) * 0.05)(D, F)),
            "w_down": _w((lambda *s: torch.randn(*s, dtype=torch.bfloat16) * 0.05)(F, D)),
        }
    _B_in = _B_setup()

    return {
        "A_x": _A_in["x"],
        "A_wqkv": _A_in["wqkv"],
        "A_wo": _A_in["wo"],
        "B_x": _B_in["x"],
        "B_w_gate": _B_in["w_gate"],
        "B_w_up": _B_in["w_up"],
        "B_w_down": _B_in["w_down"],
    }

def reference(A_x, A_wqkv, A_wo, B_x, B_w_gate, B_w_up, B_w_down):
    def _A_ref(x, wqkv, wo):
        B, S, D = x.shape
        H = 32; Dh = D // H
        qkv = (lambda x, *d: x.permute(*d))((x @ wqkv).reshape(B, S, 3, H, Dh), 2, 0, 3, 1, 4)
        q, k, v = qkv[0], qkv[1], qkv[2]
        phi = lambda t: torch.where(t > 0, t + 1, torch.exp(t)) + 1e-6
        pq, pk = phi(q), phi(k)
        kv = torch.einsum("bhsd,bhse->bhde", pk, v)
        z = torch.einsum("bhsd->bhd", pk)
        num = torch.einsum("bhqd,bhde->bhqe", pq, kv)
        den = torch.einsum("bhqd,bhd->bhq", pq, z)[..., None] + 1e-6
        o = num / den
        return (lambda x, *d: x.permute(*d))(o, 0, 2, 1, 3).reshape(B, S, D) @ wo

    def _B_ref(x, w_gate, w_up, w_down):
        return (_gelu(x @ w_gate) * (x @ w_up)) @ w_down

    x = A_x
    h = x + _A_ref(_layernorm(x, axis=-1), A_wqkv, A_wo)
    h2 = h + _B_ref(_layernorm(h, axis=-1), B_w_gate, B_w_up, B_w_down)
    return h2
```

```asm
; @launch grid=(256,1,1) block=(256,1,1) lds=163840
.amdgcn_target "amdgcn-amd-amdhsa--gfx950"
.text
.globl sequential_preLN__linear_attn_block__geglu_ffn__prompt_kernel
.p2align 8
.type sequential_preLN__linear_attn_block__geglu_ffn__prompt_kernel,@function
sequential_preLN__linear_attn_block__geglu_ffn__prompt_kernel:
    s_cmp_ge_u32 s2, 256
    s_cbranch_scc1 km_end
    s_load_dwordx16 s[8:23], s[0:1], 0
    s_load_dwordx4 s[24:27], s[0:1], 64
    v_lshrrev_b32 v2, 6, v0
    v_and_b32 v1, 63, v0
    v_readfirstlane_b32 s3, v2
    s_and_b32 s28, s2, 7
    s_lshr_b32 s29, s2, 3
    s_cmp_ge_u32 s29, 26
    s_cbranch_scc1 km_rl
    s_and_b32 s30, s29, 3
    s_lshr_b32 s31, s28, 1
    s_lshl_b32 s31, s31, 2
    s_add_u32 s30, s30, s31
    s_and_b32 s32, s28, 1
    s_lshr_b32 s31, s29, 2
    s_lshl_b32 s33, s32, 2
    s_add_u32 s33, s33, s31
    s_mul_i32 s34, s32, 3
    s_add_u32 s34, s34, s31
    s_add_u32 s34, s34, 4
    s_cmp_lt_u32 s31, 4
    s_cselect_b32 s33, s33, s34
    s_lshl_b32 s34, s32, 1
    s_add_u32 s34, s34, s30
    s_cmp_eq_u32 s31, 6
    s_cselect_b32 s30, s34, s30
    s_cselect_b32 s31, 10, s33
    s_mul_i32 s38, s30, 5
    s_mul_i32 s39, s31, 6
    s_add_u32 s38, s38, s39
    s_lshr_b32 s38, s38, 3
    s_cmp_ge_u32 s38, 10
    s_cselect_b32 s39, 10, 0
    s_sub_u32 s38, s38, s39
    v_and_b32 v2, 15, v1
    v_lshrrev_b32 v3, 4, v1
    v_lshrrev_b32 v8, 3, v1
    v_and_b32 v9, 7, v1
    v_xor_b32 v9, v9, v8
    v_mul_u32_u24 v18, 1280, v8
    v_lshl_add_u32 v18, v9, 4, v18
    s_lshl_b32 s36, s30, 2
    s_add_u32 s6, s36, s3
    s_mul_i32 s34, s6, 40960
    s_mov_b32 s36, s34
    s_lshl_b32 s43, s3, 12
    s_cmp_ge_u32 s31, 8
    s_cbranch_scc1 km_q
    v_add_u32 v8, 0, v1
    v_mul_u32_u24 v9, 6554, v8
    v_lshrrev_b32 v9, 16, v9
    v_mul_u32_u24 v10, 10, v9
    v_sub_u32 v8, v8, v10
    v_and_b32 v10, 19, v9
    v_bfe_u32 v11, v9, 2, 1
    v_lshl_add_u32 v10, v11, 3, v10
    v_bfe_u32 v11, v9, 3, 1
    v_lshl_add_u32 v10, v11, 2, v10
    v_mul_u32_u24 v10, 3840, v10
    v_lshl_add_u32 v20, v8, 4, v10
    v_add_u32 v8, 64, v1
    v_mul_u32_u24 v9, 6554, v8
    v_lshrrev_b32 v9, 16, v9
    v_mul_u32_u24 v10, 10, v9
    v_sub_u32 v8, v8, v10
    v_and_b32 v10, 19, v9
    v_bfe_u32 v11, v9, 2, 1
    v_lshl_add_u32 v10, v11, 3, v10
    v_bfe_u32 v11, v9, 3, 1
    v_lshl_add_u32 v10, v11, 2, v10
    v_mul_u32_u24 v10, 3840, v10
    v_lshl_add_u32 v21, v8, 4, v10
    v_add_u32 v8, 128, v1
    v_mul_u32_u24 v9, 6554, v8
    v_lshrrev_b32 v9, 16, v9
    v_mul_u32_u24 v10, 10, v9
    v_sub_u32 v8, v8, v10
    v_and_b32 v10, 19, v9
    v_bfe_u32 v11, v9, 2, 1
    v_lshl_add_u32 v10, v11, 3, v10
    v_bfe_u32 v11, v9, 3, 1
    v_lshl_add_u32 v10, v11, 2, v10
    v_mul_u32_u24 v10, 3840, v10
    v_lshl_add_u32 v22, v8, 4, v10
    v_add_u32 v8, 192, v1
    v_mul_u32_u24 v9, 6554, v8
    v_lshrrev_b32 v9, 16, v9
    v_mul_u32_u24 v10, 10, v9
    v_sub_u32 v8, v8, v10
    v_and_b32 v10, 19, v9
    v_bfe_u32 v11, v9, 2, 1
    v_lshl_add_u32 v10, v11, 3, v10
    v_bfe_u32 v11, v9, 3, 1
    v_lshl_add_u32 v10, v11, 2, v10
    v_mul_u32_u24 v10, 3840, v10
    v_lshl_add_u32 v23, v8, 4, v10
    v_add_u32 v8, 256, v1
    v_mul_u32_u24 v9, 6554, v8
    v_lshrrev_b32 v9, 16, v9
    v_mul_u32_u24 v10, 10, v9
    v_sub_u32 v8, v8, v10
    v_and_b32 v10, 19, v9
    v_bfe_u32 v11, v9, 2, 1
    v_lshl_add_u32 v10, v11, 3, v10
    v_bfe_u32 v11, v9, 3, 1
    v_lshl_add_u32 v10, v11, 2, v10
    v_mul_u32_u24 v10, 3840, v10
    v_lshl_add_u32 v24, v8, 4, v10
    s_lshr_b32 s32, s3, 1
    s_and_b32 s33, s3, 1
    s_add_u32 s43, s43, 20480
    s_mul_i32 s37, s32, 122880
    s_mul_i32 s41, s33, 1280
    s_add_u32 s37, s37, s41
    s_mul_i32 s41, s31, 160
    s_add_u32 s37, s37, s41
    s_add_u32 s37, s37, 1280
    s_mul_i32 s35, s3, 5120
    s_waitcnt lgkmcnt(0)
    s_mov_b32 s44, s8
    s_mov_b32 s45, s9
    s_mov_b32 s46, 2621440
    s_mov_b32 s47, 0x20000
    s_mov_b32 s48, s10
    s_mov_b32 s49, s11
    s_mov_b32 s50, 2457600
    s_mov_b32 s51, 0x20000
    s_lshl_b32 s39, s38, 7
    s_add_u32 s39, s39, s36
    s_mul_i32 s40, s38, 245760
    s_add_u32 s40, s40, s37
    s_add_u32 s38, s38, 1
    s_cmp_eq_u32 s38, 10
    s_cselect_b32 s38, 0, s38
    s_add_u32 m0, s43, 0
    s_add_u32 s41, s39, 0
    buffer_load_dwordx4 v18, s[44:47], s41 offen lds
    s_add_u32 m0, s43, 1024
    s_add_u32 s41, s39, 10240
    buffer_load_dwordx4 v18, s[44:47], s41 offen lds
    s_add_u32 m0, s43, 2048
    s_add_u32 s41, s39, 20480
    buffer_load_dwordx4 v18, s[44:47], s41 offen lds
    s_add_u32 m0, s43, 3072
    s_add_u32 s41, s39, 30720
    buffer_load_dwordx4 v18, s[44:47], s41 offen lds
    s_add_u32 m0, s35, 0
    s_nop 0
    buffer_load_dwordx4 v20, s[48:51], s40 offen lds
    s_add_u32 m0, s35, 1024
    s_nop 0
    buffer_load_dwordx4 v21, s[48:51], s40 offen lds
    s_add_u32 m0, s35, 2048
    s_nop 0
    buffer_load_dwordx4 v22, s[48:51], s40 offen lds
    s_add_u32 m0, s35, 3072
    s_nop 0
    buffer_load_dwordx4 v23, s[48:51], s40 offen lds
    s_add_u32 m0, s35, 4096
    s_nop 0
    buffer_load_dwordx4 v24, s[48:51], s40 offen lds
    s_lshl_b32 s39, s38, 7
    s_add_u32 s39, s39, s36
    s_mul_i32 s40, s38, 245760
    s_add_u32 s40, s40, s37
    s_add_u32 s38, s38, 1
    s_cmp_eq_u32 s38, 10
    s_cselect_b32 s38, 0, s38
    s_add_u32 m0, s43, 36864
    s_add_u32 s41, s39, 0
    buffer_load_dwordx4 v18, s[44:47], s41 offen lds
    s_add_u32 m0, s43, 37888
    s_add_u32 s41, s39, 10240
    buffer_load_dwordx4 v18, s[44:47], s41 offen lds
    s_add_u32 m0, s43, 38912
    s_add_u32 s41, s39, 20480
    buffer_load_dwordx4 v18, s[44:47], s41 offen lds
    s_add_u32 m0, s43, 39936
    s_add_u32 s41, s39, 30720
    buffer_load_dwordx4 v18, s[44:47], s41 offen lds
    s_add_u32 m0, s35, 36864
    s_nop 0
    buffer_load_dwordx4 v20, s[48:51], s40 offen lds
    s_add_u32 m0, s35, 37888
    s_nop 0
    buffer_load_dwordx4 v21, s[48:51], s40 offen lds
    s_add_u32 m0, s35, 38912
    s_nop 0
    buffer_load_dwordx4 v22, s[48:51], s40 offen lds
    s_add_u32 m0, s35, 39936
    s_nop 0
    buffer_load_dwordx4 v23, s[48:51], s40 offen lds
    s_add_u32 m0, s35, 40960
    s_nop 0
    buffer_load_dwordx4 v24, s[48:51], s40 offen lds
    v_bfe_u32 v4, v1, 2, 2
    v_and_b32 v5, 3, v1
    v_lshrrev_b32 v6, 1, v3
    v_lshlrev_b32 v6, 4, v6
    v_and_b32 v7, 1, v3
    v_lshl_add_u32 v6, v7, 2, v6
    v_add_u32 v6, v6, v4
    v_mov_b32 v60, 0x3f803f80
    v_mov_b32 v61, 0x3f803f80
    v_mov_b32 v62, 0x3f803f80
    v_mov_b32 v63, 0x3f803f80
    v_cmp_eq_u32 s[64:65], 1, v5
    v_cmp_eq_u32 s[66:67], 2, v5
    v_cmp_eq_u32 s[68:69], 3, v5
    v_lshl_add_u32 v17, v4, 4, v2
    v_lshlrev_b32 v17, 2, v17
    v_and_b32 v8, 7, v2
    v_xor_b32 v8, v8, v3
    v_lshlrev_b32 v9, 7, v2
    v_add_u32 v9, s43, v9
    v_lshl_add_u32 v25, v8, 4, v9
    v_xor_b32 v8, 4, v8
    v_lshl_add_u32 v19, v8, 4, v9
    v_mov_b32 v16, 0
    v_lshlrev_b32 v200, 4, v1
    s_mov_b32 s52, s24
    s_mov_b32 s53, s25
    s_mov_b32 s54, 256
    s_mov_b32 s55, 0x20000
    s_add_u32 s60, s26, 6746112
    s_addc_u32 s61, s27, 0
    s_mov_b32 s62, 819200
    s_mov_b32 s63, 0x20000
    s_lshr_b32 s5, s2, 6
    s_lshl_b32 s5, s5, 2
    s_add_u32 s5, s5, s3
    s_mul_i32 s5, s5, 51200
    s_add_u32 s72, s26, 20072448
    s_addc_u32 s73, s27, 0
    s_mov_b32 s74, 98304
    s_mov_b32 s75, 0x20000
    s_mov_b32 s70, 77824
    v_min_u32 v201, 19, v1
    v_lshlrev_b32 v201, 2, v201
    v_mul_u32_u24 v6, 160, v6
    v_lshl_add_u32 v26, v5, 3, v6
    v_mul_u32_u24 v7, 40, v5
    v_add3_u32 v27, v6, v7, 32
    s_mul_i32 s42, s3, 40
    v_add_u32 v28, s42, v26
    s_mul_i32 s4, s33, 5120
    s_mul_i32 s42, s32, 10240
    s_add_u32 s4, s4, s42
    v_add_u32 v29, s4, v27
    v_lshlrev_b32 v8, 2, v2
    s_lshl_b32 s4, s3, 6
    s_add_u32 s4, s4, 147456
    v_add_u32 v9, s4, v8
    s_lshl_b32 s4, s33, 7
    s_lshl_b32 s42, s32, 6
    s_add_u32 s4, s4, s42
    s_add_u32 s4, s4, 147968
    v_add_u32 v11, s4, v8
    v_mul_u32_u24 v10, 80, v3
    v_add_u32 v30, 36864, v26
    v_add_u32 v31, 73728, v26
    v_add_u32 v32, 110592, v26
    v_add_u32 v33, 36864, v27
    v_add_u32 v34, 73728, v27
    v_add_u32 v35, 110592, v27
    v_add_u32 v36, 36864, v28
    v_add_u32 v37, 73728, v28
    v_add_u32 v38, 110592, v28
    v_add_u32 v39, 36864, v29
    v_add_u32 v40, 73728, v29
    v_add_u32 v41, 110592, v29
    v_add_u32 v42, 36864, v25
    v_add_u32 v43, 73728, v25
    v_add_u32 v44, 110592, v25
    v_add_u32 v45, 36864, v19
    v_add_u32 v46, 73728, v19
    v_add_u32 v47, 110592, v19
    s_waitcnt vmcnt(9)
    s_waitcnt lgkmcnt(0)
    s_barrier
    ds_read_b128 a[192:195], v25 offset:0
    ds_read_b128 a[196:199], v25 offset:2048
    ds_read_b128 a[200:203], v19 offset:0
    ds_read_b128 a[204:207], v19 offset:2048
    ds_read_b64_tr_b16 a[224:225], v26 offset:0
    ds_read_b64_tr_b16 a[226:227], v26 offset:1280
    ds_read_b64_tr_b16 a[228:229], v26 offset:40
    ds_read_b64_tr_b16 a[230:231], v26 offset:1320
    ds_read_b64_tr_b16 a[232:233], v26 offset:80
    ds_read_b64_tr_b16 a[234:235], v26 offset:1360
    ds_read_b64_tr_b16 a[236:237], v28 offset:0
    ds_read_b64_tr_b16 a[238:239], v28 offset:1280
    ds_read_b64_tr_b16 a[240:241], v26 offset:120
    ds_read_b64_tr_b16 a[242:243], v26 offset:1400
    ds_read_b64_tr_b16 a[244:245], v26 offset:5120
    ds_read_b64_tr_b16 a[246:247], v26 offset:6400
    ds_read_b64_tr_b16 a[248:249], v26 offset:5160
    ds_read_b64_tr_b16 a[250:251], v26 offset:6440
    s_waitcnt lgkmcnt(12)
    v_mfma_f32_16x16x32_bf16 v[64:67], a[192:195], a[224:227], 0
    ds_read_b64_tr_b16 a[252:253], v28 offset:5120
    s_lshl_b32 s39, s38, 7
    v_mfma_f32_16x16x32_bf16 v[68:71], a[196:199], a[224:227], 0
    ds_read_b64_tr_b16 a[254:255], v28 offset:6400
    s_add_u32 s39, s39, s36
    s_waitcnt lgkmcnt(12)
    v_mfma_f32_16x16x32_bf16 v[72:75], a[192:195], a[228:231], 0
    ds_read_b64_tr_b16 a[224:225], v26 offset:5200
    s_mul_i32 s40, s38, 245760
    v_mfma_f32_16x16x32_bf16 v[76:79], a[196:199], a[228:231], 0
    ds_read_b64_tr_b16 a[226:227], v26 offset:6480
    s_waitcnt lgkmcnt(10)
    v_mfma_f32_16x16x32_bf16 v[80:83], a[192:195], a[232:235], 0
    ds_read_b64_tr_b16 a[228:229], v26 offset:5240
    s_add_u32 s40, s40, s37
    v_mfma_f32_16x16x32_bf16 v[84:87], a[196:199], a[232:235], 0
    ds_read_b64_tr_b16 a[230:231], v26 offset:6520
    s_add_u32 s38, s38, 1
    v_mfma_f32_16x16x32_bf16 v[160:163], v[60:63], a[236:239], 0
    ds_read_b64_tr_b16 a[232:233], v27 offset:0
    s_cmp_eq_u32 s38, 10
    v_mfma_f32_16x16x32_bf16 v[144:147], a[192:195], a[192:195], 0
    ds_read_b64_tr_b16 a[234:235], v27 offset:1280
    s_waitcnt lgkmcnt(10)
    v_mfma_f32_16x16x32_bf16 v[88:91], a[192:195], a[240:243], 0
    ds_read_b64_tr_b16 a[236:237], v29 offset:0
    s_cselect_b32 s38, 0, s38
    v_mfma_f32_16x16x32_bf16 v[92:95], a[196:199], a[240:243], 0
    ds_read_b64_tr_b16 a[238:239], v29 offset:1280
    s_add_u32 m0, s43, 73728
    v_mfma_f32_16x16x32_bf16 v[96:99], a[192:195], a[244:247], 0
    ds_read_b64_tr_b16 a[240:241], v27 offset:5120
    s_add_u32 s41, s39, 0
    v_mfma_f32_16x16x32_bf16 v[100:103], a[196:199], a[244:247], 0
    ds_read_b64_tr_b16 a[242:243], v27 offset:6400
    buffer_load_dwordx4 v18, s[44:47], s41 offen lds
    v_mfma_f32_16x16x32_bf16 v[152:155], v[60:63], a[192:195], 0
    s_waitcnt lgkmcnt(10)
    s_add_u32 m0, s43, 74752
    v_mfma_f32_16x16x32_bf16 v[104:107], a[192:195], a[248:251], 0
    ds_read_b64_tr_b16 a[244:245], v26 offset:10240
    s_add_u32 s41, s39, 10240
    v_mfma_f32_16x16x32_bf16 v[108:111], a[196:199], a[248:251], 0
    ds_read_b64_tr_b16 a[246:247], v26 offset:11520
    v_mfma_f32_16x16x32_bf16 v[164:167], v[60:63], a[252:255], 0
    ds_read_b64_tr_b16 a[248:249], v26 offset:10280
    buffer_load_dwordx4 v18, s[44:47], s41 offen lds
    v_mfma_f32_16x16x32_bf16 v[148:151], a[196:199], a[196:199], 0
    ds_read_b64_tr_b16 a[250:251], v26 offset:11560
    s_waitcnt lgkmcnt(10)
    v_mfma_f32_16x16x32_bf16 v[112:115], a[192:195], a[224:227], 0
    ds_read_b64_tr_b16 a[252:253], v26 offset:10320
    s_add_u32 m0, s43, 75776
    v_mfma_f32_16x16x32_bf16 v[116:119], a[196:199], a[224:227], 0
    ds_read_b64_tr_b16 a[254:255], v26 offset:11600
    s_add_u32 s41, s39, 20480
    v_mfma_f32_16x16x32_bf16 v[120:123], a[192:195], a[228:231], 0
    ds_read_b64_tr_b16 a[224:225], v28 offset:10240
    buffer_load_dwordx4 v18, s[44:47], s41 offen lds
    v_mfma_f32_16x16x32_bf16 v[124:127], a[196:199], a[228:231], 0
    ds_read_b64_tr_b16 a[226:227], v28 offset:11520
    s_waitcnt lgkmcnt(10)
    v_mfma_f32_16x16x32_bf16 v[128:131], a[192:195], a[232:235], 0
    ds_read_b64_tr_b16 a[228:229], v26 offset:10360
    s_add_u32 m0, s43, 76800
    v_mfma_f32_16x16x32_bf16 v[132:135], a[196:199], a[232:235], 0
    ds_read_b64_tr_b16 a[230:231], v26 offset:11640
    s_add_u32 s41, s39, 30720
    v_mfma_f32_16x16x32_bf16 v[168:171], v[60:63], a[236:239], 0
    ds_read_b64_tr_b16 a[232:233], v26 offset:15360
    buffer_load_dwordx4 v18, s[44:47], s41 offen lds
    v_mfma_f32_16x16x32_bf16 v[156:159], v[60:63], a[196:199], 0
    ds_read_b64_tr_b16 a[234:235], v26 offset:16640
    s_waitcnt lgkmcnt(10)
    v_mfma_f32_16x16x32_bf16 v[136:139], a[192:195], a[240:243], 0
    ds_read_b64_tr_b16 a[236:237], v26 offset:15400
    s_add_u32 m0, s35, 73728
    v_mfma_f32_16x16x32_bf16 v[140:143], a[196:199], a[240:243], 0
    ds_read_b64_tr_b16 a[238:239], v26 offset:16680
    v_mfma_f32_16x16x32_bf16 v[64:67], a[200:203], a[244:247], v[64:67]
    ds_read_b64_tr_b16 a[240:241], v28 offset:15360
    buffer_load_dwordx4 v20, s[48:51], s40 offen lds
    v_mfma_f32_16x16x32_bf16 v[68:71], a[204:207], a[244:247], v[68:71]
    ds_read_b64_tr_b16 a[242:243], v28 offset:16640
    s_waitcnt lgkmcnt(10)
    v_mfma_f32_16x16x32_bf16 v[72:75], a[200:203], a[248:251], v[72:75]
    ds_read_b64_tr_b16 a[244:245], v26 offset:15440
    s_add_u32 m0, s35, 74752
    v_mfma_f32_16x16x32_bf16 v[76:79], a[204:207], a[248:251], v[76:79]
    ds_read_b64_tr_b16 a[246:247], v26 offset:16720
    v_mfma_f32_16x16x32_bf16 v[80:83], a[200:203], a[252:255], v[80:83]
    ds_read_b64_tr_b16 a[248:249], v26 offset:15480
    buffer_load_dwordx4 v21, s[48:51], s40 offen lds
    v_mfma_f32_16x16x32_bf16 v[84:87], a[204:207], a[252:255], v[84:87]
    ds_read_b64_tr_b16 a[250:251], v26 offset:16760
    s_waitcnt lgkmcnt(10)
    v_mfma_f32_16x16x32_bf16 v[160:163], v[60:63], a[224:227], v[160:163]
    ds_read_b64_tr_b16 a[252:253], v27 offset:10240
    s_add_u32 m0, s35, 75776
    v_mfma_f32_16x16x32_bf16 v[144:147], a[200:203], a[200:203], v[144:147]
    ds_read_b64_tr_b16 a[254:255], v27 offset:11520
    v_mfma_f32_16x16x32_bf16 v[88:91], a[200:203], a[228:231], v[88:91]
    ds_read_b64_tr_b16 a[224:225], v27 offset:15360
    buffer_load_dwordx4 v22, s[48:51], s40 offen lds
    v_mfma_f32_16x16x32_bf16 v[92:95], a[204:207], a[228:231], v[92:95]
    ds_read_b64_tr_b16 a[226:227], v27 offset:16640
    s_waitcnt lgkmcnt(10)
    s_waitcnt vmcnt(7)
    s_waitcnt lgkmcnt(0)
    s_barrier
    ds_read_b128 a[208:211], v42 offset:0
    ds_read_b128 a[212:215], v42 offset:2048
    ds_read_b128 a[216:219], v45 offset:0
    ds_read_b128 a[220:223], v45 offset:2048
    v_mfma_f32_16x16x32_bf16 v[96:99], a[200:203], a[232:235], v[96:99]
    ds_read_b64_tr_b16 a[228:229], v30 offset:0
    s_add_u32 m0, s35, 76800
    v_mfma_f32_16x16x32_bf16 v[100:103], a[204:207], a[232:235], v[100:103]
    ds_read_b64_tr_b16 a[230:231], v30 offset:1280
    v_mfma_f32_16x16x32_bf16 v[152:155], v[60:63], a[200:203], v[152:155]
    buffer_load_dwordx4 v23, s[48:51], s40 offen lds
    s_add_u32 m0, s35, 77824
    v_mfma_f32_16x16x32_bf16 v[104:107], a[200:203], a[236:239], v[104:107]
    ds_read_b64_tr_b16 a[232:233], v30 offset:40
    v_mfma_f32_16x16x32_bf16 v[108:111], a[204:207], a[236:239], v[108:111]
    ds_read_b64_tr_b16 a[234:235], v30 offset:1320
    s_waitcnt lgkmcnt(10)
    v_mfma_f32_16x16x32_bf16 v[164:167], v[60:63], a[240:243], v[164:167]
    ds_read_b64_tr_b16 a[236:237], v30 offset:80
    v_mfma_f32_16x16x32_bf16 v[148:151], a[204:207], a[204:207], v[148:151]
    ds_read_b64_tr_b16 a[238:239], v30 offset:1360
    buffer_load_dwordx4 v24, s[48:51], s40 offen lds
    v_mfma_f32_16x16x32_bf16 v[112:115], a[200:203], a[244:247], v[112:115]
    ds_read_b64_tr_b16 a[240:241], v36 offset:0
    s_lshl_b32 s39, s38, 7
    v_mfma_f32_16x16x32_bf16 v[116:119], a[204:207], a[244:247], v[116:119]
    ds_read_b64_tr_b16 a[242:243], v36 offset:1280
    s_waitcnt lgkmcnt(10)
    v_mfma_f32_16x16x32_bf16 v[120:123], a[200:203], a[248:251], v[120:123]
    ds_read_b64_tr_b16 a[244:245], v30 offset:120
    s_add_u32 s39, s39, s36
    v_mfma_f32_16x16x32_bf16 v[124:127], a[204:207], a[248:251], v[124:127]
    ds_read_b64_tr_b16 a[246:247], v30 offset:1400
    s_mul_i32 s40, s38, 245760
    v_mfma_f32_16x16x32_bf16 v[156:159], v[60:63], a[204:207], v[156:159]
    s_add_u32 s40, s40, s37
    s_add_u32 s38, s38, 1
    v_mfma_f32_16x16x32_bf16 v[128:131], a[200:203], a[252:255], v[128:131]
    ds_read_b64_tr_b16 a[248:249], v30 offset:5120
    s_cmp_eq_u32 s38, 10
    v_mfma_f32_16x16x32_bf16 v[132:135], a[204:207], a[252:255], v[132:135]
    ds_read_b64_tr_b16 a[250:251], v30 offset:6400
    s_waitcnt lgkmcnt(10)
    v_mfma_f32_16x16x32_bf16 v[136:139], a[200:203], a[224:227], v[136:139]
    ds_read_b64_tr_b16 a[252:253], v30 offset:5160
    s_cselect_b32 s38, 0, s38
    v_mfma_f32_16x16x32_bf16 v[140:143], a[204:207], a[224:227], v[140:143]
    ds_read_b64_tr_b16 a[254:255], v30 offset:6440
    s_add_u32 m0, s43, 110592
    v_mfma_f32_16x16x32_bf16 v[64:67], a[208:211], a[228:231], v[64:67]
    ds_read_b64_tr_b16 a[224:225], v36 offset:5120
    s_add_u32 s41, s39, 0
    v_mfma_f32_16x16x32_bf16 v[68:71], a[212:215], a[228:231], v[68:71]
    ds_read_b64_tr_b16 a[226:227], v36 offset:6400
    s_waitcnt lgkmcnt(10)
    v_mfma_f32_16x16x32_bf16 v[72:75], a[208:211], a[232:235], v[72:75]
    ds_read_b64_tr_b16 a[228:229], v30 offset:5200
    buffer_load_dwordx4 v18, s[44:47], s41 offen lds
    v_mfma_f32_16x16x32_bf16 v[76:79], a[212:215], a[232:235], v[76:79]
    ds_read_b64_tr_b16 a[230:231], v30 offset:6480
    s_add_u32 m0, s43, 111616
    v_mfma_f32_16x16x32_bf16 v[80:83], a[208:211], a[236:239], v[80:83]
    ds_read_b64_tr_b16 a[232:233], v30 offset:5240
    s_add_u32 s41, s39, 10240
    v_mfma_f32_16x16x32_bf16 v[84:87], a[212:215], a[236:239], v[84:87]
    ds_read_b64_tr_b16 a[234:235], v30 offset:6520
    s_waitcnt lgkmcnt(10)
    v_mfma_f32_16x16x32_bf16 v[160:163], v[60:63], a[240:243], v[160:163]
    ds_read_b64_tr_b16 a[236:237], v33 offset:0
    buffer_load_dwordx4 v18, s[44:47], s41 offen lds
    v_mfma_f32_16x16x32_bf16 v[144:147], a[208:211], a[208:211], v[144:147]
    ds_read_b64_tr_b16 a[238:239], v33 offset:1280
    s_add_u32 m0, s43, 112640
    v_mfma_f32_16x16x32_bf16 v[88:91], a[208:211], a[244:247], v[88:91]
    ds_read_b64_tr_b16 a[240:241], v39 offset:0
    s_add_u32 s41, s39, 20480
    v_mfma_f32_16x16x32_bf16 v[92:95], a[212:215], a[244:247], v[92:95]
    ds_read_b64_tr_b16 a[242:243], v39 offset:1280
    s_waitcnt lgkmcnt(10)
    v_mfma_f32_16x16x32_bf16 v[96:99], a[208:211], a[248:251], v[96:99]
    ds_read_b64_tr_b16 a[244:245], v33 offset:5120
    buffer_load_dwordx4 v18, s[44:47], s41 offen lds
    v_mfma_f32_16x16x32_bf16 v[100:103], a[212:215], a[248:251], v[100:103]
    ds_read_b64_tr_b16 a[246:247], v33 offset:6400
    s_add_u32 m0, s43, 113664
    v_mfma_f32_16x16x32_bf16 v[152:155], v[60:63], a[208:211], v[152:155]
    s_add_u32 s41, s39, 30720
    v_mfma_f32_16x16x32_bf16 v[104:107], a[208:211], a[252:255], v[104:107]
    ds_read_b64_tr_b16 a[248:249], v30 offset:10240
    v_mfma_f32_16x16x32_bf16 v[108:111], a[212:215], a[252:255], v[108:111]
    ds_read_b64_tr_b16 a[250:251], v30 offset:11520
    s_waitcnt lgkmcnt(10)
    v_mfma_f32_16x16x32_bf16 v[164:167], v[60:63], a[224:227], v[164:167]
    ds_read_b64_tr_b16 a[252:253], v30 offset:10280
    buffer_load_dwordx4 v18, s[44:47], s41 offen lds
    v_mfma_f32_16x16x32_bf16 v[148:151], a[212:215], a[212:215], v[148:151]
    ds_read_b64_tr_b16 a[254:255], v30 offset:11560
    s_add_u32 m0, s35, 110592
    v_mfma_f32_16x16x32_bf16 v[112:115], a[208:211], a[228:231], v[112:115]
    ds_read_b64_tr_b16 a[224:225], v30 offset:10320
    v_mfma_f32_16x16x32_bf16 v[116:119], a[212:215], a[228:231], v[116:119]
    ds_read_b64_tr_b16 a[226:227], v30 offset:11600
    s_waitcnt lgkmcnt(10)
    v_mfma_f32_16x16x32_bf16 v[120:123], a[208:211], a[232:235], v[120:123]
    ds_read_b64_tr_b16 a[228:229], v36 offset:10240
    buffer_load_dwordx4 v20, s[48:51], s40 offen lds
    v_mfma_f32_16x16x32_bf16 v[124:127], a[212:215], a[232:235], v[124:127]
    ds_read_b64_tr_b16 a[230:231], v36 offset:11520
    s_add_u32 m0, s35, 111616
    v_mfma_f32_16x16x32_bf16 v[128:131], a[208:211], a[236:239], v[128:131]
    ds_read_b64_tr_b16 a[232:233], v30 offset:10360
    v_mfma_f32_16x16x32_bf16 v[132:135], a[212:215], a[236:239], v[132:135]
    ds_read_b64_tr_b16 a[234:235], v30 offset:11640
    s_waitcnt lgkmcnt(10)
    v_mfma_f32_16x16x32_bf16 v[168:171], v[60:63], a[240:243], v[168:171]
    ds_read_b64_tr_b16 a[236:237], v30 offset:15360
    buffer_load_dwordx4 v21, s[48:51], s40 offen lds
    v_mfma_f32_16x16x32_bf16 v[156:159], v[60:63], a[212:215], v[156:159]
    ds_read_b64_tr_b16 a[238:239], v30 offset:16640
    s_add_u32 m0, s35, 112640
    v_mfma_f32_16x16x32_bf16 v[136:139], a[208:211], a[244:247], v[136:139]
    ds_read_b64_tr_b16 a[240:241], v30 offset:15400
    v_mfma_f32_16x16x32_bf16 v[140:143], a[212:215], a[244:247], v[140:143]
    ds_read_b64_tr_b16 a[242:243], v30 offset:16680
    s_waitcnt lgkmcnt(10)
    v_mfma_f32_16x16x32_bf16 v[64:67], a[216:219], a[248:251], v[64:67]
    ds_read_b64_tr_b16 a[244:245], v36 offset:15360
    buffer_load_dwordx4 v22, s[48:51], s40 offen lds
    v_mfma_f32_16x16x32_bf16 v[68:71], a[220:223], a[248:251], v[68:71]
    ds_read_b64_tr_b16 a[246:247], v36 offset:16640
    s_add_u32 m0, s35, 113664
    v_mfma_f32_16x16x32_bf16 v[72:75], a[216:219], a[252:255], v[72:75]
    ds_read_b64_tr_b16 a[248:249], v30 offset:15440
    v_mfma_f32_16x16x32_bf16 v[76:79], a[220:223], a[252:255], v[76:79]
    ds_read_b64_tr_b16 a[250:251], v30 offset:16720
    s_waitcnt lgkmcnt(10)
    v_mfma_f32_16x16x32_bf16 v[80:83], a[216:219], a[224:227], v[80:83]
    ds_read_b64_tr_b16 a[252:253], v30 offset:15480
    buffer_load_dwordx4 v23, s[48:51], s40 offen lds
    v_mfma_f32_16x16x32_bf16 v[84:87], a[220:223], a[224:227], v[84:87]
    ds_read_b64_tr_b16 a[254:255], v30 offset:16760
    s_add_u32 m0, s35, 114688
    v_mfma_f32_16x16x32_bf16 v[160:163], v[60:63], a[228:231], v[160:163]
    ds_read_b64_tr_b16 a[224:225], v33 offset:10240
    v_mfma_f32_16x16x32_bf16 v[144:147], a[216:219], a[216:219], v[144:147]
    ds_read_b64_tr_b16 a[226:227], v33 offset:11520
    s_waitcnt lgkmcnt(10)
    v_mfma_f32_16x16x32_bf16 v[88:91], a[216:219], a[232:235], v[88:91]
    ds_read_b64_tr_b16 a[228:229], v33 offset:15360
    buffer_load_dwordx4 v24, s[48:51], s40 offen lds
    v_mfma_f32_16x16x32_bf16 v[92:95], a[220:223], a[232:235], v[92:95]
    ds_read_b64_tr_b16 a[230:231], v33 offset:16640
    s_lshl_b32 s39, s38, 7
    s_waitcnt vmcnt(9)
    s_waitcnt lgkmcnt(0)
    s_barrier
    ds_read_b128 a[192:195], v43 offset:0
    ds_read_b128 a[196:199], v43 offset:2048
    ds_read_b128 a[200:203], v46 offset:0
    ds_read_b128 a[204:207], v46 offset:2048
    v_mfma_f32_16x16x32_bf16 v[96:99], a[216:219], a[236:239], v[96:99]
    ds_read_b64_tr_b16 a[232:233], v31 offset:0
    s_add_u32 s39, s39, s36
    v_mfma_f32_16x16x32_bf16 v[100:103], a[220:223], a[236:239], v[100:103]
    ds_read_b64_tr_b16 a[234:235], v31 offset:1280
    s_mul_i32 s40, s38, 245760
    v_mfma_f32_16x16x32_bf16 v[152:155], v[60:63], a[216:219], v[152:155]
    s_waitcnt lgkmcnt(10)
    s_add_u32 s40, s40, s37
    v_mfma_f32_16x16x32_bf16 v[104:107], a[216:219], a[240:243], v[104:107]
    ds_read_b64_tr_b16 a[236:237], v31 offset:40
    s_add_u32 s38, s38, 1
    v_mfma_f32_16x16x32_bf16 v[108:111], a[220:223], a[240:243], v[108:111]
    ds_read_b64_tr_b16 a[238:239], v31 offset:1320
    s_cmp_eq_u32 s38, 10
    v_mfma_f32_16x16x32_bf16 v[164:167], v[60:63], a[244:247], v[164:167]
    ds_read_b64_tr_b16 a[240:241], v31 offset:80
    s_cselect_b32 s38, 0, s38
    v_mfma_f32_16x16x32_bf16 v[148:151], a[220:223], a[220:223], v[148:151]
    ds_read_b64_tr_b16 a[242:243], v31 offset:1360
    s_waitcnt lgkmcnt(10)
    v_mfma_f32_16x16x32_bf16 v[112:115], a[216:219], a[248:251], v[112:115]
    ds_read_b64_tr_b16 a[244:245], v37 offset:0
    s_add_u32 m0, s43, 0
    v_mfma_f32_16x16x32_bf16 v[116:119], a[220:223], a[248:251], v[116:119]
    ds_read_b64_tr_b16 a[246:247], v37 offset:1280
    s_add_u32 s41, s39, 0
    v_mfma_f32_16x16x32_bf16 v[120:123], a[216:219], a[252:255], v[120:123]
    ds_read_b64_tr_b16 a[248:249], v31 offset:120
    buffer_load_dwordx4 v18, s[44:47], s41 offen lds
    v_mfma_f32_16x16x32_bf16 v[124:127], a[220:223], a[252:255], v[124:127]
    ds_read_b64_tr_b16 a[250:251], v31 offset:1400
    s_add_u32 m0, s43, 1024
    v_mfma_f32_16x16x32_bf16 v[156:159], v[60:63], a[220:223], v[156:159]
    s_waitcnt lgkmcnt(10)
    s_add_u32 s41, s39, 10240
    v_mfma_f32_16x16x32_bf16 v[128:131], a[216:219], a[224:227], v[128:131]
    ds_read_b64_tr_b16 a[252:253], v31 offset:5120
    v_mfma_f32_16x16x32_bf16 v[132:135], a[220:223], a[224:227], v[132:135]
    ds_read_b64_tr_b16 a[254:255], v31 offset:6400
    buffer_load_dwordx4 v18, s[44:47], s41 offen lds
    v_mfma_f32_16x16x32_bf16 v[136:139], a[216:219], a[228:231], v[136:139]
    ds_read_b64_tr_b16 a[224:225], v31 offset:5160
    s_add_u32 m0, s43, 2048
    v_mfma_f32_16x16x32_bf16 v[140:143], a[220:223], a[228:231], v[140:143]
    ds_read_b64_tr_b16 a[226:227], v31 offset:6440
    s_waitcnt lgkmcnt(10)
    v_mfma_f32_16x16x32_bf16 v[64:67], a[192:195], a[232:235], v[64:67]
    ds_read_b64_tr_b16 a[228:229], v37 offset:5120
    s_add_u32 s41, s39, 20480
    v_mfma_f32_16x16x32_bf16 v[68:71], a[196:199], a[232:235], v[68:71]
    ds_read_b64_tr_b16 a[230:231], v37 offset:6400
    buffer_load_dwordx4 v18, s[44:47], s41 offen lds
    v_mfma_f32_16x16x32_bf16 v[72:75], a[192:195], a[236:239], v[72:75]
    ds_read_b64_tr_b16 a[232:233], v31 offset:5200
    s_add_u32 m0, s43, 3072
    v_mfma_f32_16x16x32_bf16 v[76:79], a[196:199], a[236:239], v[76:79]
    ds_read_b64_tr_b16 a[234:235], v31 offset:6480
    s_waitcnt lgkmcnt(10)
    v_mfma_f32_16x16x32_bf16 v[80:83], a[192:195], a[240:243], v[80:83]
    ds_read_b64_tr_b16 a[236:237], v31 offset:5240
    s_add_u32 s41, s39, 30720
    v_mfma_f32_16x16x32_bf16 v[84:87], a[196:199], a[240:243], v[84:87]
    ds_read_b64_tr_b16 a[238:239], v31 offset:6520
    buffer_load_dwordx4 v18, s[44:47], s41 offen lds
    v_mfma_f32_16x16x32_bf16 v[160:163], v[60:63], a[244:247], v[160:163]
    ds_read_b64_tr_b16 a[240:241], v34 offset:0
    s_add_u32 m0, s35, 0
    v_mfma_f32_16x16x32_bf16 v[144:147], a[192:195], a[192:195], v[144:147]
    ds_read_b64_tr_b16 a[242:243], v34 offset:1280
    s_waitcnt lgkmcnt(10)
    v_mfma_f32_16x16x32_bf16 v[88:91], a[192:195], a[248:251], v[88:91]
    ds_read_b64_tr_b16 a[244:245], v40 offset:0
    v_mfma_f32_16x16x32_bf16 v[92:95], a[196:199], a[248:251], v[92:95]
    ds_read_b64_tr_b16 a[246:247], v40 offset:1280
    buffer_load_dwordx4 v20, s[48:51], s40 offen lds
    v_mfma_f32_16x16x32_bf16 v[96:99], a[192:195], a[252:255], v[96:99]
    ds_read_b64_tr_b16 a[248:249], v34 offset:5120
    s_add_u32 m0, s35, 1024
    v_mfma_f32_16x16x32_bf16 v[100:103], a[196:199], a[252:255], v[100:103]
    ds_read_b64_tr_b16 a[250:251], v34 offset:6400
    v_mfma_f32_16x16x32_bf16 v[152:155], v[60:63], a[192:195], v[152:155]
    s_waitcnt lgkmcnt(10)
    v_mfma_f32_16x16x32_bf16 v[104:107], a[192:195], a[224:227], v[104:107]
    ds_read_b64_tr_b16 a[252:253], v31 offset:10240
    buffer_load_dwordx4 v21, s[48:51], s40 offen lds
    v_mfma_f32_16x16x32_bf16 v[108:111], a[196:199], a[224:227], v[108:111]
    ds_read_b64_tr_b16 a[254:255], v31 offset:11520
    s_add_u32 m0, s35, 2048
    v_mfma_f32_16x16x32_bf16 v[164:167], v[60:63], a[228:231], v[164:167]
    ds_read_b64_tr_b16 a[224:225], v31 offset:10280
    v_mfma_f32_16x16x32_bf16 v[148:151], a[196:199], a[196:199], v[148:151]
    ds_read_b64_tr_b16 a[226:227], v31 offset:11560
    s_waitcnt lgkmcnt(10)
    v_mfma_f32_16x16x32_bf16 v[112:115], a[192:195], a[232:235], v[112:115]
    ds_read_b64_tr_b16 a[228:229], v31 offset:10320
    buffer_load_dwordx4 v22, s[48:51], s40 offen lds
    v_mfma_f32_16x16x32_bf16 v[116:119], a[196:199], a[232:235], v[116:119]
    ds_read_b64_tr_b16 a[230:231], v31 offset:11600
    s_add_u32 m0, s35, 3072
    v_mfma_f32_16x16x32_bf16 v[120:123], a[192:195], a[236:239], v[120:123]
    ds_read_b64_tr_b16 a[232:233], v37 offset:10240
    v_mfma_f32_16x16x32_bf16 v[124:127], a[196:199], a[236:239], v[124:127]
    ds_read_b64_tr_b16 a[234:235], v37 offset:11520
    s_waitcnt lgkmcnt(10)
    v_mfma_f32_16x16x32_bf16 v[128:131], a[192:195], a[240:243], v[128:131]
    ds_read_b64_tr_b16 a[236:237], v31 offset:10360
    buffer_load_dwordx4 v23, s[48:51], s40 offen lds
    v_mfma_f32_16x16x32_bf16 v[132:135], a[196:199], a[240:243], v[132:135]
    ds_read_b64_tr_b16 a[238:239], v31 offset:11640
    s_add_u32 m0, s35, 4096
    v_mfma_f32_16x16x32_bf16 v[168:171], v[60:63], a[244:247], v[168:171]
    ds_read_b64_tr_b16 a[240:241], v31 offset:15360
    v_mfma_f32_16x16x32_bf16 v[156:159], v[60:63], a[196:199], v[156:159]
    ds_read_b64_tr_b16 a[242:243], v31 offset:16640
    s_waitcnt lgkmcnt(10)
    v_mfma_f32_16x16x32_bf16 v[136:139], a[192:195], a[248:251], v[136:139]
    ds_read_b64_tr_b16 a[244:245], v31 offset:15400
    buffer_load_dwordx4 v24, s[48:51], s40 offen lds
    v_mfma_f32_16x16x32_bf16 v[140:143], a[196:199], a[248:251], v[140:143]
    ds_read_b64_tr_b16 a[246:247], v31 offset:16680
    s_lshl_b32 s39, s38, 7
    v_mfma_f32_16x16x32_bf16 v[64:67], a[200:203], a[252:255], v[64:67]
    ds_read_b64_tr_b16 a[248:249], v37 offset:15360
    s_add_u32 s39, s39, s36
    v_mfma_f32_16x16x32_bf16 v[68:71], a[204:207], a[252:255], v[68:71]
    ds_read_b64_tr_b16 a[250:251], v37 offset:16640
    s_waitcnt lgkmcnt(10)
    v_mfma_f32_16x16x32_bf16 v[72:75], a[200:203], a[224:227], v[72:75]
    ds_read_b64_tr_b16 a[252:253], v31 offset:15440
    s_mul_i32 s40, s38, 245760
    v_mfma_f32_16x16x32_bf16 v[76:79], a[204:207], a[224:227], v[76:79]
    ds_read_b64_tr_b16 a[254:255], v31 offset:16720
    s_add_u32 s40, s40, s37
    v_mfma_f32_16x16x32_bf16 v[80:83], a[200:203], a[228:231], v[80:83]
    ds_read_b64_tr_b16 a[224:225], v31 offset:15480
    s_add_u32 s38, s38, 1
    v_mfma_f32_16x16x32_bf16 v[84:87], a[204:207], a[228:231], v[84:87]
    ds_read_b64_tr_b16 a[226:227], v31 offset:16760
    s_waitcnt lgkmcnt(10)
    v_mfma_f32_16x16x32_bf16 v[160:163], v[60:63], a[232:235], v[160:163]
    ds_read_b64_tr_b16 a[228:229], v34 offset:10240
    s_cmp_eq_u32 s38, 10
    v_mfma_f32_16x16x32_bf16 v[144:147], a[200:203], a[200:203], v[144:147]
    ds_read_b64_tr_b16 a[230:231], v34 offset:11520
    s_cselect_b32 s38, 0, s38
    v_mfma_f32_16x16x32_bf16 v[88:91], a[200:203], a[236:239], v[88:91]
    ds_read_b64_tr_b16 a[232:233], v34 offset:15360
    s_add_u32 m0, s43, 36864
    v_mfma_f32_16x16x32_bf16 v[92:95], a[204:207], a[236:239], v[92:95]
    ds_read_b64_tr_b16 a[234:235], v34 offset:16640
    s_waitcnt lgkmcnt(10)
    s_waitcnt vmcnt(9)
    s_waitcnt lgkmcnt(0)
    s_barrier
    buffer_load_dword v59, v16, s[52:55], 0 offen sc1
    ds_read_b128 a[208:211], v44 offset:0
    ds_read_b128 a[212:215], v44 offset:2048
    ds_read_b128 a[216:219], v47 offset:0
    ds_read_b128 a[220:223], v47 offset:2048
    v_mfma_f32_16x16x32_bf16 v[96:99], a[200:203], a[240:243], v[96:99]
    ds_read_b64_tr_b16 a[236:237], v32 offset:0
    s_add_u32 s41, s39, 0
    v_mfma_f32_16x16x32_bf16 v[100:103], a[204:207], a[240:243], v[100:103]
    ds_read_b64_tr_b16 a[238:239], v32 offset:1280
    buffer_load_dwordx4 v18, s[44:47], s41 offen lds
    v_mfma_f32_16x16x32_bf16 v[152:155], v[60:63], a[200:203], v[152:155]
    s_add_u32 m0, s43, 37888
    s_add_u32 s41, s39, 10240
    v_mfma_f32_16x16x32_bf16 v[104:107], a[200:203], a[244:247], v[104:107]
    ds_read_b64_tr_b16 a[240:241], v32 offset:40
    v_mfma_f32_16x16x32_bf16 v[108:111], a[204:207], a[244:247], v[108:111]
    ds_read_b64_tr_b16 a[242:243], v32 offset:1320
    s_waitcnt lgkmcnt(10)
    v_mfma_f32_16x16x32_bf16 v[164:167], v[60:63], a[248:251], v[164:167]
    ds_read_b64_tr_b16 a[244:245], v32 offset:80
    buffer_load_dwordx4 v18, s[44:47], s41 offen lds
    v_mfma_f32_16x16x32_bf16 v[148:151], a[204:207], a[204:207], v[148:151]
    ds_read_b64_tr_b16 a[246:247], v32 offset:1360
    s_add_u32 m0, s43, 38912
    v_mfma_f32_16x16x32_bf16 v[112:115], a[200:203], a[252:255], v[112:115]
    ds_read_b64_tr_b16 a[248:249], v38 offset:0
    s_add_u32 s41, s39, 20480
    v_mfma_f32_16x16x32_bf16 v[116:119], a[204:207], a[252:255], v[116:119]
    ds_read_b64_tr_b16 a[250:251], v38 offset:1280
    s_waitcnt lgkmcnt(10)
    v_mfma_f32_16x16x32_bf16 v[120:123], a[200:203], a[224:227], v[120:123]
    ds_read_b64_tr_b16 a[252:253], v32 offset:120
    buffer_load_dwordx4 v18, s[44:47], s41 offen lds
    v_mfma_f32_16x16x32_bf16 v[124:127], a[204:207], a[224:227], v[124:127]
    ds_read_b64_tr_b16 a[254:255], v32 offset:1400
    s_add_u32 m0, s43, 39936
    v_mfma_f32_16x16x32_bf16 v[156:159], v[60:63], a[204:207], v[156:159]
    s_add_u32 s41, s39, 30720
    v_mfma_f32_16x16x32_bf16 v[128:131], a[200:203], a[228:231], v[128:131]
    ds_read_b64_tr_b16 a[224:225], v32 offset:5120
    v_mfma_f32_16x16x32_bf16 v[132:135], a[204:207], a[228:231], v[132:135]
    ds_read_b64_tr_b16 a[226:227], v32 offset:6400
    s_waitcnt lgkmcnt(10)
    v_mfma_f32_16x16x32_bf16 v[136:139], a[200:203], a[232:235], v[136:139]
    ds_read_b64_tr_b16 a[228:229], v32 offset:5160
    buffer_load_dwordx4 v18, s[44:47], s41 offen lds
    v_mfma_f32_16x16x32_bf16 v[140:143], a[204:207], a[232:235], v[140:143]
    ds_read_b64_tr_b16 a[230:231], v32 offset:6440
    s_add_u32 m0, s35, 36864
    v_mfma_f32_16x16x32_bf16 v[64:67], a[208:211], a[236:239], v[64:67]
    ds_read_b64_tr_b16 a[232:233], v38 offset:5120
    v_mfma_f32_16x16x32_bf16 v[68:71], a[212:215], a[236:239], v[68:71]
    ds_read_b64_tr_b16 a[234:235], v38 offset:6400
    s_waitcnt lgkmcnt(10)
    v_mfma_f32_16x16x32_bf16 v[72:75], a[208:211], a[240:243], v[72:75]
    ds_read_b64_tr_b16 a[236:237], v32 offset:5200
    buffer_load_dwordx4 v20, s[48:51], s40 offen lds
    v_mfma_f32_16x16x32_bf16 v[76:79], a[212:215], a[240:243], v[76:79]
    ds_read_b64_tr_b16 a[238:239], v32 offset:6480
    s_add_u32 m0, s35, 37888
    v_mfma_f32_16x16x32_bf16 v[80:83], a[208:211], a[244:247], v[80:83]
    ds_read_b64_tr_b16 a[240:241], v32 offset:5240
    v_mfma_f32_16x16x32_bf16 v[84:87], a[212:215], a[244:247], v[84:87]
    ds_read_b64_tr_b16 a[242:243], v32 offset:6520
    s_waitcnt lgkmcnt(10)
    v_mfma_f32_16x16x32_bf16 v[160:163], v[60:63], a[248:251], v[160:163]
    ds_read_b64_tr_b16 a[244:245], v35 offset:0
    buffer_load_dwordx4 v21, s[48:51], s40 offen lds
    v_mfma_f32_16x16x32_bf16 v[144:147], a[208:211], a[208:211], v[144:147]
    ds_read_b64_tr_b16 a[246:247], v35 offset:1280
    s_add_u32 m0, s35, 38912
    v_mfma_f32_16x16x32_bf16 v[88:91], a[208:211], a[252:255], v[88:91]
    ds_read_b64_tr_b16 a[248:249], v41 offset:0
    v_mfma_f32_16x16x32_bf16 v[92:95], a[212:215], a[252:255], v[92:95]
    ds_read_b64_tr_b16 a[250:251], v41 offset:1280
    s_waitcnt lgkmcnt(10)
    v_mfma_f32_16x16x32_bf16 v[96:99], a[208:211], a[224:227], v[96:99]
    ds_read_b64_tr_b16 a[252:253], v35 offset:5120
    buffer_load_dwordx4 v22, s[48:51], s40 offen lds
    v_mfma_f32_16x16x32_bf16 v[100:103], a[212:215], a[224:227], v[100:103]
    ds_read_b64_tr_b16 a[254:255], v35 offset:6400
    s_add_u32 m0, s35, 39936
    v_mfma_f32_16x16x32_bf16 v[152:155], v[60:63], a[208:211], v[152:155]
    v_mfma_f32_16x16x32_bf16 v[104:107], a[208:211], a[228:231], v[104:107]
    ds_read_b64_tr_b16 a[224:225], v32 offset:10240
    v_mfma_f32_16x16x32_bf16 v[108:111], a[212:215], a[228:231], v[108:111]
    ds_read_b64_tr_b16 a[226:227], v32 offset:11520
    s_waitcnt lgkmcnt(10)
    v_mfma_f32_16x16x32_bf16 v[164:167], v[60:63], a[232:235], v[164:167]
    ds_read_b64_tr_b16 a[228:229], v32 offset:10280
    buffer_load_dwordx4 v23, s[48:51], s40 offen lds
    v_mfma_f32_16x16x32_bf16 v[148:151], a[212:215], a[212:215], v[148:151]
    ds_read_b64_tr_b16 a[230:231], v32 offset:11560
    s_add_u32 m0, s35, 40960
    v_mfma_f32_16x16x32_bf16 v[112:115], a[208:211], a[236:239], v[112:115]
    ds_read_b64_tr_b16 a[232:233], v32 offset:10320
    v_mfma_f32_16x16x32_bf16 v[116:119], a[212:215], a[236:239], v[116:119]
    ds_read_b64_tr_b16 a[234:235], v32 offset:11600
    s_waitcnt lgkmcnt(10)
    v_mfma_f32_16x16x32_bf16 v[120:123], a[208:211], a[240:243], v[120:123]
    ds_read_b64_tr_b16 a[236:237], v38 offset:10240
    buffer_load_dwordx4 v24, s[48:51], s40 offen lds
    v_mfma_f32_16x16x32_bf16 v[124:127], a[212:215], a[240:243], v[124:127]
    ds_read_b64_tr_b16 a[238:239], v38 offset:11520
    s_lshl_b32 s39, s38, 7
    v_mfma_f32_16x16x32_bf16 v[128:131], a[208:211], a[244:247], v[128:131]
    ds_read_b64_tr_b16 a[240:241], v32 offset:10360
    s_add_u32 s39, s39, s36
    v_mfma_f32_16x16x32_bf16 v[132:135], a[212:215], a[244:247], v[132:135]
    ds_read_b64_tr_b16 a[242:243], v32 offset:11640
    s_waitcnt lgkmcnt(10)
    v_mfma_f32_16x16x32_bf16 v[168:171], v[60:63], a[248:251], v[168:171]
    ds_read_b64_tr_b16 a[244:245], v32 offset:15360
    s_mul_i32 s40, s38, 245760
    v_mfma_f32_16x16x32_bf16 v[156:159], v[60:63], a[212:215], v[156:159]
    ds_read_b64_tr_b16 a[246:247], v32 offset:16640
    s_add_u32 s40, s40, s37
    v_mfma_f32_16x16x32_bf16 v[136:139], a[208:211], a[252:255], v[136:139]
    ds_read_b64_tr_b16 a[248:249], v32 offset:15400
    s_add_u32 s38, s38, 1
    v_mfma_f32_16x16x32_bf16 v[140:143], a[212:215], a[252:255], v[140:143]
    ds_read_b64_tr_b16 a[250:251], v32 offset:16680
    s_waitcnt lgkmcnt(10)
    v_mfma_f32_16x16x32_bf16 v[64:67], a[216:219], a[224:227], v[64:67]
    ds_read_b64_tr_b16 a[252:253], v38 offset:15360
    s_cmp_eq_u32 s38, 10
    v_mfma_f32_16x16x32_bf16 v[68:71], a[220:223], a[224:227], v[68:71]
    ds_read_b64_tr_b16 a[254:255], v38 offset:16640
    s_cselect_b32 s38, 0, s38
    v_mfma_f32_16x16x32_bf16 v[72:75], a[216:219], a[228:231], v[72:75]
    ds_read_b64_tr_b16 a[224:225], v32 offset:15440
    s_add_u32 m0, s43, 73728
    v_mfma_f32_16x16x32_bf16 v[76:79], a[220:223], a[228:231], v[76:79]
    ds_read_b64_tr_b16 a[226:227], v32 offset:16720
    s_waitcnt lgkmcnt(10)
    v_mfma_f32_16x16x32_bf16 v[80:83], a[216:219], a[232:235], v[80:83]
    ds_read_b64_tr_b16 a[228:229], v32 offset:15480
    s_add_u32 s41, s39, 0
    v_mfma_f32_16x16x32_bf16 v[84:87], a[220:223], a[232:235], v[84:87]
    ds_read_b64_tr_b16 a[230:231], v32 offset:16760
    buffer_load_dwordx4 v18, s[44:47], s41 offen lds
    v_mfma_f32_16x16x32_bf16 v[160:163], v[60:63], a[236:239], v[160:163]
    ds_read_b64_tr_b16 a[232:233], v35 offset:10240
    s_add_u32 m0, s43, 74752
    v_mfma_f32_16x16x32_bf16 v[144:147], a[216:219], a[216:219], v[144:147]
    ds_read_b64_tr_b16 a[234:235], v35 offset:11520
    s_waitcnt lgkmcnt(10)
    v_mfma_f32_16x16x32_bf16 v[88:91], a[216:219], a[240:243], v[88:91]
    ds_read_b64_tr_b16 a[236:237], v35 offset:15360
    s_add_u32 s41, s39, 10240
    v_mfma_f32_16x16x32_bf16 v[92:95], a[220:223], a[240:243], v[92:95]
    ds_read_b64_tr_b16 a[238:239], v35 offset:16640
    buffer_load_dwordx4 v18, s[44:47], s41 offen lds
    s_waitcnt vmcnt(12)
    s_waitcnt lgkmcnt(0)
    s_barrier
    ds_read_b128 a[192:195], v25 offset:0
    ds_read_b128 a[196:199], v25 offset:2048
    ds_read_b128 a[200:203], v19 offset:0
    ds_read_b128 a[204:207], v19 offset:2048
    v_mfma_f32_16x16x32_bf16 v[96:99], a[216:219], a[244:247], v[96:99]
    ds_read_b64_tr_b16 a[240:241], v26 offset:0
    s_add_u32 m0, s43, 75776
    v_mfma_f32_16x16x32_bf16 v[100:103], a[220:223], a[244:247], v[100:103]
    ds_read_b64_tr_b16 a[242:243], v26 offset:1280
    s_add_u32 s41, s39, 20480
    v_mfma_f32_16x16x32_bf16 v[152:155], v[60:63], a[216:219], v[152:155]
    s_waitcnt lgkmcnt(10)
    v_mfma_f32_16x16x32_bf16 v[104:107], a[216:219], a[248:251], v[104:107]
    ds_read_b64_tr_b16 a[244:245], v26 offset:40
    buffer_load_dwordx4 v18, s[44:47], s41 offen lds
    v_mfma_f32_16x16x32_bf16 v[108:111], a[220:223], a[248:251], v[108:111]
    ds_read_b64_tr_b16 a[246:247], v26 offset:1320
    s_add_u32 m0, s43, 76800
    v_mfma_f32_16x16x32_bf16 v[164:167], v[60:63], a[252:255], v[164:167]
    ds_read_b64_tr_b16 a[248:249], v26 offset:80
    s_add_u32 s41, s39, 30720
    v_mfma_f32_16x16x32_bf16 v[148:151], a[220:223], a[220:223], v[148:151]
    ds_read_b64_tr_b16 a[250:251], v26 offset:1360
    s_waitcnt lgkmcnt(10)
    v_mfma_f32_16x16x32_bf16 v[112:115], a[216:219], a[224:227], v[112:115]
    ds_read_b64_tr_b16 a[252:253], v28 offset:0
    buffer_load_dwordx4 v18, s[44:47], s41 offen lds
    v_mfma_f32_16x16x32_bf16 v[116:119], a[220:223], a[224:227], v[116:119]
    ds_read_b64_tr_b16 a[254:255], v28 offset:1280
    s_add_u32 m0, s35, 73728
    v_mfma_f32_16x16x32_bf16 v[120:123], a[216:219], a[228:231], v[120:123]
    ds_read_b64_tr_b16 a[224:225], v26 offset:120
    v_mfma_f32_16x16x32_bf16 v[124:127], a[220:223], a[228:231], v[124:127]
    ds_read_b64_tr_b16 a[226:227], v26 offset:1400
    v_mfma_f32_16x16x32_bf16 v[156:159], v[60:63], a[220:223], v[156:159]
    s_waitcnt lgkmcnt(10)
    buffer_load_dwordx4 v20, s[48:51], s40 offen lds
    v_mfma_f32_16x16x32_bf16 v[128:131], a[216:219], a[232:235], v[128:131]
    ds_read_b64_tr_b16 a[228:229], v26 offset:5120
    s_add_u32 m0, s35, 74752
    v_mfma_f32_16x16x32_bf16 v[132:135], a[220:223], a[232:235], v[132:135]
    ds_read_b64_tr_b16 a[230:231], v26 offset:6400
    v_mfma_f32_16x16x32_bf16 v[136:139], a[216:219], a[236:239], v[136:139]
    ds_read_b64_tr_b16 a[232:233], v26 offset:5160
    v_mfma_f32_16x16x32_bf16 v[140:143], a[220:223], a[236:239], v[140:143]
    ds_read_b64_tr_b16 a[234:235], v26 offset:6440
    s_waitcnt lgkmcnt(10)
    v_mfma_f32_16x16x32_bf16 v[64:67], a[192:195], a[240:243], v[64:67]
    ds_read_b64_tr_b16 a[236:237], v28 offset:5120
    buffer_load_dwordx4 v21, s[48:51], s40 offen lds
    v_mfma_f32_16x16x32_bf16 v[68:71], a[196:199], a[240:243], v[68:71]
    ds_read_b64_tr_b16 a[238:239], v28 offset:6400
    s_add_u32 m0, s35, 75776
    v_mfma_f32_16x16x32_bf16 v[72:75], a[192:195], a[244:247], v[72:75]
    ds_read_b64_tr_b16 a[240:241], v26 offset:5200
    v_mfma_f32_16x16x32_bf16 v[76:79], a[196:199], a[244:247], v[76:79]
    ds_read_b64_tr_b16 a[242:243], v26 offset:6480
    s_waitcnt lgkmcnt(10)
    v_mfma_f32_16x16x32_bf16 v[80:83], a[192:195], a[248:251], v[80:83]
    ds_read_b64_tr_b16 a[244:245], v26 offset:5240
    buffer_load_dwordx4 v22, s[48:51], s40 offen lds
    v_mfma_f32_16x16x32_bf16 v[84:87], a[196:199], a[248:251], v[84:87]
    ds_read_b64_tr_b16 a[246:247], v26 offset:6520
    s_add_u32 m0, s35, 76800
    v_mfma_f32_16x16x32_bf16 v[160:163], v[60:63], a[252:255], v[160:163]
    ds_read_b64_tr_b16 a[248:249], v27 offset:0
    v_mfma_f32_16x16x32_bf16 v[144:147], a[192:195], a[192:195], v[144:147]
    ds_read_b64_tr_b16 a[250:251], v27 offset:1280
    s_waitcnt lgkmcnt(10)
    v_mfma_f32_16x16x32_bf16 v[88:91], a[192:195], a[224:227], v[88:91]
    ds_read_b64_tr_b16 a[252:253], v29 offset:0
    buffer_load_dwordx4 v23, s[48:51], s40 offen lds
    v_mfma_f32_16x16x32_bf16 v[92:95], a[196:199], a[224:227], v[92:95]
    ds_read_b64_tr_b16 a[254:255], v29 offset:1280
    s_add_u32 m0, s35, 77824
    v_mfma_f32_16x16x32_bf16 v[96:99], a[192:195], a[228:231], v[96:99]
    ds_read_b64_tr_b16 a[224:225], v27 offset:5120
    v_mfma_f32_16x16x32_bf16 v[100:103], a[196:199], a[228:231], v[100:103]
    ds_read_b64_tr_b16 a[226:227], v27 offset:6400
    v_mfma_f32_16x16x32_bf16 v[152:155], v[60:63], a[192:195], v[152:155]
    s_waitcnt lgkmcnt(10)
    buffer_load_dwordx4 v24, s[48:51], s40 offen lds
    v_mfma_f32_16x16x32_bf16 v[104:107], a[192:195], a[232:235], v[104:107]
    ds_read_b64_tr_b16 a[228:229], v26 offset:10240
    s_lshl_b32 s39, s38, 7
    v_mfma_f32_16x16x32_bf16 v[108:111], a[196:199], a[232:235], v[108:111]
    ds_read_b64_tr_b16 a[230:231], v26 offset:11520
    s_add_u32 s39, s39, s36
    v_mfma_f32_16x16x32_bf16 v[164:167], v[60:63], a[236:239], v[164:167]
    ds_read_b64_tr_b16 a[232:233], v26 offset:10280
    s_mul_i32 s40, s38, 245760
    v_mfma_f32_16x16x32_bf16 v[148:151], a[196:199], a[196:199], v[148:151]
    ds_read_b64_tr_b16 a[234:235], v26 offset:11560
    s_waitcnt lgkmcnt(10)
    v_mfma_f32_16x16x32_bf16 v[112:115], a[192:195], a[240:243], v[112:115]
    ds_read_b64_tr_b16 a[236:237], v26 offset:10320
    s_add_u32 s40, s40, s37
    v_mfma_f32_16x16x32_bf16 v[116:119], a[196:199], a[240:243], v[116:119]
    ds_read_b64_tr_b16 a[238:239], v26 offset:11600
    s_add_u32 s38, s38, 1
    v_mfma_f32_16x16x32_bf16 v[120:123], a[192:195], a[244:247], v[120:123]
    ds_read_b64_tr_b16 a[240:241], v28 offset:10240
    s_cmp_eq_u32 s38, 10
    v_mfma_f32_16x16x32_bf16 v[124:127], a[196:199], a[244:247], v[124:127]
    ds_read_b64_tr_b16 a[242:243], v28 offset:11520
    s_waitcnt lgkmcnt(10)
    v_mfma_f32_16x16x32_bf16 v[128:131], a[192:195], a[248:251], v[128:131]
    ds_read_b64_tr_b16 a[244:245], v26 offset:10360
    s_cselect_b32 s38, 0, s38
    v_mfma_f32_16x16x32_bf16 v[132:135], a[196:199], a[248:251], v[132:135]
    ds_read_b64_tr_b16 a[246:247], v26 offset:11640
    s_add_u32 m0, s43, 110592
    v_mfma_f32_16x16x32_bf16 v[168:171], v[60:63], a[252:255], v[168:171]
    ds_read_b64_tr_b16 a[248:249], v26 offset:15360
    s_add_u32 s41, s39, 0
    v_mfma_f32_16x16x32_bf16 v[156:159], v[60:63], a[196:199], v[156:159]
    ds_read_b64_tr_b16 a[250:251], v26 offset:16640
    s_waitcnt lgkmcnt(10)
    v_mfma_f32_16x16x32_bf16 v[136:139], a[192:195], a[224:227], v[136:139]
    ds_read_b64_tr_b16 a[252:253], v26 offset:15400
    buffer_load_dwordx4 v18, s[44:47], s41 offen lds
    v_mfma_f32_16x16x32_bf16 v[140:143], a[196:199], a[224:227], v[140:143]
    ds_read_b64_tr_b16 a[254:255], v26 offset:16680
    s_add_u32 m0, s43, 111616
    v_mfma_f32_16x16x32_bf16 v[64:67], a[200:203], a[228:231], v[64:67]
    ds_read_b64_tr_b16 a[224:225], v28 offset:15360
    s_add_u32 s41, s39, 10240
    v_mfma_f32_16x16x32_bf16 v[68:71], a[204:207], a[228:231], v[68:71]
    ds_read_b64_tr_b16 a[226:227], v28 offset:16640
    s_waitcnt lgkmcnt(10)
    v_mfma_f32_16x16x32_bf16 v[72:75], a[200:203], a[232:235], v[72:75]
    ds_read_b64_tr_b16 a[228:229], v26 offset:15440
    buffer_load_dwordx4 v18, s[44:47], s41 offen lds
    v_mfma_f32_16x16x32_bf16 v[76:79], a[204:207], a[232:235], v[76:79]
    ds_read_b64_tr_b16 a[230:231], v26 offset:16720
    s_add_u32 m0, s43, 112640
    v_mfma_f32_16x16x32_bf16 v[80:83], a[200:203], a[236:239], v[80:83]
    ds_read_b64_tr_b16 a[232:233], v26 offset:15480
    s_add_u32 s41, s39, 20480
    v_mfma_f32_16x16x32_bf16 v[84:87], a[204:207], a[236:239], v[84:87]
    ds_read_b64_tr_b16 a[234:235], v26 offset:16760
    s_waitcnt lgkmcnt(10)
    v_mfma_f32_16x16x32_bf16 v[160:163], v[60:63], a[240:243], v[160:163]
    ds_read_b64_tr_b16 a[236:237], v27 offset:10240
    buffer_load_dwordx4 v18, s[44:47], s41 offen lds
    v_mfma_f32_16x16x32_bf16 v[144:147], a[200:203], a[200:203], v[144:147]
    ds_read_b64_tr_b16 a[238:239], v27 offset:11520
    s_add_u32 m0, s43, 113664
    v_mfma_f32_16x16x32_bf16 v[88:91], a[200:203], a[244:247], v[88:91]
    ds_read_b64_tr_b16 a[240:241], v27 offset:15360
    s_add_u32 s41, s39, 30720
    v_mfma_f32_16x16x32_bf16 v[92:95], a[204:207], a[244:247], v[92:95]
    ds_read_b64_tr_b16 a[242:243], v27 offset:16640
    s_waitcnt lgkmcnt(10)
    s_waitcnt vmcnt(12)
    s_waitcnt lgkmcnt(0)
    s_barrier
    v_cmp_gt_u32 vcc, 1, v59
    s_mov_b32 s7, 0
    s_nop 3
    s_cbranch_vccz km_zk_ok
km_zk:
    s_sleep 8
    buffer_load_dword v59, v16, s[52:55], 0 offen sc1
    s_add_u32 s7, s7, 1
    s_waitcnt vmcnt(0)
    v_cmp_gt_u32 vcc, 1, v59
    s_cmp_lt_u32 s7, 0x40000
    s_nop 3
    s_cbranch_vccz km_zk_ok
    s_cbranch_scc1 km_zk
km_zk_ok:
    ds_read_b128 a[208:211], v42 offset:0
    ds_read_b128 a[212:215], v42 offset:2048
    ds_read_b128 a[216:219], v45 offset:0
    ds_read_b128 a[220:223], v45 offset:2048
    v_mfma_f32_16x16x32_bf16 v[96:99], a[200:203], a[248:251], v[96:99]
    ds_read_b64_tr_b16 a[244:245], v30 offset:0
    buffer_load_dwordx4 v18, s[44:47], s41 offen lds
    v_mfma_f32_16x16x32_bf16 v[100:103], a[204:207], a[248:251], v[100:103]
    ds_read_b64_tr_b16 a[246:247], v30 offset:1280
    s_add_u32 m0, s35, 110592
    v_mfma_f32_16x16x32_bf16 v[152:155], v[60:63], a[200:203], v[152:155]
    v_mfma_f32_16x16x32_bf16 v[104:107], a[200:203], a[252:255], v[104:107]
    ds_read_b64_tr_b16 a[248:249], v30 offset:40
    v_mfma_f32_16x16x32_bf16 v[108:111], a[204:207], a[252:255], v[108:111]
    ds_read_b64_tr_b16 a[250:251], v30 offset:1320
    s_waitcnt lgkmcnt(10)
    v_mfma_f32_16x16x32_bf16 v[164:167], v[60:63], a[224:227], v[164:167]
    ds_read_b64_tr_b16 a[252:253], v30 offset:80
    buffer_load_dwordx4 v20, s[48:51], s40 offen lds
    v_mfma_f32_16x16x32_bf16 v[148:151], a[204:207], a[204:207], v[148:151]
    ds_read_b64_tr_b16 a[254:255], v30 offset:1360
    s_add_u32 m0, s35, 111616
    v_mfma_f32_16x16x32_bf16 v[112:115], a[200:203], a[228:231], v[112:115]
    ds_read_b64_tr_b16 a[224:225], v36 offset:0
    v_mfma_f32_16x16x32_bf16 v[116:119], a[204:207], a[228:231], v[116:119]
    ds_read_b64_tr_b16 a[226:227], v36 offset:1280
    s_waitcnt lgkmcnt(10)
    v_mfma_f32_16x16x32_bf16 v[120:123], a[200:203], a[232:235], v[120:123]
    ds_read_b64_tr_b16 a[228:229], v30 offset:120
    buffer_load_dwordx4 v21, s[48:51], s40 offen lds
    v_mfma_f32_16x16x32_bf16 v[124:127], a[204:207], a[232:235], v[124:127]
    ds_read_b64_tr_b16 a[230:231], v30 offset:1400
    s_add_u32 m0, s35, 112640
    v_mfma_f32_16x16x32_bf16 v[156:159], v[60:63], a[204:207], v[156:159]
    v_mfma_f32_16x16x32_bf16 v[128:131], a[200:203], a[236:239], v[128:131]
    ds_read_b64_tr_b16 a[232:233], v30 offset:5120
    v_mfma_f32_16x16x32_bf16 v[132:135], a[204:207], a[236:239], v[132:135]
    ds_read_b64_tr_b16 a[234:235], v30 offset:6400
    s_waitcnt lgkmcnt(10)
    v_mfma_f32_16x16x32_bf16 v[136:139], a[200:203], a[240:243], v[136:139]
    ds_read_b64_tr_b16 a[236:237], v30 offset:5160
    buffer_load_dwordx4 v22, s[48:51], s40 offen lds
    v_mfma_f32_16x16x32_bf16 v[140:143], a[204:207], a[240:243], v[140:143]
    ds_read_b64_tr_b16 a[238:239], v30 offset:6440
    s_add_u32 m0, s35, 113664
    v_mfma_f32_16x16x32_bf16 v[64:67], a[208:211], a[244:247], v[64:67]
    ds_read_b64_tr_b16 a[240:241], v36 offset:5120
    v_mfma_f32_16x16x32_bf16 v[68:71], a[212:215], a[244:247], v[68:71]
    ds_read_b64_tr_b16 a[242:243], v36 offset:6400
    s_waitcnt lgkmcnt(10)
    v_mfma_f32_16x16x32_bf16 v[72:75], a[208:211], a[248:251], v[72:75]
    ds_read_b64_tr_b16 a[244:245], v30 offset:5200
    buffer_load_dwordx4 v23, s[48:51], s40 offen lds
    v_mfma_f32_16x16x32_bf16 v[76:79], a[212:215], a[248:251], v[76:79]
    ds_read_b64_tr_b16 a[246:247], v30 offset:6480
    s_add_u32 m0, s35, 114688
    v_mfma_f32_16x16x32_bf16 v[80:83], a[208:211], a[252:255], v[80:83]
    ds_read_b64_tr_b16 a[248:249], v30 offset:5240
    v_mfma_f32_16x16x32_bf16 v[84:87], a[212:215], a[252:255], v[84:87]
    ds_read_b64_tr_b16 a[250:251], v30 offset:6520
    s_waitcnt lgkmcnt(10)
    v_mfma_f32_16x16x32_bf16 v[160:163], v[60:63], a[224:227], v[160:163]
    ds_read_b64_tr_b16 a[252:253], v33 offset:0
    buffer_load_dwordx4 v24, s[48:51], s40 offen lds
    v_mfma_f32_16x16x32_bf16 v[144:147], a[208:211], a[208:211], v[144:147]
    ds_read_b64_tr_b16 a[254:255], v33 offset:1280
    s_lshl_b32 s39, s38, 7
    v_mfma_f32_16x16x32_bf16 v[88:91], a[208:211], a[228:231], v[88:91]
    ds_read_b64_tr_b16 a[224:225], v39 offset:0
    s_add_u32 s39, s39, s36
    v_mfma_f32_16x16x32_bf16 v[92:95], a[212:215], a[228:231], v[92:95]
    ds_read_b64_tr_b16 a[226:227], v39 offset:1280
    s_waitcnt lgkmcnt(10)
    v_mfma_f32_16x16x32_bf16 v[96:99], a[208:211], a[232:235], v[96:99]
    ds_read_b64_tr_b16 a[228:229], v33 offset:5120
    s_mul_i32 s40, s38, 245760
    v_mfma_f32_16x16x32_bf16 v[100:103], a[212:215], a[232:235], v[100:103]
    ds_read_b64_tr_b16 a[230:231], v33 offset:6400
    s_add_u32 s40, s40, s37
    v_mfma_f32_16x16x32_bf16 v[152:155], v[60:63], a[208:211], v[152:155]
    s_add_u32 s38, s38, 1
    s_cmp_eq_u32 s38, 10
    v_mfma_f32_16x16x32_bf16 v[104:107], a[208:211], a[236:239], v[104:107]
    ds_read_b64_tr_b16 a[232:233], v30 offset:10240
    s_cselect_b32 s38, 0, s38
    v_mfma_f32_16x16x32_bf16 v[108:111], a[212:215], a[236:239], v[108:111]
    ds_read_b64_tr_b16 a[234:235], v30 offset:11520
    s_waitcnt lgkmcnt(10)
    v_mfma_f32_16x16x32_bf16 v[164:167], v[60:63], a[240:243], v[164:167]
    ds_read_b64_tr_b16 a[236:237], v30 offset:10280
    s_add_u32 m0, s43, 0
    v_mfma_f32_16x16x32_bf16 v[148:151], a[212:215], a[212:215], v[148:151]
    ds_read_b64_tr_b16 a[238:239], v30 offset:11560
    s_add_u32 s41, s39, 0
    v_mfma_f32_16x16x32_bf16 v[112:115], a[208:211], a[244:247], v[112:115]
    ds_read_b64_tr_b16 a[240:241], v30 offset:10320
    buffer_load_dwordx4 v18, s[44:47], s41 offen lds
    v_mfma_f32_16x16x32_bf16 v[116:119], a[212:215], a[244:247], v[116:119]
    ds_read_b64_tr_b16 a[242:243], v30 offset:11600
    s_waitcnt lgkmcnt(10)
    v_mfma_f32_16x16x32_bf16 v[120:123], a[208:211], a[248:251], v[120:123]
    ds_read_b64_tr_b16 a[244:245], v36 offset:10240
    s_add_u32 m0, s43, 1024
    v_mfma_f32_16x16x32_bf16 v[124:127], a[212:215], a[248:251], v[124:127]
    ds_read_b64_tr_b16 a[246:247], v36 offset:11520
    s_add_u32 s41, s39, 10240
    v_mfma_f32_16x16x32_bf16 v[128:131], a[208:211], a[252:255], v[128:131]
    ds_read_b64_tr_b16 a[248:249], v30 offset:10360
    buffer_load_dwordx4 v18, s[44:47], s41 offen lds
    v_mfma_f32_16x16x32_bf16 v[132:135], a[212:215], a[252:255], v[132:135]
    ds_read_b64_tr_b16 a[250:251], v30 offset:11640
    s_waitcnt lgkmcnt(10)
    v_mfma_f32_16x16x32_bf16 v[168:171], v[60:63], a[224:227], v[168:171]
    ds_read_b64_tr_b16 a[252:253], v30 offset:15360
    s_add_u32 m0, s43, 2048
    v_mfma_f32_16x16x32_bf16 v[156:159], v[60:63], a[212:215], v[156:159]
    ds_read_b64_tr_b16 a[254:255], v30 offset:16640
    s_add_u32 s41, s39, 20480
    v_mfma_f32_16x16x32_bf16 v[136:139], a[208:211], a[228:231], v[136:139]
    ds_read_b64_tr_b16 a[224:225], v30 offset:15400
    buffer_load_dwordx4 v18, s[44:47], s41 offen lds
    v_mfma_f32_16x16x32_bf16 v[140:143], a[212:215], a[228:231], v[140:143]
    ds_read_b64_tr_b16 a[226:227], v30 offset:16680
    s_waitcnt lgkmcnt(10)
    v_mfma_f32_16x16x32_bf16 v[64:67], a[216:219], a[232:235], v[64:67]
    ds_read_b64_tr_b16 a[228:229], v36 offset:15360
    s_add_u32 m0, s43, 3072
    v_mfma_f32_16x16x32_bf16 v[68:71], a[220:223], a[232:235], v[68:71]
    ds_read_b64_tr_b16 a[230:231], v36 offset:16640
    s_add_u32 s41, s39, 30720
    v_mfma_f32_16x16x32_bf16 v[72:75], a[216:219], a[236:239], v[72:75]
    ds_read_b64_tr_b16 a[232:233], v30 offset:15440
    buffer_load_dwordx4 v18, s[44:47], s41 offen lds
    v_mfma_f32_16x16x32_bf16 v[76:79], a[220:223], a[236:239], v[76:79]
    ds_read_b64_tr_b16 a[234:235], v30 offset:16720
    s_waitcnt lgkmcnt(10)
    v_mfma_f32_16x16x32_bf16 v[80:83], a[216:219], a[240:243], v[80:83]
    ds_read_b64_tr_b16 a[236:237], v30 offset:15480
    s_add_u32 m0, s35, 0
    v_mfma_f32_16x16x32_bf16 v[84:87], a[220:223], a[240:243], v[84:87]
    ds_read_b64_tr_b16 a[238:239], v30 offset:16760
    v_mfma_f32_16x16x32_bf16 v[160:163], v[60:63], a[244:247], v[160:163]
    ds_read_b64_tr_b16 a[240:241], v33 offset:10240
    buffer_load_dwordx4 v20, s[48:51], s40 offen lds
    v_mfma_f32_16x16x32_bf16 v[144:147], a[216:219], a[216:219], v[144:147]
    ds_read_b64_tr_b16 a[242:243], v33 offset:11520
    s_waitcnt lgkmcnt(10)
    v_mfma_f32_16x16x32_bf16 v[88:91], a[216:219], a[248:251], v[88:91]
    ds_read_b64_tr_b16 a[244:245], v33 offset:15360
    s_add_u32 m0, s35, 1024
    v_mfma_f32_16x16x32_bf16 v[92:95], a[220:223], a[248:251], v[92:95]
    ds_read_b64_tr_b16 a[246:247], v33 offset:16640
    s_waitcnt vmcnt(14)
    s_waitcnt lgkmcnt(0)
    s_barrier
    ds_read_b128 a[192:195], v43 offset:0
    ds_read_b128 a[196:199], v43 offset:2048
    ds_read_b128 a[200:203], v46 offset:0
    ds_read_b128 a[204:207], v46 offset:2048
    v_mfma_f32_16x16x32_bf16 v[96:99], a[216:219], a[252:255], v[96:99]
    ds_read_b64_tr_b16 a[248:249], v31 offset:0
    buffer_load_dwordx4 v21, s[48:51], s40 offen lds
    v_mfma_f32_16x16x32_bf16 v[100:103], a[220:223], a[252:255], v[100:103]
    ds_read_b64_tr_b16 a[250:251], v31 offset:1280
    s_add_u32 m0, s35, 2048
    v_mfma_f32_16x16x32_bf16 v[152:155], v[60:63], a[216:219], v[152:155]
    s_waitcnt lgkmcnt(10)
    v_mfma_f32_16x16x32_bf16 v[104:107], a[216:219], a[224:227], v[104:107]
    ds_read_b64_tr_b16 a[252:253], v31 offset:40
    v_mfma_f32_16x16x32_bf16 v[108:111], a[220:223], a[224:227], v[108:111]
    ds_read_b64_tr_b16 a[254:255], v31 offset:1320
    buffer_load_dwordx4 v22, s[48:51], s40 offen lds
    v_mfma_f32_16x16x32_bf16 v[164:167], v[60:63], a[228:231], v[164:167]
    ds_read_b64_tr_b16 a[224:225], v31 offset:80
    s_add_u32 m0, s35, 3072
    v_mfma_f32_16x16x32_bf16 v[148:151], a[220:223], a[220:223], v[148:151]
    ds_read_b64_tr_b16 a[226:227], v31 offset:1360
    s_waitcnt lgkmcnt(10)
    v_mfma_f32_16x16x32_bf16 v[112:115], a[216:219], a[232:235], v[112:115]
    ds_read_b64_tr_b16 a[228:229], v37 offset:0
    v_mfma_f32_16x16x32_bf16 v[116:119], a[220:223], a[232:235], v[116:119]
    ds_read_b64_tr_b16 a[230:231], v37 offset:1280
    buffer_load_dwordx4 v23, s[48:51], s40 offen lds
    v_mfma_f32_16x16x32_bf16 v[120:123], a[216:219], a[236:239], v[120:123]
    ds_read_b64_tr_b16 a[232:233], v31 offset:120
    s_add_u32 m0, s35, 4096
    v_mfma_f32_16x16x32_bf16 v[124:127], a[220:223], a[236:239], v[124:127]
    ds_read_b64_tr_b16 a[234:235], v31 offset:1400
    v_mfma_f32_16x16x32_bf16 v[156:159], v[60:63], a[220:223], v[156:159]
    s_waitcnt lgkmcnt(10)
    v_mfma_f32_16x16x32_bf16 v[128:131], a[216:219], a[240:243], v[128:131]
    ds_read_b64_tr_b16 a[236:237], v31 offset:5120
    buffer_load_dwordx4 v24, s[48:51], s40 offen lds
    v_mfma_f32_16x16x32_bf16 v[132:135], a[220:223], a[240:243], v[132:135]
    ds_read_b64_tr_b16 a[238:239], v31 offset:6400
    s_lshl_b32 s39, s38, 7
    v_mfma_f32_16x16x32_bf16 v[136:139], a[216:219], a[244:247], v[136:139]
    ds_read_b64_tr_b16 a[240:241], v31 offset:5160
    s_add_u32 s39, s39, s36
    v_mfma_f32_16x16x32_bf16 v[140:143], a[220:223], a[244:247], v[140:143]
    ds_read_b64_tr_b16 a[242:243], v31 offset:6440
    s_waitcnt lgkmcnt(10)
    v_mfma_f32_16x16x32_bf16 v[64:67], a[192:195], a[248:251], v[64:67]
    ds_read_b64_tr_b16 a[244:245], v37 offset:5120
    s_mul_i32 s40, s38, 245760
    v_mfma_f32_16x16x32_bf16 v[68:71], a[196:199], a[248:251], v[68:71]
    ds_read_b64_tr_b16 a[246:247], v37 offset:6400
    s_add_u32 s40, s40, s37
    v_mfma_f32_16x16x32_bf16 v[72:75], a[192:195], a[252:255], v[72:75]
    ds_read_b64_tr_b16 a[248:249], v31 offset:5200
    s_add_u32 s38, s38, 1
    v_mfma_f32_16x16x32_bf16 v[76:79], a[196:199], a[252:255], v[76:79]
    ds_read_b64_tr_b16 a[250:251], v31 offset:6480
    s_waitcnt lgkmcnt(10)
    v_mfma_f32_16x16x32_bf16 v[80:83], a[192:195], a[224:227], v[80:83]
    ds_read_b64_tr_b16 a[252:253], v31 offset:5240
    s_cmp_eq_u32 s38, 10
    v_mfma_f32_16x16x32_bf16 v[84:87], a[196:199], a[224:227], v[84:87]
    ds_read_b64_tr_b16 a[254:255], v31 offset:6520
    s_cselect_b32 s38, 0, s38
    v_mfma_f32_16x16x32_bf16 v[160:163], v[60:63], a[228:231], v[160:163]
    ds_read_b64_tr_b16 a[224:225], v34 offset:0
    s_add_u32 m0, s43, 36864
    v_mfma_f32_16x16x32_bf16 v[144:147], a[192:195], a[192:195], v[144:147]
    ds_read_b64_tr_b16 a[226:227], v34 offset:1280
    s_waitcnt lgkmcnt(10)
    v_mfma_f32_16x16x32_bf16 v[88:91], a[192:195], a[232:235], v[88:91]
    ds_read_b64_tr_b16 a[228:229], v40 offset:0
    s_add_u32 s41, s39, 0
    v_mfma_f32_16x16x32_bf16 v[92:95], a[196:199], a[232:235], v[92:95]
    ds_read_b64_tr_b16 a[230:231], v40 offset:1280
    buffer_load_dwordx4 v18, s[44:47], s41 offen lds
    v_mfma_f32_16x16x32_bf16 v[96:99], a[192:195], a[236:239], v[96:99]
    ds_read_b64_tr_b16 a[232:233], v34 offset:5120
    s_add_u32 m0, s43, 37888
    v_mfma_f32_16x16x32_bf16 v[100:103], a[196:199], a[236:239], v[100:103]
    ds_read_b64_tr_b16 a[234:235], v34 offset:6400
    s_add_u32 s41, s39, 10240
    v_mfma_f32_16x16x32_bf16 v[152:155], v[60:63], a[192:195], v[152:155]
    s_waitcnt lgkmcnt(10)
    v_mfma_f32_16x16x32_bf16 v[104:107], a[192:195], a[240:243], v[104:107]
    ds_read_b64_tr_b16 a[236:237], v31 offset:10240
    buffer_load_dwordx4 v18, s[44:47], s41 offen lds
    v_mfma_f32_16x16x32_bf16 v[108:111], a[196:199], a[240:243], v[108:111]
    ds_read_b64_tr_b16 a[238:239], v31 offset:11520
    s_add_u32 m0, s43, 38912
    v_mfma_f32_16x16x32_bf16 v[164:167], v[60:63], a[244:247], v[164:167]
    ds_read_b64_tr_b16 a[240:241], v31 offset:10280
    s_add_u32 s41, s39, 20480
    v_mfma_f32_16x16x32_bf16 v[148:151], a[196:199], a[196:199], v[148:151]
    ds_read_b64_tr_b16 a[242:243], v31 offset:11560
    s_waitcnt lgkmcnt(10)
    v_mfma_f32_16x16x32_bf16 v[112:115], a[192:195], a[248:251], v[112:115]
    ds_read_b64_tr_b16 a[244:245], v31 offset:10320
    buffer_load_dwordx4 v18, s[44:47], s41 offen lds
    v_mfma_f32_16x16x32_bf16 v[116:119], a[196:199], a[248:251], v[116:119]
    ds_read_b64_tr_b16 a[246:247], v31 offset:11600
    s_add_u32 m0, s43, 39936
    v_mfma_f32_16x16x32_bf16 v[120:123], a[192:195], a[252:255], v[120:123]
    ds_read_b64_tr_b16 a[248:249], v37 offset:10240
    s_add_u32 s41, s39, 30720
    v_mfma_f32_16x16x32_bf16 v[124:127], a[196:199], a[252:255], v[124:127]
    ds_read_b64_tr_b16 a[250:251], v37 offset:11520
    s_waitcnt lgkmcnt(10)
    v_mfma_f32_16x16x32_bf16 v[128:131], a[192:195], a[224:227], v[128:131]
    ds_read_b64_tr_b16 a[252:253], v31 offset:10360
    buffer_load_dwordx4 v18, s[44:47], s41 offen lds
    v_mfma_f32_16x16x32_bf16 v[132:135], a[196:199], a[224:227], v[132:135]
    ds_read_b64_tr_b16 a[254:255], v31 offset:11640
    s_add_u32 m0, s35, 36864
    v_mfma_f32_16x16x32_bf16 v[168:171], v[60:63], a[228:231], v[168:171]
    ds_read_b64_tr_b16 a[224:225], v31 offset:15360
    v_mfma_f32_16x16x32_bf16 v[156:159], v[60:63], a[196:199], v[156:159]
    ds_read_b64_tr_b16 a[226:227], v31 offset:16640
    s_waitcnt lgkmcnt(10)
    v_mfma_f32_16x16x32_bf16 v[136:139], a[192:195], a[232:235], v[136:139]
    ds_read_b64_tr_b16 a[228:229], v31 offset:15400
    buffer_load_dwordx4 v20, s[48:51], s40 offen lds
    v_mfma_f32_16x16x32_bf16 v[140:143], a[196:199], a[232:235], v[140:143]
    ds_read_b64_tr_b16 a[230:231], v31 offset:16680
    s_add_u32 m0, s35, 37888
    v_mfma_f32_16x16x32_bf16 v[64:67], a[200:203], a[236:239], v[64:67]
    ds_read_b64_tr_b16 a[232:233], v37 offset:15360
    v_mfma_f32_16x16x32_bf16 v[68:71], a[204:207], a[236:239], v[68:71]
    ds_read_b64_tr_b16 a[234:235], v37 offset:16640
    s_waitcnt lgkmcnt(10)
    v_mfma_f32_16x16x32_bf16 v[72:75], a[200:203], a[240:243], v[72:75]
    ds_read_b64_tr_b16 a[236:237], v31 offset:15440
    buffer_load_dwordx4 v21, s[48:51], s40 offen lds
    v_mfma_f32_16x16x32_bf16 v[76:79], a[204:207], a[240:243], v[76:79]
    ds_read_b64_tr_b16 a[238:239], v31 offset:16720
    s_add_u32 m0, s35, 38912
    v_mfma_f32_16x16x32_bf16 v[80:83], a[200:203], a[244:247], v[80:83]
    ds_read_b64_tr_b16 a[240:241], v31 offset:15480
    v_mfma_f32_16x16x32_bf16 v[84:87], a[204:207], a[244:247], v[84:87]
    ds_read_b64_tr_b16 a[242:243], v31 offset:16760
    s_waitcnt lgkmcnt(10)
    v_mfma_f32_16x16x32_bf16 v[160:163], v[60:63], a[248:251], v[160:163]
    ds_read_b64_tr_b16 a[244:245], v34 offset:10240
    buffer_load_dwordx4 v22, s[48:51], s40 offen lds
    v_mfma_f32_16x16x32_bf16 v[144:147], a[200:203], a[200:203], v[144:147]
    ds_read_b64_tr_b16 a[246:247], v34 offset:11520
    s_add_u32 m0, s35, 39936
    v_mfma_f32_16x16x32_bf16 v[88:91], a[200:203], a[252:255], v[88:91]
    ds_read_b64_tr_b16 a[248:249], v34 offset:15360
    v_mfma_f32_16x16x32_bf16 v[92:95], a[204:207], a[252:255], v[92:95]
    ds_read_b64_tr_b16 a[250:251], v34 offset:16640
    s_waitcnt lgkmcnt(10)
    s_waitcnt vmcnt(16)
    s_waitcnt lgkmcnt(0)
    s_barrier
    ds_read_b128 a[208:211], v44 offset:0
    ds_read_b128 a[212:215], v44 offset:2048
    ds_read_b128 a[216:219], v47 offset:0
    ds_read_b128 a[220:223], v47 offset:2048
    v_mfma_f32_16x16x32_bf16 v[96:99], a[200:203], a[224:227], v[96:99]
    ds_read_b64_tr_b16 a[252:253], v32 offset:0
    buffer_load_dwordx4 v23, s[48:51], s40 offen lds
    v_mfma_f32_16x16x32_bf16 v[100:103], a[204:207], a[224:227], v[100:103]
    ds_read_b64_tr_b16 a[254:255], v32 offset:1280
    s_add_u32 m0, s35, 40960
    v_mfma_f32_16x16x32_bf16 v[152:155], v[60:63], a[200:203], v[152:155]
    v_mfma_f32_16x16x32_bf16 v[104:107], a[200:203], a[228:231], v[104:107]
    ds_read_b64_tr_b16 a[224:225], v32 offset:40
    v_mfma_f32_16x16x32_bf16 v[108:111], a[204:207], a[228:231], v[108:111]
    ds_read_b64_tr_b16 a[226:227], v32 offset:1320
    s_waitcnt lgkmcnt(10)
    v_mfma_f32_16x16x32_bf16 v[164:167], v[60:63], a[232:235], v[164:167]
    ds_read_b64_tr_b16 a[228:229], v32 offset:80
    buffer_load_dwordx4 v24, s[48:51], s40 offen lds
    v_mfma_f32_16x16x32_bf16 v[148:151], a[204:207], a[204:207], v[148:151]
    ds_read_b64_tr_b16 a[230:231], v32 offset:1360
    v_mfma_f32_16x16x32_bf16 v[112:115], a[200:203], a[236:239], v[112:115]
    ds_read_b64_tr_b16 a[232:233], v38 offset:0
    v_mfma_f32_16x16x32_bf16 v[116:119], a[204:207], a[236:239], v[116:119]
    ds_read_b64_tr_b16 a[234:235], v38 offset:1280
    s_waitcnt lgkmcnt(10)
    v_mfma_f32_16x16x32_bf16 v[120:123], a[200:203], a[240:243], v[120:123]
    ds_read_b64_tr_b16 a[236:237], v32 offset:120
    v_mfma_f32_16x16x32_bf16 v[124:127], a[204:207], a[240:243], v[124:127]
    ds_read_b64_tr_b16 a[238:239], v32 offset:1400
    v_mfma_f32_16x16x32_bf16 v[156:159], v[60:63], a[204:207], v[156:159]
    v_mfma_f32_16x16x32_bf16 v[128:131], a[200:203], a[244:247], v[128:131]
    ds_read_b64_tr_b16 a[240:241], v32 offset:5120
    v_mfma_f32_16x16x32_bf16 v[132:135], a[204:207], a[244:247], v[132:135]
    ds_read_b64_tr_b16 a[242:243], v32 offset:6400
    s_waitcnt lgkmcnt(10)
    v_mfma_f32_16x16x32_bf16 v[136:139], a[200:203], a[248:251], v[136:139]
    ds_read_b64_tr_b16 a[244:245], v32 offset:5160
    v_mfma_f32_16x16x32_bf16 v[140:143], a[204:207], a[248:251], v[140:143]
    ds_read_b64_tr_b16 a[246:247], v32 offset:6440
    v_mfma_f32_16x16x32_bf16 v[64:67], a[208:211], a[252:255], v[64:67]
    ds_read_b64_tr_b16 a[248:249], v38 offset:5120
    v_mfma_f32_16x16x32_bf16 v[68:71], a[212:215], a[252:255], v[68:71]
    ds_read_b64_tr_b16 a[250:251], v38 offset:6400
    s_waitcnt lgkmcnt(10)
    v_mfma_f32_16x16x32_bf16 v[72:75], a[208:211], a[224:227], v[72:75]
    ds_read_b64_tr_b16 a[252:253], v32 offset:5200
    v_mfma_f32_16x16x32_bf16 v[76:79], a[212:215], a[224:227], v[76:79]
    ds_read_b64_tr_b16 a[254:255], v32 offset:6480
    v_mfma_f32_16x16x32_bf16 v[80:83], a[208:211], a[228:231], v[80:83]
    ds_read_b64_tr_b16 a[224:225], v32 offset:5240
    v_mfma_f32_16x16x32_bf16 v[84:87], a[212:215], a[228:231], v[84:87]
    ds_read_b64_tr_b16 a[226:227], v32 offset:6520
    s_waitcnt lgkmcnt(10)
    v_mfma_f32_16x16x32_bf16 v[160:163], v[60:63], a[232:235], v[160:163]
    ds_read_b64_tr_b16 a[228:229], v35 offset:0
    v_mfma_f32_16x16x32_bf16 v[144:147], a[208:211], a[208:211], v[144:147]
    ds_read_b64_tr_b16 a[230:231], v35 offset:1280
    v_mfma_f32_16x16x32_bf16 v[88:91], a[208:211], a[236:239], v[88:91]
    ds_read_b64_tr_b16 a[232:233], v41 offset:0
    v_mfma_f32_16x16x32_bf16 v[92:95], a[212:215], a[236:239], v[92:95]
    ds_read_b64_tr_b16 a[234:235], v41 offset:1280
    s_waitcnt lgkmcnt(10)
    v_mfma_f32_16x16x32_bf16 v[96:99], a[208:211], a[240:243], v[96:99]
    ds_read_b64_tr_b16 a[236:237], v35 offset:5120
    v_mfma_f32_16x16x32_bf16 v[100:103], a[212:215], a[240:243], v[100:103]
    ds_read_b64_tr_b16 a[238:239], v35 offset:6400
    v_mfma_f32_16x16x32_bf16 v[152:155], v[60:63], a[208:211], v[152:155]
    v_mfma_f32_16x16x32_bf16 v[104:107], a[208:211], a[244:247], v[104:107]
    ds_read_b64_tr_b16 a[240:241], v32 offset:10240
    v_mfma_f32_16x16x32_bf16 v[108:111], a[212:215], a[244:247], v[108:111]
    ds_read_b64_tr_b16 a[242:243], v32 offset:11520
    s_waitcnt lgkmcnt(10)
    v_mfma_f32_16x16x32_bf16 v[164:167], v[60:63], a[248:251], v[164:167]
    ds_read_b64_tr_b16 a[244:245], v32 offset:10280
    v_mfma_f32_16x16x32_bf16 v[148:151], a[212:215], a[212:215], v[148:151]
    ds_read_b64_tr_b16 a[246:247], v32 offset:11560
    v_mfma_f32_16x16x32_bf16 v[112:115], a[208:211], a[252:255], v[112:115]
    ds_read_b64_tr_b16 a[248:249], v32 offset:10320
    v_mfma_f32_16x16x32_bf16 v[116:119], a[212:215], a[252:255], v[116:119]
    ds_read_b64_tr_b16 a[250:251], v32 offset:11600
    s_waitcnt lgkmcnt(10)
    v_mfma_f32_16x16x32_bf16 v[120:123], a[208:211], a[224:227], v[120:123]
    ds_read_b64_tr_b16 a[252:253], v38 offset:10240
    v_mfma_f32_16x16x32_bf16 v[124:127], a[212:215], a[224:227], v[124:127]
    ds_read_b64_tr_b16 a[254:255], v38 offset:11520
    v_mfma_f32_16x16x32_bf16 v[128:131], a[208:211], a[228:231], v[128:131]
    ds_read_b64_tr_b16 a[224:225], v32 offset:10360
    v_mfma_f32_16x16x32_bf16 v[132:135], a[212:215], a[228:231], v[132:135]
    ds_read_b64_tr_b16 a[226:227], v32 offset:11640
    s_waitcnt lgkmcnt(10)
    v_mfma_f32_16x16x32_bf16 v[168:171], v[60:63], a[232:235], v[168:171]
    ds_read_b64_tr_b16 a[228:229], v32 offset:15360
    v_mfma_f32_16x16x32_bf16 v[156:159], v[60:63], a[212:215], v[156:159]
    ds_read_b64_tr_b16 a[230:231], v32 offset:16640
    v_mfma_f32_16x16x32_bf16 v[136:139], a[208:211], a[236:239], v[136:139]
    ds_read_b64_tr_b16 a[232:233], v32 offset:15400
    v_mfma_f32_16x16x32_bf16 v[140:143], a[212:215], a[236:239], v[140:143]
    ds_read_b64_tr_b16 a[234:235], v32 offset:16680
    s_waitcnt lgkmcnt(10)
    v_mfma_f32_16x16x32_bf16 v[64:67], a[216:219], a[240:243], v[64:67]
    ds_read_b64_tr_b16 a[236:237], v38 offset:15360
    v_mfma_f32_16x16x32_bf16 v[68:71], a[220:223], a[240:243], v[68:71]
    ds_read_b64_tr_b16 a[238:239], v38 offset:16640
    v_mfma_f32_16x16x32_bf16 v[72:75], a[216:219], a[244:247], v[72:75]
    ds_read_b64_tr_b16 a[240:241], v32 offset:15440
    v_mfma_f32_16x16x32_bf16 v[76:79], a[220:223], a[244:247], v[76:79]
    ds_read_b64_tr_b16 a[242:243], v32 offset:16720
    s_waitcnt lgkmcnt(10)
    v_mfma_f32_16x16x32_bf16 v[80:83], a[216:219], a[248:251], v[80:83]
    ds_read_b64_tr_b16 a[244:245], v32 offset:15480
    v_mfma_f32_16x16x32_bf16 v[84:87], a[220:223], a[248:251], v[84:87]
    ds_read_b64_tr_b16 a[246:247], v32 offset:16760
    v_mfma_f32_16x16x32_bf16 v[160:163], v[60:63], a[252:255], v[160:163]
    ds_read_b64_tr_b16 a[248:249], v35 offset:10240
    v_mfma_f32_16x16x32_bf16 v[144:147], a[216:219], a[216:219], v[144:147]
    ds_read_b64_tr_b16 a[250:251], v35 offset:11520
    s_waitcnt lgkmcnt(10)
    v_mfma_f32_16x16x32_bf16 v[88:91], a[216:219], a[224:227], v[88:91]
    ds_read_b64_tr_b16 a[252:253], v35 offset:15360
    v_mfma_f32_16x16x32_bf16 v[92:95], a[220:223], a[224:227], v[92:95]
    ds_read_b64_tr_b16 a[254:255], v35 offset:16640
    s_waitcnt vmcnt(9)
    s_waitcnt lgkmcnt(0)
    s_barrier
    ds_read_b128 a[192:195], v25 offset:0
    ds_read_b128 a[196:199], v25 offset:2048
    ds_read_b128 a[200:203], v19 offset:0
    ds_read_b128 a[204:207], v19 offset:2048
    v_mfma_f32_16x16x32_bf16 v[96:99], a[216:219], a[228:231], v[96:99]
    ds_read_b64_tr_b16 a[224:225], v26 offset:0
    v_mfma_f32_16x16x32_bf16 v[100:103], a[220:223], a[228:231], v[100:103]
    ds_read_b64_tr_b16 a[226:227], v26 offset:1280
    v_mfma_f32_16x16x32_bf16 v[152:155], v[60:63], a[216:219], v[152:155]
    s_waitcnt lgkmcnt(10)
    v_mfma_f32_16x16x32_bf16 v[104:107], a[216:219], a[232:235], v[104:107]
    ds_read_b64_tr_b16 a[228:229], v26 offset:40
    v_mfma_f32_16x16x32_bf16 v[108:111], a[220:223], a[232:235], v[108:111]
    ds_read_b64_tr_b16 a[230:231], v26 offset:1320
    v_mfma_f32_16x16x32_bf16 v[164:167], v[60:63], a[236:239], v[164:167]
    ds_read_b64_tr_b16 a[232:233], v26 offset:80
    v_mfma_f32_16x16x32_bf16 v[148:151], a[220:223], a[220:223], v[148:151]
    ds_read_b64_tr_b16 a[234:235], v26 offset:1360
    s_waitcnt lgkmcnt(10)
    v_mfma_f32_16x16x32_bf16 v[112:115], a[216:219], a[240:243], v[112:115]
    ds_read_b64_tr_b16 a[236:237], v28 offset:0
    v_mfma_f32_16x16x32_bf16 v[116:119], a[220:223], a[240:243], v[116:119]
    ds_read_b64_tr_b16 a[238:239], v28 offset:1280
    v_mfma_f32_16x16x32_bf16 v[120:123], a[216:219], a[244:247], v[120:123]
    ds_read_b64_tr_b16 a[240:241], v26 offset:120
    v_mfma_f32_16x16x32_bf16 v[124:127], a[220:223], a[244:247], v[124:127]
    ds_read_b64_tr_b16 a[242:243], v26 offset:1400
    v_mfma_f32_16x16x32_bf16 v[156:159], v[60:63], a[220:223], v[156:159]
    s_waitcnt lgkmcnt(10)
    v_mfma_f32_16x16x32_bf16 v[128:131], a[216:219], a[248:251], v[128:131]
    ds_read_b64_tr_b16 a[244:245], v26 offset:5120
    v_mfma_f32_16x16x32_bf16 v[132:135], a[220:223], a[248:251], v[132:135]
    ds_read_b64_tr_b16 a[246:247], v26 offset:6400
    v_mfma_f32_16x16x32_bf16 v[136:139], a[216:219], a[252:255], v[136:139]
    ds_read_b64_tr_b16 a[248:249], v26 offset:5160
    v_mfma_f32_16x16x32_bf16 v[140:143], a[220:223], a[252:255], v[140:143]
    ds_read_b64_tr_b16 a[250:251], v26 offset:6440
    s_waitcnt lgkmcnt(10)
    v_mfma_f32_16x16x32_bf16 v[64:67], a[192:195], a[224:227], v[64:67]
    ds_read_b64_tr_b16 a[252:253], v28 offset:5120
    v_mfma_f32_16x16x32_bf16 v[68:71], a[196:199], a[224:227], v[68:71]
    ds_read_b64_tr_b16 a[254:255], v28 offset:6400
    v_mfma_f32_16x16x32_bf16 v[72:75], a[192:195], a[228:231], v[72:75]
    ds_read_b64_tr_b16 a[224:225], v26 offset:5200
    v_mfma_f32_16x16x32_bf16 v[76:79], a[196:199], a[228:231], v[76:79]
    ds_read_b64_tr_b16 a[226:227], v26 offset:6480
    s_waitcnt lgkmcnt(10)
    v_mfma_f32_16x16x32_bf16 v[80:83], a[192:195], a[232:235], v[80:83]
    ds_read_b64_tr_b16 a[228:229], v26 offset:5240
    v_mfma_f32_16x16x32_bf16 v[84:87], a[196:199], a[232:235], v[84:87]
    ds_read_b64_tr_b16 a[230:231], v26 offset:6520
    v_mfma_f32_16x16x32_bf16 v[160:163], v[60:63], a[236:239], v[160:163]
    ds_read_b64_tr_b16 a[232:233], v27 offset:0
    v_mfma_f32_16x16x32_bf16 v[144:147], a[192:195], a[192:195], v[144:147]
    ds_read_b64_tr_b16 a[234:235], v27 offset:1280
    s_waitcnt lgkmcnt(10)
    v_mfma_f32_16x16x32_bf16 v[88:91], a[192:195], a[240:243], v[88:91]
    ds_read_b64_tr_b16 a[236:237], v29 offset:0
    v_mfma_f32_16x16x32_bf16 v[92:95], a[196:199], a[240:243], v[92:95]
    ds_read_b64_tr_b16 a[238:239], v29 offset:1280
    v_mfma_f32_16x16x32_bf16 v[96:99], a[192:195], a[244:247], v[96:99]
    ds_read_b64_tr_b16 a[240:241], v27 offset:5120
    v_mfma_f32_16x16x32_bf16 v[100:103], a[196:199], a[244:247], v[100:103]
    ds_read_b64_tr_b16 a[242:243], v27 offset:6400
    v_mfma_f32_16x16x32_bf16 v[152:155], v[60:63], a[192:195], v[152:155]
    s_waitcnt lgkmcnt(10)
    v_mfma_f32_16x16x32_bf16 v[104:107], a[192:195], a[248:251], v[104:107]
    ds_read_b64_tr_b16 a[244:245], v26 offset:10240
    v_mfma_f32_16x16x32_bf16 v[108:111], a[196:199], a[248:251], v[108:111]
    ds_read_b64_tr_b16 a[246:247], v26 offset:11520
    v_mfma_f32_16x16x32_bf16 v[164:167], v[60:63], a[252:255], v[164:167]
    ds_read_b64_tr_b16 a[248:249], v26 offset:10280
    v_mfma_f32_16x16x32_bf16 v[148:151], a[196:199], a[196:199], v[148:151]
    ds_read_b64_tr_b16 a[250:251], v26 offset:11560
    s_waitcnt lgkmcnt(10)
    v_mfma_f32_16x16x32_bf16 v[112:115], a[192:195], a[224:227], v[112:115]
    ds_read_b64_tr_b16 a[252:253], v26 offset:10320
    v_mfma_f32_16x16x32_bf16 v[116:119], a[196:199], a[224:227], v[116:119]
    ds_read_b64_tr_b16 a[254:255], v26 offset:11600
    v_mfma_f32_16x16x32_bf16 v[120:123], a[192:195], a[228:231], v[120:123]
    ds_read_b64_tr_b16 a[224:225], v28 offset:10240
    v_mfma_f32_16x16x32_bf16 v[124:127], a[196:199], a[228:231], v[124:127]
    ds_read_b64_tr_b16 a[226:227], v28 offset:11520
    s_waitcnt lgkmcnt(10)
    v_mfma_f32_16x16x32_bf16 v[128:131], a[192:195], a[232:235], v[128:131]
    ds_read_b64_tr_b16 a[228:229], v26 offset:10360
    v_mfma_f32_16x16x32_bf16 v[132:135], a[196:199], a[232:235], v[132:135]
    ds_read_b64_tr_b16 a[230:231], v26 offset:11640
    v_mfma_f32_16x16x32_bf16 v[168:171], v[60:63], a[236:239], v[168:171]
    ds_read_b64_tr_b16 a[232:233], v26 offset:15360
    v_mfma_f32_16x16x32_bf16 v[156:159], v[60:63], a[196:199], v[156:159]
    ds_read_b64_tr_b16 a[234:235], v26 offset:16640
    s_waitcnt lgkmcnt(10)
    v_mfma_f32_16x16x32_bf16 v[136:139], a[192:195], a[240:243], v[136:139]
    ds_read_b64_tr_b16 a[236:237], v26 offset:15400
    v_mfma_f32_16x16x32_bf16 v[140:143], a[196:199], a[240:243], v[140:143]
    ds_read_b64_tr_b16 a[238:239], v26 offset:16680
    v_mfma_f32_16x16x32_bf16 v[64:67], a[200:203], a[244:247], v[64:67]
    ds_read_b64_tr_b16 a[240:241], v28 offset:15360
    v_mfma_f32_16x16x32_bf16 v[68:71], a[204:207], a[244:247], v[68:71]
    ds_read_b64_tr_b16 a[242:243], v28 offset:16640
    s_waitcnt lgkmcnt(10)
    v_mfma_f32_16x16x32_bf16 v[72:75], a[200:203], a[248:251], v[72:75]
    ds_read_b64_tr_b16 a[244:245], v26 offset:15440
    v_mfma_f32_16x16x32_bf16 v[76:79], a[204:207], a[248:251], v[76:79]
    ds_read_b64_tr_b16 a[246:247], v26 offset:16720
    v_mfma_f32_16x16x32_bf16 v[80:83], a[200:203], a[252:255], v[80:83]
    ds_read_b64_tr_b16 a[248:249], v26 offset:15480
    v_mfma_f32_16x16x32_bf16 v[84:87], a[204:207], a[252:255], v[84:87]
    ds_read_b64_tr_b16 a[250:251], v26 offset:16760
    s_waitcnt lgkmcnt(10)
    v_mfma_f32_16x16x32_bf16 v[160:163], v[60:63], a[224:227], v[160:163]
    ds_read_b64_tr_b16 a[252:253], v27 offset:10240
    v_mfma_f32_16x16x32_bf16 v[144:147], a[200:203], a[200:203], v[144:147]
    ds_read_b64_tr_b16 a[254:255], v27 offset:11520
    v_mfma_f32_16x16x32_bf16 v[88:91], a[200:203], a[228:231], v[88:91]
    ds_read_b64_tr_b16 a[224:225], v27 offset:15360
    v_mfma_f32_16x16x32_bf16 v[92:95], a[204:207], a[228:231], v[92:95]
    ds_read_b64_tr_b16 a[226:227], v27 offset:16640
    s_waitcnt lgkmcnt(10)
    s_waitcnt vmcnt(0)
    s_waitcnt lgkmcnt(0)
    s_barrier
    ds_read_b128 a[208:211], v42 offset:0
    ds_read_b128 a[212:215], v42 offset:2048
    ds_read_b128 a[216:219], v45 offset:0
    ds_read_b128 a[220:223], v45 offset:2048
    v_mfma_f32_16x16x32_bf16 v[96:99], a[200:203], a[232:235], v[96:99]
    ds_read_b64_tr_b16 a[228:229], v36 offset:0
    v_mfma_f32_16x16x32_bf16 v[100:103], a[204:207], a[232:235], v[100:103]
    ds_read_b64_tr_b16 a[230:231], v36 offset:1280
    v_mfma_f32_16x16x32_bf16 v[152:155], v[60:63], a[200:203], v[152:155]
    v_mfma_f32_16x16x32_bf16 v[104:107], a[200:203], a[236:239], v[104:107]
    ds_read_b64_tr_b16 a[232:233], v36 offset:5120
    v_mfma_f32_16x16x32_bf16 v[108:111], a[204:207], a[236:239], v[108:111]
    ds_read_b64_tr_b16 a[234:235], v36 offset:6400
    s_waitcnt lgkmcnt(10)
    v_mfma_f32_16x16x32_bf16 v[164:167], v[60:63], a[240:243], v[164:167]
    ds_read_b64_tr_b16 a[236:237], v39 offset:0
    v_mfma_f32_16x16x32_bf16 v[148:151], a[204:207], a[204:207], v[148:151]
    ds_read_b64_tr_b16 a[238:239], v39 offset:1280
    v_mfma_f32_16x16x32_bf16 v[112:115], a[200:203], a[244:247], v[112:115]
    ds_read_b64_tr_b16 a[240:241], v36 offset:10240
    v_mfma_f32_16x16x32_bf16 v[116:119], a[204:207], a[244:247], v[116:119]
    ds_read_b64_tr_b16 a[242:243], v36 offset:11520
    s_waitcnt lgkmcnt(10)
    v_mfma_f32_16x16x32_bf16 v[120:123], a[200:203], a[248:251], v[120:123]
    ds_read_b64_tr_b16 a[244:245], v36 offset:15360
    v_mfma_f32_16x16x32_bf16 v[124:127], a[204:207], a[248:251], v[124:127]
    ds_read_b64_tr_b16 a[246:247], v36 offset:16640
    v_mfma_f32_16x16x32_bf16 v[156:159], v[60:63], a[204:207], v[156:159]
    v_mfma_f32_16x16x32_bf16 v[128:131], a[200:203], a[252:255], v[128:131]
    ds_read_b64_tr_b16 a[248:249], v30 offset:0
    v_mfma_f32_16x16x32_bf16 v[132:135], a[204:207], a[252:255], v[132:135]
    ds_read_b64_tr_b16 a[250:251], v30 offset:1280
    s_waitcnt lgkmcnt(10)
    v_mfma_f32_16x16x32_bf16 v[136:139], a[200:203], a[224:227], v[136:139]
    ds_read_b64_tr_b16 a[252:253], v30 offset:40
    v_mfma_f32_16x16x32_bf16 v[140:143], a[204:207], a[224:227], v[140:143]
    ds_read_b64_tr_b16 a[254:255], v30 offset:1320
    v_mfma_f32_16x16x32_bf16 v[160:163], v[60:63], a[228:231], v[160:163]
    ds_read_b64_tr_b16 a[224:225], v30 offset:80
    v_mfma_f32_16x16x32_bf16 v[144:147], a[208:211], a[208:211], v[144:147]
    ds_read_b64_tr_b16 a[226:227], v30 offset:1360
    v_mfma_f32_16x16x32_bf16 v[152:155], v[60:63], a[208:211], v[152:155]
    s_waitcnt lgkmcnt(10)
    v_mfma_f32_16x16x32_bf16 v[164:167], v[60:63], a[232:235], v[164:167]
    ds_read_b64_tr_b16 a[228:229], v30 offset:120
    v_mfma_f32_16x16x32_bf16 v[148:151], a[212:215], a[212:215], v[148:151]
    ds_read_b64_tr_b16 a[230:231], v30 offset:1400
    v_mfma_f32_16x16x32_bf16 v[168:171], v[60:63], a[236:239], v[168:171]
    ds_read_b64_tr_b16 a[232:233], v30 offset:5120
    v_mfma_f32_16x16x32_bf16 v[156:159], v[60:63], a[212:215], v[156:159]
    ds_read_b64_tr_b16 a[234:235], v30 offset:6400
    s_waitcnt lgkmcnt(10)
    v_mfma_f32_16x16x32_bf16 v[160:163], v[60:63], a[240:243], v[160:163]
    ds_read_b64_tr_b16 a[236:237], v30 offset:5160
    v_mfma_f32_16x16x32_bf16 v[144:147], a[216:219], a[216:219], v[144:147]
    ds_read_b64_tr_b16 a[238:239], v30 offset:6440
    v_mfma_f32_16x16x32_bf16 v[152:155], v[60:63], a[216:219], v[152:155]
    v_mfma_f32_16x16x32_bf16 v[164:167], v[60:63], a[244:247], v[164:167]
    ds_read_b64_tr_b16 a[240:241], v30 offset:5200
    v_mfma_f32_16x16x32_bf16 v[148:151], a[220:223], a[220:223], v[148:151]
    ds_read_b64_tr_b16 a[242:243], v30 offset:6480
    v_mfma_f32_16x16x32_bf16 v[156:159], v[60:63], a[220:223], v[156:159]
    s_waitcnt lgkmcnt(10)
    v_mfma_f32_16x16x32_bf16 v[64:67], a[208:211], a[248:251], v[64:67]
    ds_read_b64_tr_b16 a[244:245], v30 offset:5240
    v_mfma_f32_16x16x32_bf16 v[68:71], a[212:215], a[248:251], v[68:71]
    ds_read_b64_tr_b16 a[246:247], v30 offset:6520
    v_mfma_f32_16x16x32_bf16 v[72:75], a[208:211], a[252:255], v[72:75]
    ds_read_b64_tr_b16 a[248:249], v33 offset:0
    v_mfma_f32_16x16x32_bf16 v[76:79], a[212:215], a[252:255], v[76:79]
    ds_read_b64_tr_b16 a[250:251], v33 offset:1280
    s_waitcnt lgkmcnt(10)
    v_mfma_f32_16x16x32_bf16 v[80:83], a[208:211], a[224:227], v[80:83]
    ds_read_b64_tr_b16 a[252:253], v33 offset:5120
    ds_write_b32 v9, v160
    v_mfma_f32_16x16x32_bf16 v[84:87], a[212:215], a[224:227], v[84:87]
    ds_read_b64_tr_b16 a[254:255], v33 offset:6400
    ds_write_b32 v9, v164 offset:256
    v_mfma_f32_16x16x32_bf16 v[88:91], a[208:211], a[228:231], v[88:91]
    ds_read_b64_tr_b16 a[224:225], v30 offset:10240
    ds_write_b32 v11, v168
    v_mfma_f32_16x16x32_bf16 v[92:95], a[212:215], a[228:231], v[92:95]
    ds_read_b64_tr_b16 a[226:227], v30 offset:11520
    s_waitcnt lgkmcnt(10)
    v_mfma_f32_16x16x32_bf16 v[96:99], a[208:211], a[232:235], v[96:99]
    ds_read_b64_tr_b16 a[228:229], v30 offset:10280
    buffer_load_dword v57, v201, s[72:75], s70 offen sc1
    v_mfma_f32_16x16x32_bf16 v[100:103], a[212:215], a[232:235], v[100:103]
    ds_read_b64_tr_b16 a[230:231], v30 offset:11560
    v_cndmask_b32 v144, v144, v145, s[64:65]
    v_mfma_f32_16x16x32_bf16 v[104:107], a[208:211], a[236:239], v[104:107]
    ds_read_b64_tr_b16 a[232:233], v30 offset:10320
    v_cndmask_b32 v144, v144, v146, s[66:67]
    v_mfma_f32_16x16x32_bf16 v[108:111], a[212:215], a[236:239], v[108:111]
    ds_read_b64_tr_b16 a[234:235], v30 offset:11600
    s_waitcnt lgkmcnt(10)
    v_mfma_f32_16x16x32_bf16 v[112:115], a[208:211], a[240:243], v[112:115]
    ds_read_b64_tr_b16 a[236:237], v30 offset:10360
    v_cndmask_b32 v144, v144, v147, s[68:69]
    v_mfma_f32_16x16x32_bf16 v[116:119], a[212:215], a[240:243], v[116:119]
    ds_read_b64_tr_b16 a[238:239], v30 offset:11640
    ds_bpermute_b32 v145, v17, v144
    v_mfma_f32_16x16x32_bf16 v[120:123], a[208:211], a[244:247], v[120:123]
    ds_read_b64_tr_b16 a[240:241], v30 offset:15360
    v_cndmask_b32 v148, v148, v149, s[64:65]
    v_mfma_f32_16x16x32_bf16 v[124:127], a[212:215], a[244:247], v[124:127]
    ds_read_b64_tr_b16 a[242:243], v30 offset:16640
    s_waitcnt lgkmcnt(10)
    v_mfma_f32_16x16x32_bf16 v[128:131], a[208:211], a[248:251], v[128:131]
    ds_read_b64_tr_b16 a[244:245], v30 offset:15400
    v_cndmask_b32 v148, v148, v150, s[66:67]
    v_mfma_f32_16x16x32_bf16 v[132:135], a[212:215], a[248:251], v[132:135]
    ds_read_b64_tr_b16 a[246:247], v30 offset:16680
    v_cndmask_b32 v148, v148, v151, s[68:69]
    v_mfma_f32_16x16x32_bf16 v[136:139], a[208:211], a[252:255], v[136:139]
    ds_read_b64_tr_b16 a[248:249], v30 offset:15440
    ds_bpermute_b32 v149, v17, v148
    v_mfma_f32_16x16x32_bf16 v[140:143], a[212:215], a[252:255], v[140:143]
    ds_read_b64_tr_b16 a[250:251], v30 offset:16720
    s_waitcnt lgkmcnt(10)
    v_mfma_f32_16x16x32_bf16 v[64:67], a[216:219], a[224:227], v[64:67]
    ds_read_b64_tr_b16 a[252:253], v30 offset:15480
    v_mul_f32 v152, 0x3acccccd, v152
    v_mfma_f32_16x16x32_bf16 v[68:71], a[220:223], a[224:227], v[68:71]
    ds_read_b64_tr_b16 a[254:255], v30 offset:16760
    v_mul_f32 v156, 0x3acccccd, v156
    v_mfma_f32_16x16x32_bf16 v[72:75], a[216:219], a[228:231], v[72:75]
    ds_read_b64_tr_b16 a[224:225], v33 offset:10240
    s_waitcnt lgkmcnt(10)
    v_mul_f32 v145, 0x3acccccd, v145
    v_mfma_f32_16x16x32_bf16 v[76:79], a[220:223], a[228:231], v[76:79]
    ds_read_b64_tr_b16 a[226:227], v33 offset:11520
    s_waitcnt lgkmcnt(10)
    v_mfma_f32_16x16x32_bf16 v[80:83], a[216:219], a[232:235], v[80:83]
    ds_read_b64_tr_b16 a[228:229], v33 offset:15360
    s_waitcnt lgkmcnt(6)
    v_mul_f32 v149, 0x3acccccd, v149
    v_mfma_f32_16x16x32_bf16 v[84:87], a[220:223], a[232:235], v[84:87]
    ds_read_b64_tr_b16 a[230:231], v33 offset:16640
    v_fma_f32 v145, -v152, v152, v145
    v_mfma_f32_16x16x32_bf16 v[88:91], a[216:219], a[236:239], v[88:91]
    v_fma_f32 v149, -v156, v156, v149
    v_max_f32 v145, 0, v145
    v_mfma_f32_16x16x32_bf16 v[92:95], a[220:223], a[236:239], v[92:95]
    v_max_f32 v149, 0, v149
    v_cvt_pk_bf16_f32 v12, v152, v152
    v_mfma_f32_16x16x32_bf16 v[96:99], a[216:219], a[240:243], v[96:99]
    v_cvt_pk_bf16_f32 v13, v156, v156
    v_and_b32 v12, 0xffff0000, v12
    v_mfma_f32_16x16x32_bf16 v[100:103], a[220:223], a[240:243], v[100:103]
    v_and_b32 v13, 0xffff0000, v13
    v_cvt_pk_bf16_f32 v192, v145, v145
    v_mfma_f32_16x16x32_bf16 v[104:107], a[216:219], a[244:247], v[104:107]
    v_cvt_pk_bf16_f32 v193, v149, v149
    v_and_b32 v192, 0xffff0000, v192
    v_mfma_f32_16x16x32_bf16 v[108:111], a[220:223], a[244:247], v[108:111]
    v_and_b32 v193, 0xffff0000, v193
    v_add_f32 v192, 0x3727c5ac, v192
    s_waitcnt lgkmcnt(6)
    v_mfma_f32_16x16x32_bf16 v[112:115], a[216:219], a[248:251], v[112:115]
    v_add_f32 v193, 0x3727c5ac, v193
    v_cvt_pk_bf16_f32 v192, v192, v192
    v_mfma_f32_16x16x32_bf16 v[116:119], a[220:223], a[248:251], v[116:119]
    v_cvt_pk_bf16_f32 v193, v193, v193
    v_and_b32 v192, 0xffff0000, v192
    s_waitcnt lgkmcnt(4)
    v_mfma_f32_16x16x32_bf16 v[120:123], a[216:219], a[252:255], v[120:123]
    v_and_b32 v193, 0xffff0000, v193
    v_sqrt_f32 v192, v192
    v_mfma_f32_16x16x32_bf16 v[124:127], a[220:223], a[252:255], v[124:127]
    v_sqrt_f32 v193, v193
    v_cvt_pk_bf16_f32 v192, v192, v192
    s_waitcnt lgkmcnt(2)
    v_mfma_f32_16x16x32_bf16 v[128:131], a[216:219], a[224:227], v[128:131]
    v_cvt_pk_bf16_f32 v193, v193, v193
    v_and_b32 v192, 0xffff0000, v192
    v_mfma_f32_16x16x32_bf16 v[132:135], a[220:223], a[224:227], v[132:135]
    v_and_b32 v193, 0xffff0000, v193
    v_rcp_f32 v14, v192
    s_waitcnt lgkmcnt(0)
    v_mfma_f32_16x16x32_bf16 v[136:139], a[216:219], a[228:231], v[136:139]
    v_rcp_f32 v15, v193
    v_mul_f32 v12, v12, v14
    v_mfma_f32_16x16x32_bf16 v[140:143], a[220:223], a[228:231], v[140:143]
    v_mul_f32 v13, v13, v15
    ds_bpermute_b32 v172, v10, v14 offset:0
    ds_bpermute_b32 v48, v10, v12 offset:0
    ds_bpermute_b32 v173, v10, v14 offset:4
    ds_bpermute_b32 v49, v10, v12 offset:4
    ds_bpermute_b32 v174, v10, v14 offset:8
    ds_bpermute_b32 v50, v10, v12 offset:8
    ds_bpermute_b32 v175, v10, v14 offset:12
    ds_bpermute_b32 v51, v10, v12 offset:12
    ds_bpermute_b32 v176, v10, v15 offset:0
    ds_bpermute_b32 v52, v10, v13 offset:0
    ds_bpermute_b32 v177, v10, v15 offset:4
    ds_bpermute_b32 v53, v10, v13 offset:4
    ds_bpermute_b32 v178, v10, v15 offset:8
    ds_bpermute_b32 v54, v10, v13 offset:8
    ds_bpermute_b32 v179, v10, v15 offset:12
    ds_bpermute_b32 v55, v10, v13 offset:12
    s_waitcnt lgkmcnt(0)
    s_barrier
    v_add_u32 v9, 147456, v8
    ds_read_b32 v26, v9 offset:0
    ds_read_b32 v28, v9 offset:64
    ds_read_b32 v30, v9 offset:128
    ds_read_b32 v32, v9 offset:192
    ds_read_b32 v34, v9 offset:256
    ds_read_b32 v36, v9 offset:320
    ds_read_b32 v38, v9 offset:384
    ds_read_b32 v40, v9 offset:448
    ds_read_b32 v42, v9 offset:512
    ds_read_b32 v43, v9 offset:576
    ds_read_b32 v44, v9 offset:640
    ds_read_b32 v45, v9 offset:704
    s_waitcnt vmcnt(0)
    v_cmp_eq_u32 vcc, 0, v57
    s_nop 1
    s_cmp_eq_u64 vcc, 0
    s_cselect_b32 s33, 1, 0
    s_cselect_b32 s5, s5, 67108864
    s_waitcnt lgkmcnt(2)
    v_add_f32 v42, v42, v43
    s_waitcnt lgkmcnt(0)
    v_add_f32 v44, v44, v45
    v_mov_b32 v56, 0x358637bd
    v_mov_b32 v58, 0x3fb8aa3b
    s_mul_i32 s41, s3, 10240
    v_add_u32 v12, s41, v200
    s_lshl_b32 s41, s3, 10
    v_add_u32 v13, s41, v200
    v_pk_fma_f32 v[180:181], v[48:49], v[26:27], v[56:57] op_sel_hi:[1,0,0] neg_lo:[1,0,0] neg_hi:[1,0,0]
    v_pk_fma_f32 v[184:185], v[52:53], v[26:27], v[56:57] op_sel_hi:[1,0,0] neg_lo:[1,0,0] neg_hi:[1,0,0]
    v_pk_fma_f32 v[182:183], v[50:51], v[26:27], v[56:57] op_sel_hi:[1,0,0] neg_lo:[1,0,0] neg_hi:[1,0,0]
    v_pk_fma_f32 v[186:187], v[54:55], v[26:27], v[56:57] op_sel_hi:[1,0,0] neg_lo:[1,0,0] neg_hi:[1,0,0]
    v_pk_fma_f32 v[64:65], v[64:65], v[172:173], v[180:181]
    v_pk_fma_f32 v[68:69], v[68:69], v[176:177], v[184:185]
    v_pk_fma_f32 v[66:67], v[66:67], v[174:175], v[182:183]
    v_pk_fma_f32 v[70:71], v[70:71], v[178:179], v[186:187]
    buffer_load_dwordx4 a[0:3], v200, s[60:63], s5 offen offset:0
    v_pk_mul_f32 v[180:181], v[64:65], v[58:59] op_sel_hi:[1,0]
    v_pk_mul_f32 v[184:185], v[68:69], v[58:59] op_sel_hi:[1,0]
    v_pk_mul_f32 v[182:183], v[66:67], v[58:59] op_sel_hi:[1,0]
    v_pk_mul_f32 v[186:187], v[70:71], v[58:59] op_sel_hi:[1,0]
    v_exp_f32 v180, v180 clamp
    v_exp_f32 v184, v184 clamp
    v_exp_f32 v181, v181 clamp
    v_exp_f32 v185, v185 clamp
    buffer_load_dwordx4 a[4:7], v200, s[60:63], s5 offen offset:1024
    v_exp_f32 v182, v182 clamp
    v_exp_f32 v186, v186 clamp
    v_exp_f32 v183, v183 clamp
    v_exp_f32 v187, v187 clamp
    v_max_f32 v64, v56, v64
    v_max_f32 v68, v56, v68
    v_max_f32 v65, v56, v65
    v_max_f32 v69, v56, v69
    buffer_load_dwordx4 a[8:11], v200, s[60:63], s5 offen offset:2048
    v_max_f32 v66, v56, v66
    v_max_f32 v70, v56, v70
    v_max_f32 v67, v56, v67
    v_max_f32 v71, v56, v71
    v_pk_add_f32 v[64:65], v[64:65], v[180:181]
    v_pk_add_f32 v[68:69], v[68:69], v[184:185]
    v_pk_add_f32 v[66:67], v[66:67], v[182:183]
    v_pk_add_f32 v[70:71], v[70:71], v[186:187]
    buffer_load_dwordx4 a[12:15], v200, s[60:63], s5 offen offset:3072
    v_cvt_pk_bf16_f32 v188, v64, v65
    v_cvt_pk_bf16_f32 v190, v68, v69
    v_cvt_pk_bf16_f32 v189, v66, v67
    v_cvt_pk_bf16_f32 v191, v70, v71
    ds_write_b128 v12, v[188:191] offset:0
    v_pk_fma_f32 v[180:181], v[48:49], v[28:29], v[56:57] op_sel_hi:[1,0,0] neg_lo:[1,0,0] neg_hi:[1,0,0]
    v_pk_fma_f32 v[184:185], v[52:53], v[28:29], v[56:57] op_sel_hi:[1,0,0] neg_lo:[1,0,0] neg_hi:[1,0,0]
    v_pk_fma_f32 v[182:183], v[50:51], v[28:29], v[56:57] op_sel_hi:[1,0,0] neg_lo:[1,0,0] neg_hi:[1,0,0]
    v_pk_fma_f32 v[186:187], v[54:55], v[28:29], v[56:57] op_sel_hi:[1,0,0] neg_lo:[1,0,0] neg_hi:[1,0,0]
    s_add_u32 s5, s5, 4096
    buffer_load_dwordx4 a[16:19], v200, s[60:63], s5 offen offset:0
    v_pk_fma_f32 v[72:73], v[72:73], v[172:173], v[180:181]
    v_pk_fma_f32 v[76:77], v[76:77], v[176:177], v[184:185]
    v_pk_fma_f32 v[74:75], v[74:75], v[174:175], v[182:183]
    v_pk_fma_f32 v[78:79], v[78:79], v[178:179], v[186:187]
    v_pk_mul_f32 v[180:181], v[72:73], v[58:59] op_sel_hi:[1,0]
    v_pk_mul_f32 v[184:185], v[76:77], v[58:59] op_sel_hi:[1,0]
    v_pk_mul_f32 v[182:183], v[74:75], v[58:59] op_sel_hi:[1,0]
    v_pk_mul_f32 v[186:187], v[78:79], v[58:59] op_sel_hi:[1,0]
    buffer_load_dwordx4 a[20:23], v200, s[60:63], s5 offen offset:1024
    v_exp_f32 v180, v180 clamp
    v_exp_f32 v184, v184 clamp
    v_exp_f32 v181, v181 clamp
    v_exp_f32 v185, v185 clamp
    v_exp_f32 v182, v182 clamp
    v_exp_f32 v186, v186 clamp
    v_exp_f32 v183, v183 clamp
    v_exp_f32 v187, v187 clamp
    buffer_load_dwordx4 a[24:27], v200, s[60:63], s5 offen offset:2048
    v_max_f32 v72, v56, v72
    v_max_f32 v76, v56, v76
    v_max_f32 v73, v56, v73
    v_max_f32 v77, v56, v77
    v_max_f32 v74, v56, v74
    v_max_f32 v78, v56, v78
    v_max_f32 v75, v56, v75
    v_max_f32 v79, v56, v79
    buffer_load_dwordx4 a[28:31], v200, s[60:63], s5 offen offset:3072
    v_pk_add_f32 v[72:73], v[72:73], v[180:181]
    v_pk_add_f32 v[76:77], v[76:77], v[184:185]
    v_pk_add_f32 v[74:75], v[74:75], v[182:183]
    v_pk_add_f32 v[78:79], v[78:79], v[186:187]
    v_cvt_pk_bf16_f32 v188, v72, v73
    v_cvt_pk_bf16_f32 v190, v76, v77
    v_cvt_pk_bf16_f32 v189, v74, v75
    v_cvt_pk_bf16_f32 v191, v78, v79
    s_add_u32 s5, s5, 4096
    buffer_load_dwordx4 a[32:35], v200, s[60:63], s5 offen offset:0
    ds_write_b128 v12, v[188:191] offset:1024
    v_pk_fma_f32 v[180:181], v[48:49], v[30:31], v[56:57] op_sel_hi:[1,0,0] neg_lo:[1,0,0] neg_hi:[1,0,0]
    v_pk_fma_f32 v[184:185], v[52:53], v[30:31], v[56:57] op_sel_hi:[1,0,0] neg_lo:[1,0,0] neg_hi:[1,0,0]
    v_pk_fma_f32 v[182:183], v[50:51], v[30:31], v[56:57] op_sel_hi:[1,0,0] neg_lo:[1,0,0] neg_hi:[1,0,0]
    v_pk_fma_f32 v[186:187], v[54:55], v[30:31], v[56:57] op_sel_hi:[1,0,0] neg_lo:[1,0,0] neg_hi:[1,0,0]
    v_pk_fma_f32 v[80:81], v[80:81], v[172:173], v[180:181]
    v_pk_fma_f32 v[84:85], v[84:85], v[176:177], v[184:185]
    v_pk_fma_f32 v[82:83], v[82:83], v[174:175], v[182:183]
    v_pk_fma_f32 v[86:87], v[86:87], v[178:179], v[186:187]
    buffer_load_dwordx4 a[36:39], v200, s[60:63], s5 offen offset:1024
    v_pk_mul_f32 v[180:181], v[80:81], v[58:59] op_sel_hi:[1,0]
    v_pk_mul_f32 v[184:185], v[84:85], v[58:59] op_sel_hi:[1,0]
    v_pk_mul_f32 v[182:183], v[82:83], v[58:59] op_sel_hi:[1,0]
    v_pk_mul_f32 v[186:187], v[86:87], v[58:59] op_sel_hi:[1,0]
    v_exp_f32 v180, v180 clamp
    v_exp_f32 v184, v184 clamp
    v_exp_f32 v181, v181 clamp
    v_exp_f32 v185, v185 clamp
    buffer_load_dwordx4 a[40:43], v200, s[60:63], s5 offen offset:2048
    v_exp_f32 v182, v182 clamp
    v_exp_f32 v186, v186 clamp
    v_exp_f32 v183, v183 clamp
    v_exp_f32 v187, v187 clamp
    v_max_f32 v80, v56, v80
    v_max_f32 v84, v56, v84
    v_max_f32 v81, v56, v81
    v_max_f32 v85, v56, v85
    buffer_load_dwordx4 a[44:47], v200, s[60:63], s5 offen offset:3072
    v_max_f32 v82, v56, v82
    v_max_f32 v86, v56, v86
    v_max_f32 v83, v56, v83
    v_max_f32 v87, v56, v87
    v_pk_add_f32 v[80:81], v[80:81], v[180:181]
    v_pk_add_f32 v[84:85], v[84:85], v[184:185]
    v_pk_add_f32 v[82:83], v[82:83], v[182:183]
    v_pk_add_f32 v[86:87], v[86:87], v[186:187]
    s_add_u32 s5, s5, 4096
    buffer_load_dwordx4 a[48:51], v200, s[60:63], s5 offen offset:0
    v_cvt_pk_bf16_f32 v188, v80, v81
    v_cvt_pk_bf16_f32 v190, v84, v85
    v_cvt_pk_bf16_f32 v189, v82, v83
    v_cvt_pk_bf16_f32 v191, v86, v87
    ds_write_b128 v12, v[188:191] offset:2048
    v_pk_fma_f32 v[180:181], v[48:49], v[32:33], v[56:57] op_sel_hi:[1,0,0] neg_lo:[1,0,0] neg_hi:[1,0,0]
    v_pk_fma_f32 v[184:185], v[52:53], v[32:33], v[56:57] op_sel_hi:[1,0,0] neg_lo:[1,0,0] neg_hi:[1,0,0]
    v_pk_fma_f32 v[182:183], v[50:51], v[32:33], v[56:57] op_sel_hi:[1,0,0] neg_lo:[1,0,0] neg_hi:[1,0,0]
    v_pk_fma_f32 v[186:187], v[54:55], v[32:33], v[56:57] op_sel_hi:[1,0,0] neg_lo:[1,0,0] neg_hi:[1,0,0]
    buffer_load_dwordx4 a[52:55], v200, s[60:63], s5 offen offset:1024
    v_pk_fma_f32 v[88:89], v[88:89], v[172:173], v[180:181]
    v_pk_fma_f32 v[92:93], v[92:93], v[176:177], v[184:185]
    v_pk_fma_f32 v[90:91], v[90:91], v[174:175], v[182:183]
    v_pk_fma_f32 v[94:95], v[94:95], v[178:179], v[186:187]
    v_pk_mul_f32 v[180:181], v[88:89], v[58:59] op_sel_hi:[1,0]
    v_pk_mul_f32 v[184:185], v[92:93], v[58:59] op_sel_hi:[1,0]
    v_pk_mul_f32 v[182:183], v[90:91], v[58:59] op_sel_hi:[1,0]
    v_pk_mul_f32 v[186:187], v[94:95], v[58:59] op_sel_hi:[1,0]
    buffer_load_dwordx4 a[56:59], v200, s[60:63], s5 offen offset:2048
    v_exp_f32 v180, v180 clamp
    v_exp_f32 v184, v184 clamp
    v_exp_f32 v181, v181 clamp
    v_exp_f32 v185, v185 clamp
    v_exp_f32 v182, v182 clamp
    v_exp_f32 v186, v186 clamp
    v_exp_f32 v183, v183 clamp
    v_exp_f32 v187, v187 clamp
    buffer_load_dwordx4 a[60:63], v200, s[60:63], s5 offen offset:3072
    v_max_f32 v88, v56, v88
    v_max_f32 v92, v56, v92
    v_max_f32 v89, v56, v89
    v_max_f32 v93, v56, v93
    v_max_f32 v90, v56, v90
    v_max_f32 v94, v56, v94
    v_max_f32 v91, v56, v91
    v_max_f32 v95, v56, v95
    s_add_u32 s5, s5, 4096
    buffer_load_dwordx4 a[64:67], v200, s[60:63], s5 offen offset:0
    v_pk_add_f32 v[88:89], v[88:89], v[180:181]
    v_pk_add_f32 v[92:93], v[92:93], v[184:185]
    v_pk_add_f32 v[90:91], v[90:91], v[182:183]
    v_pk_add_f32 v[94:95], v[94:95], v[186:187]
    v_cvt_pk_bf16_f32 v188, v88, v89
    v_cvt_pk_bf16_f32 v190, v92, v93
    v_cvt_pk_bf16_f32 v189, v90, v91
    v_cvt_pk_bf16_f32 v191, v94, v95
    buffer_load_dwordx4 a[68:71], v200, s[60:63], s5 offen offset:1024
    ds_write_b128 v12, v[188:191] offset:3072
    v_pk_mul_f32 v[180:181], v[48:49], v[34:35] op_sel_hi:[1,0] neg_lo:[1,0] neg_hi:[1,0]
    v_pk_mul_f32 v[184:185], v[52:53], v[34:35] op_sel_hi:[1,0] neg_lo:[1,0] neg_hi:[1,0]
    v_pk_mul_f32 v[182:183], v[50:51], v[34:35] op_sel_hi:[1,0] neg_lo:[1,0] neg_hi:[1,0]
    v_pk_mul_f32 v[186:187], v[54:55], v[34:35] op_sel_hi:[1,0] neg_lo:[1,0] neg_hi:[1,0]
    v_pk_fma_f32 v[96:97], v[96:97], v[172:173], v[180:181]
    v_pk_fma_f32 v[100:101], v[100:101], v[176:177], v[184:185]
    v_pk_fma_f32 v[98:99], v[98:99], v[174:175], v[182:183]
    v_pk_fma_f32 v[102:103], v[102:103], v[178:179], v[186:187]
    buffer_load_dwordx4 a[72:75], v200, s[60:63], s5 offen offset:2048
    v_cvt_pk_bf16_f32 v188, v96, v97
    v_cvt_pk_bf16_f32 v190, v100, v101
    v_cvt_pk_bf16_f32 v189, v98, v99
    v_cvt_pk_bf16_f32 v191, v102, v103
    ds_write_b128 v12, v[188:191] offset:4096
    v_pk_mul_f32 v[180:181], v[48:49], v[36:37] op_sel_hi:[1,0] neg_lo:[1,0] neg_hi:[1,0]
    v_pk_mul_f32 v[184:185], v[52:53], v[36:37] op_sel_hi:[1,0] neg_lo:[1,0] neg_hi:[1,0]
    v_pk_mul_f32 v[182:183], v[50:51], v[36:37] op_sel_hi:[1,0] neg_lo:[1,0] neg_hi:[1,0]
    v_pk_mul_f32 v[186:187], v[54:55], v[36:37] op_sel_hi:[1,0] neg_lo:[1,0] neg_hi:[1,0]
    buffer_load_dwordx4 a[76:79], v200, s[60:63], s5 offen offset:3072
    v_pk_fma_f32 v[104:105], v[104:105], v[172:173], v[180:181]
    v_pk_fma_f32 v[108:109], v[108:109], v[176:177], v[184:185]
    v_pk_fma_f32 v[106:107], v[106:107], v[174:175], v[182:183]
    v_pk_fma_f32 v[110:111], v[110:111], v[178:179], v[186:187]
    v_cvt_pk_bf16_f32 v188, v104, v105
    v_cvt_pk_bf16_f32 v190, v108, v109
    v_cvt_pk_bf16_f32 v189, v106, v107
    v_cvt_pk_bf16_f32 v191, v110, v111
    s_add_u32 s5, s5, 4096
    buffer_load_dwordx4 a[80:83], v200, s[60:63], s5 offen offset:0
    ds_write_b128 v12, v[188:191] offset:5120
    v_pk_mul_f32 v[180:181], v[48:49], v[38:39] op_sel_hi:[1,0] neg_lo:[1,0] neg_hi:[1,0]
    v_pk_mul_f32 v[184:185], v[52:53], v[38:39] op_sel_hi:[1,0] neg_lo:[1,0] neg_hi:[1,0]
    v_pk_mul_f32 v[182:183], v[50:51], v[38:39] op_sel_hi:[1,0] neg_lo:[1,0] neg_hi:[1,0]
    v_pk_mul_f32 v[186:187], v[54:55], v[38:39] op_sel_hi:[1,0] neg_lo:[1,0] neg_hi:[1,0]
    v_pk_fma_f32 v[112:113], v[112:113], v[172:173], v[180:181]
    v_pk_fma_f32 v[116:117], v[116:117], v[176:177], v[184:185]
    v_pk_fma_f32 v[114:115], v[114:115], v[174:175], v[182:183]
    v_pk_fma_f32 v[118:119], v[118:119], v[178:179], v[186:187]
    buffer_load_dwordx4 a[84:87], v200, s[60:63], s5 offen offset:1024
    v_cvt_pk_bf16_f32 v188, v112, v113
    v_cvt_pk_bf16_f32 v190, v116, v117
    v_cvt_pk_bf16_f32 v189, v114, v115
    v_cvt_pk_bf16_f32 v191, v118, v119
    ds_write_b128 v12, v[188:191] offset:6144
    v_pk_mul_f32 v[180:181], v[48:49], v[40:41] op_sel_hi:[1,0] neg_lo:[1,0] neg_hi:[1,0]
    v_pk_mul_f32 v[184:185], v[52:53], v[40:41] op_sel_hi:[1,0] neg_lo:[1,0] neg_hi:[1,0]
    v_pk_mul_f32 v[182:183], v[50:51], v[40:41] op_sel_hi:[1,0] neg_lo:[1,0] neg_hi:[1,0]
    v_pk_mul_f32 v[186:187], v[54:55], v[40:41] op_sel_hi:[1,0] neg_lo:[1,0] neg_hi:[1,0]
    buffer_load_dwordx4 a[88:91], v200, s[60:63], s5 offen offset:2048
    v_pk_fma_f32 v[120:121], v[120:121], v[172:173], v[180:181]
    v_pk_fma_f32 v[124:125], v[124:125], v[176:177], v[184:185]
    v_pk_fma_f32 v[122:123], v[122:123], v[174:175], v[182:183]
    v_pk_fma_f32 v[126:127], v[126:127], v[178:179], v[186:187]
    v_cvt_pk_bf16_f32 v188, v120, v121
    v_cvt_pk_bf16_f32 v190, v124, v125
    v_cvt_pk_bf16_f32 v189, v122, v123
    v_cvt_pk_bf16_f32 v191, v126, v127
    buffer_load_dwordx4 a[92:95], v200, s[60:63], s5 offen offset:3072
    ds_write_b128 v12, v[188:191] offset:7168
    v_pk_fma_f32 v[180:181], v[48:49], v[42:43], v[56:57] op_sel_hi:[1,0,0] neg_lo:[1,0,0] neg_hi:[1,0,0]
    v_pk_fma_f32 v[184:185], v[52:53], v[42:43], v[56:57] op_sel_hi:[1,0,0] neg_lo:[1,0,0] neg_hi:[1,0,0]
    v_pk_fma_f32 v[182:183], v[50:51], v[42:43], v[56:57] op_sel_hi:[1,0,0] neg_lo:[1,0,0] neg_hi:[1,0,0]
    v_pk_fma_f32 v[186:187], v[54:55], v[42:43], v[56:57] op_sel_hi:[1,0,0] neg_lo:[1,0,0] neg_hi:[1,0,0]
    v_pk_fma_f32 v[128:129], v[128:129], v[172:173], v[180:181]
    v_pk_fma_f32 v[132:133], v[132:133], v[176:177], v[184:185]
    v_pk_fma_f32 v[130:131], v[130:131], v[174:175], v[182:183]
    v_pk_fma_f32 v[134:135], v[134:135], v[178:179], v[186:187]
    s_add_u32 s5, s5, 4096
    buffer_load_dwordx4 a[96:99], v200, s[60:63], s5 offen offset:0
    v_pk_mul_f32 v[180:181], v[128:129], v[58:59] op_sel_hi:[1,0]
    v_pk_mul_f32 v[184:185], v[132:133], v[58:59] op_sel_hi:[1,0]
    v_pk_mul_f32 v[182:183], v[130:131], v[58:59] op_sel_hi:[1,0]
    v_pk_mul_f32 v[186:187], v[134:135], v[58:59] op_sel_hi:[1,0]
    v_exp_f32 v180, v180 clamp
    v_exp_f32 v184, v184 clamp
    v_exp_f32 v181, v181 clamp
    v_exp_f32 v185, v185 clamp
    buffer_load_dwordx4 a[100:103], v200, s[60:63], s5 offen offset:1024
    v_exp_f32 v182, v182 clamp
    v_exp_f32 v186, v186 clamp
    v_exp_f32 v183, v183 clamp
    v_exp_f32 v187, v187 clamp
    v_max_f32 v128, v56, v128
    v_max_f32 v132, v56, v132
    v_max_f32 v129, v56, v129
    v_max_f32 v133, v56, v133
    buffer_load_dwordx4 a[104:107], v200, s[60:63], s5 offen offset:2048
    v_max_f32 v130, v56, v130
    v_max_f32 v134, v56, v134
    v_max_f32 v131, v56, v131
    v_max_f32 v135, v56, v135
    v_pk_add_f32 v[128:129], v[128:129], v[180:181]
    v_pk_add_f32 v[132:133], v[132:133], v[184:185]
    v_pk_add_f32 v[130:131], v[130:131], v[182:183]
    v_pk_add_f32 v[134:135], v[134:135], v[186:187]
    buffer_load_dwordx4 a[108:111], v200, s[60:63], s5 offen offset:3072
    v_cvt_pk_bf16_f32 v188, v128, v129
    v_cvt_pk_bf16_f32 v190, v132, v133
    v_cvt_pk_bf16_f32 v189, v130, v131
    v_cvt_pk_bf16_f32 v191, v134, v135
    ds_write_b128 v12, v[188:191] offset:8192
    v_pk_mul_f32 v[180:181], v[48:49], v[44:45] op_sel_hi:[1,0] neg_lo:[1,0] neg_hi:[1,0]
    v_pk_mul_f32 v[184:185], v[52:53], v[44:45] op_sel_hi:[1,0] neg_lo:[1,0] neg_hi:[1,0]
    v_pk_mul_f32 v[182:183], v[50:51], v[44:45] op_sel_hi:[1,0] neg_lo:[1,0] neg_hi:[1,0]
    v_pk_mul_f32 v[186:187], v[54:55], v[44:45] op_sel_hi:[1,0] neg_lo:[1,0] neg_hi:[1,0]
    s_add_u32 s5, s5, 4096
    buffer_load_dwordx4 a[112:115], v200, s[60:63], s5 offen offset:0
    v_pk_fma_f32 v[136:137], v[136:137], v[172:173], v[180:181]
    v_pk_fma_f32 v[140:141], v[140:141], v[176:177], v[184:185]
    v_pk_fma_f32 v[138:139], v[138:139], v[174:175], v[182:183]
    v_pk_fma_f32 v[142:143], v[142:143], v[178:179], v[186:187]
    v_cvt_pk_bf16_f32 v188, v136, v137
    v_cvt_pk_bf16_f32 v190, v140, v141
    v_cvt_pk_bf16_f32 v189, v138, v139
    v_cvt_pk_bf16_f32 v191, v142, v143
    buffer_load_dwordx4 a[116:119], v200, s[60:63], s5 offen offset:1024
    ds_write_b128 v12, v[188:191] offset:9216
    s_waitcnt lgkmcnt(0)
    s_barrier
    ds_read_b128 a[192:195], v13 offset:0
    ds_read_b128 a[196:199], v13 offset:4096
    ds_read_b128 a[200:203], v200 offset:8192
    ds_read_b128 a[204:207], v200 offset:9216
    ds_read_b128 a[208:211], v13 offset:10240
    ds_read_b128 a[212:215], v13 offset:14336
    ds_read_b128 a[216:219], v200 offset:18432
    ds_read_b128 a[220:223], v200 offset:19456
    ds_read_b128 a[224:227], v13 offset:20480
    ds_read_b128 a[228:231], v13 offset:24576
    ds_read_b128 a[232:235], v200 offset:28672
    ds_read_b128 a[236:239], v200 offset:29696
    ds_read_b128 a[240:243], v13 offset:30720
    ds_read_b128 a[244:247], v13 offset:34816
    ds_read_b128 a[248:251], v200 offset:38912
    ds_read_b128 a[252:255], v200 offset:39936
    v_mul_u32_u24 v9, 336, v3
    s_lshl_b32 s41, s3, 11
    s_add_u32 s41, s41, 40960
    v_add_u32 v9, s41, v9
    v_lshl_add_u32 v10, v2, 4, v9
    v_lshl_add_u32 v14, v5, 4, v9
    v_lshlrev_b32 v15, 4, v2
    v_add_u32 v15, s41, v15
    v_lshlrev_b32 v20, 4, v5
    v_add_u32 v20, s41, v20
    v_lshlrev_b32 v21, 2, v1
    v_add_u32 v22, s41, v21
    s_lshl_b32 s41, s3, 4
    s_mov_b64 s[70:71], 0xffff
    s_lshl_b64 s[70:71], s[70:71], s41
    s_lshl_b32 s41, s3, 2
    s_mov_b32 s72, 0x000f000f
    s_lshl_b32 s72, s72, s41
    s_mov_b32 s73, s72
    s_mov_b32 s74, 0x00010001
    s_mov_b32 s75, 0x00010001
    s_waitcnt lgkmcnt(14)
    v_mfma_f32_16x16x32_bf16 v[64:67], a[192:195], a[196:199], 0
    s_waitcnt lgkmcnt(13)
    v_mfma_f32_16x16x32_bf16 v[68:71], a[200:203], a[196:199], 0
    s_waitcnt lgkmcnt(12)
    v_mfma_f32_16x16x32_bf16 v[72:75], a[192:195], a[204:207], 0
    v_mfma_f32_16x16x32_bf16 v[76:79], a[200:203], a[204:207], 0
    v_mfma_f32_16x16x32_bf16 v[80:83], a[192:195], v[60:63], 0
    v_mfma_f32_16x16x32_bf16 v[84:87], a[200:203], v[60:63], 0
    s_waitcnt lgkmcnt(10)
    v_mfma_f32_16x16x32_bf16 v[64:67], a[208:211], a[212:215], v[64:67]
    s_waitcnt lgkmcnt(9)
    v_mfma_f32_16x16x32_bf16 v[68:71], a[216:219], a[212:215], v[68:71]
    s_waitcnt lgkmcnt(8)
    v_mfma_f32_16x16x32_bf16 v[72:75], a[208:211], a[220:223], v[72:75]
    v_mfma_f32_16x16x32_bf16 v[76:79], a[216:219], a[220:223], v[76:79]
    v_mfma_f32_16x16x32_bf16 v[80:83], a[208:211], v[60:63], v[80:83]
    v_mfma_f32_16x16x32_bf16 v[84:87], a[216:219], v[60:63], v[84:87]
    s_waitcnt lgkmcnt(6)
    v_mfma_f32_16x16x32_bf16 v[64:67], a[224:227], a[228:231], v[64:67]
    s_waitcnt lgkmcnt(5)
    v_mfma_f32_16x16x32_bf16 v[68:71], a[232:235], a[228:231], v[68:71]
    s_waitcnt lgkmcnt(4)
    v_mfma_f32_16x16x32_bf16 v[72:75], a[224:227], a[236:239], v[72:75]
    v_mfma_f32_16x16x32_bf16 v[76:79], a[232:235], a[236:239], v[76:79]
    v_mfma_f32_16x16x32_bf16 v[80:83], a[224:227], v[60:63], v[80:83]
    v_mfma_f32_16x16x32_bf16 v[84:87], a[232:235], v[60:63], v[84:87]
    s_waitcnt lgkmcnt(2)
    v_mfma_f32_16x16x32_bf16 v[64:67], a[240:243], a[244:247], v[64:67]
    s_waitcnt lgkmcnt(1)
    v_mfma_f32_16x16x32_bf16 v[68:71], a[248:251], a[244:247], v[68:71]
    s_waitcnt lgkmcnt(0)
    v_mfma_f32_16x16x32_bf16 v[72:75], a[240:243], a[252:255], v[72:75]
    v_mfma_f32_16x16x32_bf16 v[76:79], a[248:251], a[252:255], v[76:79]
    v_mfma_f32_16x16x32_bf16 v[80:83], a[240:243], v[60:63], v[80:83]
    v_mfma_f32_16x16x32_bf16 v[84:87], a[248:251], v[60:63], v[84:87]
    s_add_u32 s44, s26, 20072448
    s_addc_u32 s45, s27, 0
    s_mov_b32 s46, 98304
    s_mov_b32 s47, 0x20000
    s_lshl_b32 s41, s31, 2
    s_add_u32 s41, s41, s3
    s_lshr_b32 s4, s31, 1
    s_lshl_b32 s4, s4, 7
    s_add_u32 s4, s4, 81920
    s_mul_i32 s41, s41, 1680
    s_add_u32 s41, s41, 7565312
    s_add_u32 s56, s26, s41
    s_addc_u32 s57, s27, 0
    s_mov_b32 s58, 1680
    s_mov_b32 s59, 0x20000
    ds_write_b128 v10, v[64:67]
    s_mov_b64 exec, s[70:71]
    ds_write_b128 v15, v[68:71] offset:1344
    s_mov_b64 exec, s[72:73]
    ds_write_b128 v14, v[72:75] offset:256
    s_and_b64 exec, s[70:71], s[72:73]
    ds_write_b128 v20, v[76:79] offset:1600
    s_mov_b64 exec, s[74:75]
    ds_write_b128 v9, v[80:83] offset:320
    s_and_b64 exec, s[70:71], s[74:75]
    ds_write_b128 v20, v[84:87] offset:1664
    s_mov_b64 exec, -1
    ds_read_b32 v24, v22 offset:0
    ds_read_b32 v25, v22 offset:256
    ds_read_b32 v26, v22 offset:512
    ds_read_b32 v27, v22 offset:768
    ds_read_b32 v28, v22 offset:1024
    ds_read_b32 v29, v22 offset:1280
    ds_read_b32 v30, v22 offset:1536
    s_waitcnt lgkmcnt(6)
    buffer_atomic_add_f32 v24, v21, s[56:59], 0 offen offset:0
    s_waitcnt lgkmcnt(5)
    buffer_atomic_add_f32 v25, v21, s[56:59], 0 offen offset:256
    s_waitcnt lgkmcnt(4)
    buffer_atomic_add_f32 v26, v21, s[56:59], 0 offen offset:512
    s_waitcnt lgkmcnt(3)
    buffer_atomic_add_f32 v27, v21, s[56:59], 0 offen offset:768
    s_waitcnt lgkmcnt(2)
    buffer_atomic_add_f32 v28, v21, s[56:59], 0 offen offset:1024
    s_waitcnt lgkmcnt(1)
    buffer_atomic_add_f32 v29, v21, s[56:59], 0 offen offset:1280
    s_waitcnt lgkmcnt(0)
    buffer_atomic_add_f32 v30, v21, s[56:59], 0 offen offset:1536
    buffer_load_dwordx4 a[120:123], v200, s[60:63], s5 offen offset:2048
    buffer_load_dwordx4 a[124:127], v200, s[60:63], s5 offen offset:3072
    s_add_u32 s5, s5, 4096
    buffer_load_dwordx4 a[128:131], v200, s[60:63], s5 offen offset:0
    buffer_load_dwordx4 a[132:135], v200, s[60:63], s5 offen offset:1024
    s_waitcnt vmcnt(4)
    s_barrier
    s_cmp_eq_u32 s3, 0
    s_cbranch_scc0 km_ka
    v_mov_b32 v17, 1
    s_mov_b64 exec, 1
    buffer_atomic_add v17, v16, s[44:47], s4 offen sc0
    s_mov_b64 exec, -1
    s_waitcnt vmcnt(0)
    v_readfirstlane_b32 s42, v17
    s_add_u32 s4, s4, 512
    s_nop 0
    s_cmp_eq_u32 s42, 31
    s_cbranch_scc0 km_ka
    v_mov_b32 v17, 1
    s_mov_b64 exec, 1
    buffer_store_dword v17, v16, s[44:47], s4 offen sc1
    s_mov_b64 exec, -1
km_ka:
    buffer_load_dwordx4 a[136:139], v200, s[60:63], s5 offen offset:2048
    buffer_load_dwordx4 a[140:143], v200, s[60:63], s5 offen offset:3072
    s_add_u32 s5, s5, 4096
    buffer_load_dwordx4 a[144:147], v200, s[60:63], s5 offen offset:0
    buffer_load_dwordx4 a[148:151], v200, s[60:63], s5 offen offset:1024
    buffer_load_dwordx4 a[152:155], v200, s[60:63], s5 offen offset:2048
    buffer_load_dwordx4 a[156:159], v200, s[60:63], s5 offen offset:3072
    s_add_u32 s5, s5, 4096
    buffer_load_dwordx4 a[160:163], v200, s[60:63], s5 offen offset:0
    buffer_load_dwordx4 a[164:167], v200, s[60:63], s5 offen offset:1024
    buffer_load_dwordx4 a[168:171], v200, s[60:63], s5 offen offset:2048
    buffer_load_dwordx4 a[172:175], v200, s[60:63], s5 offen offset:3072
    s_add_u32 s5, s5, 4096
    buffer_load_dwordx4 a[176:179], v200, s[60:63], s5 offen offset:0
    buffer_load_dwordx4 a[180:183], v200, s[60:63], s5 offen offset:1024
    buffer_load_dwordx4 a[184:187], v200, s[60:63], s5 offen offset:2048
    buffer_load_dwordx4 a[188:191], v200, s[60:63], s5 offen offset:3072
    s_mov_b32 s39, 0
    s_cmp_eq_u32 s33, 0
    s_cbranch_scc1 km_wo
    s_branch km_A
km_q:
    v_add_u32 v8, 0, v3
    v_lshlrev_b32 v8, 1, v8
    v_xor_b32 v8, v8, v2
    v_add_u32 v9, 0, v3
    v_mul_u32_u24 v9, 3840, v9
    v_lshl_add_u32 v20, v8, 4, v9
    v_add_u32 v8, 4, v3
    v_lshlrev_b32 v8, 1, v8
    v_xor_b32 v8, v8, v2
    v_add_u32 v9, 8, v3
    v_mul_u32_u24 v9, 3840, v9
    v_lshl_add_u32 v21, v8, 4, v9
    v_add_u32 v8, 0, v3
    v_lshlrev_b32 v8, 1, v8
    v_xor_b32 v8, v8, v2
    v_add_u32 v9, 4, v3
    v_mul_u32_u24 v9, 3840, v9
    v_lshl_add_u32 v22, v8, 4, v9
    v_add_u32 v8, 4, v3
    v_lshlrev_b32 v8, 1, v8
    v_xor_b32 v8, v8, v2
    v_add_u32 v9, 12, v3
    v_mul_u32_u24 v9, 3840, v9
    v_lshl_add_u32 v23, v8, 4, v9
    s_sub_u32 s31, s31, 8
    s_add_u32 s43, s43, 16384
    s_mul_i32 s37, s3, 61440
    s_lshl_b32 s41, s31, 8
    s_add_u32 s37, s37, s41
    s_lshl_b32 s35, s3, 12
    s_waitcnt lgkmcnt(0)
    s_mov_b32 s44, s8
    s_mov_b32 s45, s9
    s_mov_b32 s46, 2621440
    s_mov_b32 s47, 0x20000
    s_mov_b32 s48, s10
    s_mov_b32 s49, s11
    s_mov_b32 s50, 2457600
    s_mov_b32 s51, 0x20000
    s_lshl_b32 s39, s38, 7
    s_add_u32 s39, s39, s36
    s_mul_i32 s40, s38, 245760
    s_add_u32 s40, s40, s37
    s_add_u32 s38, s38, 1
    s_cmp_eq_u32 s38, 10
    s_cselect_b32 s38, 0, s38
    s_add_u32 m0, s43, 0
    s_add_u32 s41, s39, 0
    buffer_load_dwordx4 v18, s[44:47], s41 offen lds
    s_add_u32 m0, s43, 1024
    s_add_u32 s41, s39, 10240
    buffer_load_dwordx4 v18, s[44:47], s41 offen lds
    s_add_u32 m0, s43, 2048
    s_add_u32 s41, s39, 20480
    buffer_load_dwordx4 v18, s[44:47], s41 offen lds
    s_add_u32 m0, s43, 3072
    s_add_u32 s41, s39, 30720
    buffer_load_dwordx4 v18, s[44:47], s41 offen lds
    s_add_u32 m0, s35, 0
    s_nop 0
    buffer_load_dwordx4 v20, s[48:51], s40 offen lds
    s_add_u32 m0, s35, 1024
    s_nop 0
    buffer_load_dwordx4 v21, s[48:51], s40 offen lds
    s_add_u32 m0, s35, 2048
    s_nop 0
    buffer_load_dwordx4 v22, s[48:51], s40 offen lds
    s_add_u32 m0, s35, 3072
    s_nop 0
    buffer_load_dwordx4 v23, s[48:51], s40 offen lds
    s_lshl_b32 s39, s38, 7
    s_add_u32 s39, s39, s36
    s_mul_i32 s40, s38, 245760
    s_add_u32 s40, s40, s37
    s_add_u32 s38, s38, 1
    s_cmp_eq_u32 s38, 10
    s_cselect_b32 s38, 0, s38
    s_add_u32 m0, s43, 32768
    s_add_u32 s41, s39, 0
    buffer_load_dwordx4 v18, s[44:47], s41 offen lds
    s_add_u32 m0, s43, 33792
    s_add_u32 s41, s39, 10240
    buffer_load_dwordx4 v18, s[44:47], s41 offen lds
    s_add_u32 m0, s43, 34816
    s_add_u32 s41, s39, 20480
    buffer_load_dwordx4 v18, s[44:47], s41 offen lds
    s_add_u32 m0, s43, 35840
    s_add_u32 s41, s39, 30720
    buffer_load_dwordx4 v18, s[44:47], s41 offen lds
    s_add_u32 m0, s35, 32768
    s_nop 0
    buffer_load_dwordx4 v20, s[48:51], s40 offen lds
    s_add_u32 m0, s35, 33792
    s_nop 0
    buffer_load_dwordx4 v21, s[48:51], s40 offen lds
    s_add_u32 m0, s35, 34816
    s_nop 0
    buffer_load_dwordx4 v22, s[48:51], s40 offen lds
    s_add_u32 m0, s35, 35840
    s_nop 0
    buffer_load_dwordx4 v23, s[48:51], s40 offen lds
    v_bfe_u32 v4, v1, 2, 2
    v_and_b32 v5, 3, v1
    v_lshrrev_b32 v6, 1, v3
    v_lshlrev_b32 v6, 4, v6
    v_and_b32 v7, 1, v3
    v_lshl_add_u32 v6, v7, 2, v6
    v_add_u32 v6, v6, v4
    v_mov_b32 v60, 0x3f803f80
    v_mov_b32 v61, 0x3f803f80
    v_mov_b32 v62, 0x3f803f80
    v_mov_b32 v63, 0x3f803f80
    v_cmp_eq_u32 s[64:65], 1, v5
    v_cmp_eq_u32 s[66:67], 2, v5
    v_cmp_eq_u32 s[68:69], 3, v5
    v_lshl_add_u32 v17, v4, 4, v2
    v_lshlrev_b32 v17, 2, v17
    v_and_b32 v8, 7, v2
    v_xor_b32 v8, v8, v3
    v_lshlrev_b32 v9, 7, v2
    v_add_u32 v9, s43, v9
    v_lshl_add_u32 v25, v8, 4, v9
    v_xor_b32 v8, 4, v8
    v_lshl_add_u32 v19, v8, 4, v9
    v_mov_b32 v16, 0
    v_lshlrev_b32 v200, 4, v1
    s_mov_b32 s52, s24
    s_mov_b32 s53, s25
    s_mov_b32 s54, 256
    s_mov_b32 s55, 0x20000
    s_add_u32 s60, s26, 6746112
    s_addc_u32 s61, s27, 0
    s_mov_b32 s62, 819200
    s_mov_b32 s63, 0x20000
    s_lshr_b32 s5, s2, 6
    s_lshl_b32 s5, s5, 2
    s_add_u32 s5, s5, s3
    s_mul_i32 s5, s5, 51200
    s_add_u32 s72, s26, 20072448
    s_addc_u32 s73, s27, 0
    s_mov_b32 s74, 98304
    s_mov_b32 s75, 0x20000
    s_mov_b32 s70, 77824
    v_min_u32 v201, 19, v1
    v_lshlrev_b32 v201, 2, v201
    v_and_b32 v7, 7, v6
    v_lshlrev_b32 v7, 1, v7
    v_lshlrev_b32 v6, 8, v6
    v_and_b32 v8, 1, v5
    v_lshl_add_u32 v6, v8, 3, v6
    v_lshrrev_b32 v8, 1, v5
    v_lshl_add_u32 v6, v8, 4, v6
    v_xor_b32 v9, 0, v7
    v_lshl_add_u32 v26, v9, 4, v6
    v_xor_b32 v9, 2, v7
    v_lshl_add_u32 v27, v9, 4, v6
    v_xor_b32 v9, 4, v7
    v_lshl_add_u32 v28, v9, 4, v6
    v_xor_b32 v9, 6, v7
    v_lshl_add_u32 v29, v9, 4, v6
    v_xor_b32 v9, 8, v7
    v_lshl_add_u32 v30, v9, 4, v6
    v_xor_b32 v9, 10, v7
    v_lshl_add_u32 v31, v9, 4, v6
    v_xor_b32 v9, 12, v7
    v_lshl_add_u32 v32, v9, 4, v6
    v_xor_b32 v9, 14, v7
    v_lshl_add_u32 v33, v9, 4, v6
    s_lshl_b32 s4, s3, 1
    v_xor_b32 v9, s4, v7
    v_lshl_add_u32 v34, v9, 4, v6
    s_add_u32 s4, s4, 8
    v_xor_b32 v9, s4, v7
    v_lshl_add_u32 v35, v9, 4, v6
    s_lshl_b32 s42, s31, 5
    v_add_u32 v176, 0, v3
    v_add_u32 v176, s42, v176
    v_mul_u32_u24 v177, 52429, v176
    v_lshrrev_b32 v177, 18, v177
    v_mul_u32_u24 v178, 5, v177
    v_sub_u32 v176, v176, v178
    v_mul_u32_u24 v177, 1280, v177
    v_lshrrev_b32 v178, 1, v176
    v_lshl_add_u32 v177, v178, 9, v177
    v_and_b32 v178, 1, v176
    v_lshl_add_u32 v177, v178, 3, v177
    v_lshrrev_b32 v178, 2, v176
    v_sub_u32 v178, 4, v178
    v_lshlrev_b32 v179, v178, v2
    v_add_u32 v160, v177, v179
    v_lshlrev_b32 v179, v178, 16
    v_add_u32 v161, v160, v179
    v_add_u32 v176, 4, v3
    v_add_u32 v176, s42, v176
    v_mul_u32_u24 v177, 52429, v176
    v_lshrrev_b32 v177, 18, v177
    v_mul_u32_u24 v178, 5, v177
    v_sub_u32 v176, v176, v178
    v_mul_u32_u24 v177, 1280, v177
    v_lshrrev_b32 v178, 1, v176
    v_lshl_add_u32 v177, v178, 9, v177
    v_and_b32 v178, 1, v176
    v_lshl_add_u32 v177, v178, 3, v177
    v_lshrrev_b32 v178, 2, v176
    v_sub_u32 v178, 4, v178
    v_lshlrev_b32 v179, v178, v2
    v_add_u32 v162, v177, v179
    v_lshlrev_b32 v179, v178, 16
    v_add_u32 v163, v162, v179
    v_add_u32 v176, 8, v3
    v_add_u32 v176, s42, v176
    v_mul_u32_u24 v177, 52429, v176
    v_lshrrev_b32 v177, 18, v177
    v_mul_u32_u24 v178, 5, v177
    v_sub_u32 v176, v176, v178
    v_mul_u32_u24 v177, 1280, v177
    v_lshrrev_b32 v178, 1, v176
    v_lshl_add_u32 v177, v178, 9, v177
    v_and_b32 v178, 1, v176
    v_lshl_add_u32 v177, v178, 3, v177
    v_lshrrev_b32 v178, 2, v176
    v_sub_u32 v178, 4, v178
    v_lshlrev_b32 v179, v178, v2
    v_add_u32 v164, v177, v179
    v_lshlrev_b32 v179, v178, 16
    v_add_u32 v165, v164, v179
    v_add_u32 v176, 12, v3
    v_add_u32 v176, s42, v176
    v_mul_u32_u24 v177, 52429, v176
    v_lshrrev_b32 v177, 18, v177
    v_mul_u32_u24 v178, 5, v177
    v_sub_u32 v176, v176, v178
    v_mul_u32_u24 v177, 1280, v177
    v_lshrrev_b32 v178, 1, v176
    v_lshl_add_u32 v177, v178, 9, v177
    v_and_b32 v178, 1, v176
    v_lshl_add_u32 v177, v178, 3, v177
    v_lshrrev_b32 v178, 2, v176
    v_sub_u32 v178, 4, v178
    v_lshlrev_b32 v179, v178, v2
    v_add_u32 v166, v177, v179
    v_lshlrev_b32 v179, v178, 16
    v_add_u32 v167, v166, v179
    v_add_u32 v176, 16, v3
    v_add_u32 v176, s42, v176
    v_mul_u32_u24 v177, 52429, v176
    v_lshrrev_b32 v177, 18, v177
    v_mul_u32_u24 v178, 5, v177
    v_sub_u32 v176, v176, v178
    v_mul_u32_u24 v177, 1280, v177
    v_lshrrev_b32 v178, 1, v176
    v_lshl_add_u32 v177, v178, 9, v177
    v_and_b32 v178, 1, v176
    v_lshl_add_u32 v177, v178, 3, v177
    v_lshrrev_b32 v178, 2, v176
    v_sub_u32 v178, 4, v178
    v_lshlrev_b32 v179, v178, v2
    v_add_u32 v168, v177, v179
    v_lshlrev_b32 v179, v178, 16
    v_add_u32 v169, v168, v179
    v_add_u32 v176, 20, v3
    v_add_u32 v176, s42, v176
    v_mul_u32_u24 v177, 52429, v176
    v_lshrrev_b32 v177, 18, v177
    v_mul_u32_u24 v178, 5, v177
    v_sub_u32 v176, v176, v178
    v_mul_u32_u24 v177, 1280, v177
    v_lshrrev_b32 v178, 1, v176
    v_lshl_add_u32 v177, v178, 9, v177
    v_and_b32 v178, 1, v176
    v_lshl_add_u32 v177, v178, 3, v177
    v_lshrrev_b32 v178, 2, v176
    v_sub_u32 v178, 4, v178
    v_lshlrev_b32 v179, v178, v2
    v_add_u32 v170, v177, v179
    v_lshlrev_b32 v179, v178, 16
    v_add_u32 v171, v170, v179
    v_add_u32 v176, 24, v3
    v_add_u32 v176, s42, v176
    v_mul_u32_u24 v177, 52429, v176
    v_lshrrev_b32 v177, 18, v177
    v_mul_u32_u24 v178, 5, v177
    v_sub_u32 v176, v176, v178
    v_mul_u32_u24 v177, 1280, v177
    v_lshrrev_b32 v178, 1, v176
    v_lshl_add_u32 v177, v178, 9, v177
    v_and_b32 v178, 1, v176
    v_lshl_add_u32 v177, v178, 3, v177
    v_lshrrev_b32 v178, 2, v176
    v_sub_u32 v178, 4, v178
    v_lshlrev_b32 v179, v178, v2
    v_add_u32 v172, v177, v179
    v_lshlrev_b32 v179, v178, 16
    v_add_u32 v173, v172, v179
    v_add_u32 v176, 28, v3
    v_add_u32 v176, s42, v176
    v_mul_u32_u24 v177, 52429, v176
    v_lshrrev_b32 v177, 18, v177
    v_mul_u32_u24 v178, 5, v177
    v_sub_u32 v176, v176, v178
    v_mul_u32_u24 v177, 1280, v177
    v_lshrrev_b32 v178, 1, v176
    v_lshl_add_u32 v177, v178, 9, v177
    v_and_b32 v178, 1, v176
    v_lshl_add_u32 v177, v178, 3, v177
    v_lshrrev_b32 v178, 2, v176
    v_sub_u32 v178, 4, v178
    v_lshlrev_b32 v179, v178, v2
    v_add_u32 v174, v177, v179
    v_lshlrev_b32 v179, v178, 16
    v_add_u32 v175, v174, v179
    v_lshlrev_b32 v8, 4, v3
    v_add_u32 v8, 131072, v8
    s_lshl_b32 s4, s3, 6
    v_add_u32 v9, s4, v8
    s_add_u32 s56, s26, 7751680
    s_addc_u32 s57, s27, 0
    s_mov_b32 s58, 2621440
    s_mov_b32 s59, 0x20000
    v_add_u32 v36, 65536, v26
    v_add_u32 v37, 65536, v27
    v_add_u32 v38, 65536, v28
    v_add_u32 v39, 65536, v29
    v_add_u32 v40, 65536, v30
    v_add_u32 v41, 65536, v31
    v_add_u32 v42, 65536, v32
    v_add_u32 v43, 65536, v33
    v_add_u32 v44, 65536, v34
    v_add_u32 v45, 65536, v35
    v_add_u32 v46, 65536, v25
    v_add_u32 v47, 65536, v19
    s_waitcnt vmcnt(8)
    s_waitcnt lgkmcnt(0)
    s_barrier
    ds_read_b128 a[192:195], v25 offset:0
    ds_read_b128 a[196:199], v25 offset:2048
    ds_read_b128 a[200:203], v19 offset:0
    ds_read_b128 a[204:207], v19 offset:2048
    ds_read_b64_tr_b16 a[224:225], v26 offset:0
    ds_read_b64_tr_b16 a[226:227], v26 offset:2048
    ds_read_b64_tr_b16 a[228:229], v27 offset:0
    ds_read_b64_tr_b16 a[230:231], v27 offset:2048
    ds_read_b64_tr_b16 a[232:233], v28 offset:0
    ds_read_b64_tr_b16 a[234:235], v28 offset:2048
    ds_read_b64_tr_b16 a[236:237], v34 offset:0
    ds_read_b64_tr_b16 a[238:239], v34 offset:2048
    ds_read_b64_tr_b16 a[240:241], v29 offset:0
    ds_read_b64_tr_b16 a[242:243], v29 offset:2048
    ds_read_b64_tr_b16 a[244:245], v30 offset:0
    ds_read_b64_tr_b16 a[246:247], v30 offset:2048
    ds_read_b64_tr_b16 a[248:249], v31 offset:0
    ds_read_b64_tr_b16 a[250:251], v31 offset:2048
    s_waitcnt lgkmcnt(12)
    v_mfma_f32_16x16x32_bf16 v[64:67], a[224:227], a[192:195], 0
    ds_read_b64_tr_b16 a[252:253], v35 offset:0
    s_lshl_b32 s39, s38, 7
    v_mfma_f32_16x16x32_bf16 v[68:71], a[224:227], a[196:199], 0
    ds_read_b64_tr_b16 a[254:255], v35 offset:2048
    s_add_u32 s39, s39, s36
    s_waitcnt lgkmcnt(12)
    v_mfma_f32_16x16x32_bf16 v[72:75], a[228:231], a[192:195], 0
    ds_read_b64_tr_b16 a[224:225], v32 offset:0
    s_mul_i32 s40, s38, 245760
    v_mfma_f32_16x16x32_bf16 v[76:79], a[228:231], a[196:199], 0
    ds_read_b64_tr_b16 a[226:227], v32 offset:2048
    s_waitcnt lgkmcnt(10)
    v_mfma_f32_16x16x32_bf16 v[80:83], a[232:235], a[192:195], 0
    ds_read_b64_tr_b16 a[228:229], v33 offset:0
    s_add_u32 s40, s40, s37
    v_mfma_f32_16x16x32_bf16 v[84:87], a[232:235], a[196:199], 0
    ds_read_b64_tr_b16 a[230:231], v33 offset:2048
    s_add_u32 s38, s38, 1
    v_mfma_f32_16x16x32_bf16 v[144:147], a[236:239], v[60:63], 0
    ds_read_b64_tr_b16 a[232:233], v26 offset:8192
    s_cmp_eq_u32 s38, 10
    v_mfma_f32_16x16x32_bf16 v[128:131], a[192:195], a[192:195], 0
    ds_read_b64_tr_b16 a[234:235], v26 offset:10240
    s_waitcnt lgkmcnt(10)
    v_mfma_f32_16x16x32_bf16 v[88:91], a[240:243], a[192:195], 0
    ds_read_b64_tr_b16 a[236:237], v27 offset:8192
    s_cselect_b32 s38, 0, s38
    v_mfma_f32_16x16x32_bf16 v[92:95], a[240:243], a[196:199], 0
    ds_read_b64_tr_b16 a[238:239], v27 offset:10240
    s_add_u32 m0, s43, 65536
    v_mfma_f32_16x16x32_bf16 v[96:99], a[244:247], a[192:195], 0
    ds_read_b64_tr_b16 a[240:241], v28 offset:8192
    s_add_u32 s41, s39, 0
    v_mfma_f32_16x16x32_bf16 v[100:103], a[244:247], a[196:199], 0
    ds_read_b64_tr_b16 a[242:243], v28 offset:10240
    buffer_load_dwordx4 v18, s[44:47], s41 offen lds
    v_mfma_f32_16x16x32_bf16 v[136:139], v[60:63], a[192:195], 0
    s_waitcnt lgkmcnt(10)
    s_add_u32 m0, s43, 66560
    v_mfma_f32_16x16x32_bf16 v[104:107], a[248:251], a[192:195], 0
    ds_read_b64_tr_b16 a[244:245], v34 offset:8192
    s_add_u32 s41, s39, 10240
    v_mfma_f32_16x16x32_bf16 v[108:111], a[248:251], a[196:199], 0
    ds_read_b64_tr_b16 a[246:247], v34 offset:10240
    v_mfma_f32_16x16x32_bf16 v[148:151], a[252:255], v[60:63], 0
    ds_read_b64_tr_b16 a[248:249], v29 offset:8192
    buffer_load_dwordx4 v18, s[44:47], s41 offen lds
    v_mfma_f32_16x16x32_bf16 v[132:135], a[196:199], a[196:199], 0
    ds_read_b64_tr_b16 a[250:251], v29 offset:10240
    s_waitcnt lgkmcnt(10)
    v_mfma_f32_16x16x32_bf16 v[112:115], a[224:227], a[192:195], 0
    ds_read_b64_tr_b16 a[252:253], v30 offset:8192
    s_add_u32 m0, s43, 67584
    v_mfma_f32_16x16x32_bf16 v[116:119], a[224:227], a[196:199], 0
    ds_read_b64_tr_b16 a[254:255], v30 offset:10240
    s_add_u32 s41, s39, 20480
    v_mfma_f32_16x16x32_bf16 v[120:123], a[228:231], a[192:195], 0
    ds_read_b64_tr_b16 a[224:225], v31 offset:8192
    buffer_load_dwordx4 v18, s[44:47], s41 offen lds
    v_mfma_f32_16x16x32_bf16 v[124:127], a[228:231], a[196:199], 0
    ds_read_b64_tr_b16 a[226:227], v31 offset:10240
    s_add_u32 m0, s43, 68608
    v_mfma_f32_16x16x32_bf16 v[140:143], v[60:63], a[196:199], 0
    s_waitcnt lgkmcnt(10)
    s_add_u32 s41, s39, 30720
    v_mfma_f32_16x16x32_bf16 v[64:67], a[232:235], a[200:203], v[64:67]
    ds_read_b64_tr_b16 a[228:229], v35 offset:8192
    v_mfma_f32_16x16x32_bf16 v[68:71], a[232:235], a[204:207], v[68:71]
    ds_read_b64_tr_b16 a[230:231], v35 offset:10240
    buffer_load_dwordx4 v18, s[44:47], s41 offen lds
    v_mfma_f32_16x16x32_bf16 v[72:75], a[236:239], a[200:203], v[72:75]
    ds_read_b64_tr_b16 a[232:233], v32 offset:8192
    s_add_u32 m0, s35, 65536
    v_mfma_f32_16x16x32_bf16 v[76:79], a[236:239], a[204:207], v[76:79]
    ds_read_b64_tr_b16 a[234:235], v32 offset:10240
    s_waitcnt lgkmcnt(10)
    v_mfma_f32_16x16x32_bf16 v[80:83], a[240:243], a[200:203], v[80:83]
    ds_read_b64_tr_b16 a[236:237], v33 offset:8192
    v_mfma_f32_16x16x32_bf16 v[84:87], a[240:243], a[204:207], v[84:87]
    ds_read_b64_tr_b16 a[238:239], v33 offset:10240
    buffer_load_dwordx4 v20, s[48:51], s40 offen lds
    s_waitcnt vmcnt(5)
    s_waitcnt lgkmcnt(0)
    s_barrier
    ds_read_b128 a[208:211], v25 offset:32768
    ds_read_b128 a[212:215], v25 offset:34816
    ds_read_b128 a[216:219], v19 offset:32768
    ds_read_b128 a[220:223], v19 offset:34816
    v_mfma_f32_16x16x32_bf16 v[144:147], a[244:247], v[60:63], v[144:147]
    ds_read_b64_tr_b16 a[240:241], v26 offset:32768
    s_add_u32 m0, s35, 66560
    v_mfma_f32_16x16x32_bf16 v[128:131], a[200:203], a[200:203], v[128:131]
    ds_read_b64_tr_b16 a[242:243], v26 offset:34816
    s_waitcnt lgkmcnt(10)
    v_mfma_f32_16x16x32_bf16 v[88:91], a[248:251], a[200:203], v[88:91]
    ds_read_b64_tr_b16 a[244:245], v27 offset:32768
    v_mfma_f32_16x16x32_bf16 v[92:95], a[248:251], a[204:207], v[92:95]
    ds_read_b64_tr_b16 a[246:247], v27 offset:34816
    buffer_load_dwordx4 v21, s[48:51], s40 offen lds
    v_mfma_f32_16x16x32_bf16 v[96:99], a[252:255], a[200:203], v[96:99]
    ds_read_b64_tr_b16 a[248:249], v28 offset:32768
    s_add_u32 m0, s35, 67584
    v_mfma_f32_16x16x32_bf16 v[100:103], a[252:255], a[204:207], v[100:103]
    ds_read_b64_tr_b16 a[250:251], v28 offset:34816
    v_mfma_f32_16x16x32_bf16 v[136:139], v[60:63], a[200:203], v[136:139]
    s_waitcnt lgkmcnt(10)
    v_mfma_f32_16x16x32_bf16 v[104:107], a[224:227], a[200:203], v[104:107]
    ds_read_b64_tr_b16 a[252:253], v34 offset:32768
    buffer_load_dwordx4 v22, s[48:51], s40 offen lds
    v_mfma_f32_16x16x32_bf16 v[108:111], a[224:227], a[204:207], v[108:111]
    ds_read_b64_tr_b16 a[254:255], v34 offset:34816
    s_add_u32 m0, s35, 68608
    v_mfma_f32_16x16x32_bf16 v[148:151], a[228:231], v[60:63], v[148:151]
    ds_read_b64_tr_b16 a[224:225], v29 offset:32768
    v_mfma_f32_16x16x32_bf16 v[132:135], a[204:207], a[204:207], v[132:135]
    ds_read_b64_tr_b16 a[226:227], v29 offset:34816
    s_waitcnt lgkmcnt(10)
    v_mfma_f32_16x16x32_bf16 v[112:115], a[232:235], a[200:203], v[112:115]
    ds_read_b64_tr_b16 a[228:229], v30 offset:32768
    buffer_load_dwordx4 v23, s[48:51], s40 offen lds
    v_mfma_f32_16x16x32_bf16 v[116:119], a[232:235], a[204:207], v[116:119]
    ds_read_b64_tr_b16 a[230:231], v30 offset:34816
    s_lshl_b32 s39, s38, 7
    v_mfma_f32_16x16x32_bf16 v[120:123], a[236:239], a[200:203], v[120:123]
    ds_read_b64_tr_b16 a[232:233], v31 offset:32768
    s_add_u32 s39, s39, s36
    v_mfma_f32_16x16x32_bf16 v[124:127], a[236:239], a[204:207], v[124:127]
    ds_read_b64_tr_b16 a[234:235], v31 offset:34816
    s_mul_i32 s40, s38, 245760
    v_mfma_f32_16x16x32_bf16 v[140:143], v[60:63], a[204:207], v[140:143]
    s_waitcnt lgkmcnt(10)
    s_add_u32 s40, s40, s37
    v_mfma_f32_16x16x32_bf16 v[64:67], a[240:243], a[208:211], v[64:67]
    ds_read_b64_tr_b16 a[236:237], v35 offset:32768
    s_add_u32 s38, s38, 1
    v_mfma_f32_16x16x32_bf16 v[68:71], a[240:243], a[212:215], v[68:71]
    ds_read_b64_tr_b16 a[238:239], v35 offset:34816
    s_cmp_eq_u32 s38, 10
    v_mfma_f32_16x16x32_bf16 v[72:75], a[244:247], a[208:211], v[72:75]
    ds_read_b64_tr_b16 a[240:241], v32 offset:32768
    s_cselect_b32 s38, 0, s38
    v_mfma_f32_16x16x32_bf16 v[76:79], a[244:247], a[212:215], v[76:79]
    ds_read_b64_tr_b16 a[242:243], v32 offset:34816
    s_waitcnt lgkmcnt(10)
    v_mfma_f32_16x16x32_bf16 v[80:83], a[248:251], a[208:211], v[80:83]
    ds_read_b64_tr_b16 a[244:245], v33 offset:32768
    s_add_u32 m0, s43, 98304
    v_mfma_f32_16x16x32_bf16 v[84:87], a[248:251], a[212:215], v[84:87]
    ds_read_b64_tr_b16 a[246:247], v33 offset:34816
    s_add_u32 s41, s39, 0
    v_mfma_f32_16x16x32_bf16 v[144:147], a[252:255], v[60:63], v[144:147]
    ds_read_b64_tr_b16 a[248:249], v26 offset:40960
    buffer_load_dwordx4 v18, s[44:47], s41 offen lds
    v_mfma_f32_16x16x32_bf16 v[128:131], a[208:211], a[208:211], v[128:131]
    ds_read_b64_tr_b16 a[250:251], v26 offset:43008
    s_waitcnt lgkmcnt(10)
    v_mfma_f32_16x16x32_bf16 v[88:91], a[224:227], a[208:211], v[88:91]
    ds_read_b64_tr_b16 a[252:253], v27 offset:40960
    s_add_u32 m0, s43, 99328
    v_mfma_f32_16x16x32_bf16 v[92:95], a[224:227], a[212:215], v[92:95]
    ds_read_b64_tr_b16 a[254:255], v27 offset:43008
    s_add_u32 s41, s39, 10240
    v_mfma_f32_16x16x32_bf16 v[96:99], a[228:231], a[208:211], v[96:99]
    ds_read_b64_tr_b16 a[224:225], v28 offset:40960
    buffer_load_dwordx4 v18, s[44:47], s41 offen lds
    v_mfma_f32_16x16x32_bf16 v[100:103], a[228:231], a[212:215], v[100:103]
    ds_read_b64_tr_b16 a[226:227], v28 offset:43008
    s_add_u32 m0, s43, 100352
    v_mfma_f32_16x16x32_bf16 v[136:139], v[60:63], a[208:211], v[136:139]
    s_waitcnt lgkmcnt(10)
    s_add_u32 s41, s39, 20480
    v_mfma_f32_16x16x32_bf16 v[104:107], a[232:235], a[208:211], v[104:107]
    ds_read_b64_tr_b16 a[228:229], v34 offset:40960
    v_mfma_f32_16x16x32_bf16 v[108:111], a[232:235], a[212:215], v[108:111]
    ds_read_b64_tr_b16 a[230:231], v34 offset:43008
    buffer_load_dwordx4 v18, s[44:47], s41 offen lds
    v_mfma_f32_16x16x32_bf16 v[148:151], a[236:239], v[60:63], v[148:151]
    ds_read_b64_tr_b16 a[232:233], v29 offset:40960
    s_add_u32 m0, s43, 101376
    v_mfma_f32_16x16x32_bf16 v[132:135], a[212:215], a[212:215], v[132:135]
    ds_read_b64_tr_b16 a[234:235], v29 offset:43008
    s_waitcnt lgkmcnt(10)
    v_mfma_f32_16x16x32_bf16 v[112:115], a[240:243], a[208:211], v[112:115]
    ds_read_b64_tr_b16 a[236:237], v30 offset:40960
    s_add_u32 s41, s39, 30720
    v_mfma_f32_16x16x32_bf16 v[116:119], a[240:243], a[212:215], v[116:119]
    ds_read_b64_tr_b16 a[238:239], v30 offset:43008
    buffer_load_dwordx4 v18, s[44:47], s41 offen lds
    v_mfma_f32_16x16x32_bf16 v[120:123], a[244:247], a[208:211], v[120:123]
    ds_read_b64_tr_b16 a[240:241], v31 offset:40960
    s_add_u32 m0, s35, 98304
    v_mfma_f32_16x16x32_bf16 v[124:127], a[244:247], a[212:215], v[124:127]
    ds_read_b64_tr_b16 a[242:243], v31 offset:43008
    v_mfma_f32_16x16x32_bf16 v[140:143], v[60:63], a[212:215], v[140:143]
    s_waitcnt lgkmcnt(10)
    v_mfma_f32_16x16x32_bf16 v[64:67], a[248:251], a[216:219], v[64:67]
    ds_read_b64_tr_b16 a[244:245], v35 offset:40960
    buffer_load_dwordx4 v20, s[48:51], s40 offen lds
    v_mfma_f32_16x16x32_bf16 v[68:71], a[248:251], a[220:223], v[68:71]
    ds_read_b64_tr_b16 a[246:247], v35 offset:43008
    s_add_u32 m0, s35, 99328
    v_mfma_f32_16x16x32_bf16 v[72:75], a[252:255], a[216:219], v[72:75]
    ds_read_b64_tr_b16 a[248:249], v32 offset:40960
    v_mfma_f32_16x16x32_bf16 v[76:79], a[252:255], a[220:223], v[76:79]
    ds_read_b64_tr_b16 a[250:251], v32 offset:43008
    s_waitcnt lgkmcnt(10)
    v_mfma_f32_16x16x32_bf16 v[80:83], a[224:227], a[216:219], v[80:83]
    ds_read_b64_tr_b16 a[252:253], v33 offset:40960
    buffer_load_dwordx4 v21, s[48:51], s40 offen lds
    v_mfma_f32_16x16x32_bf16 v[84:87], a[224:227], a[220:223], v[84:87]
    ds_read_b64_tr_b16 a[254:255], v33 offset:43008
    s_add_u32 m0, s35, 100352
    s_waitcnt vmcnt(6)
    s_waitcnt lgkmcnt(0)
    s_barrier
    ds_read_b128 a[192:195], v46 offset:0
    ds_read_b128 a[196:199], v46 offset:2048
    ds_read_b128 a[200:203], v47 offset:0
    ds_read_b128 a[204:207], v47 offset:2048
    v_mfma_f32_16x16x32_bf16 v[144:147], a[228:231], v[60:63], v[144:147]
    ds_read_b64_tr_b16 a[224:225], v36 offset:0
    v_mfma_f32_16x16x32_bf16 v[128:131], a[216:219], a[216:219], v[128:131]
    ds_read_b64_tr_b16 a[226:227], v36 offset:2048
    s_waitcnt lgkmcnt(10)
    v_mfma_f32_16x16x32_bf16 v[88:91], a[232:235], a[216:219], v[88:91]
    ds_read_b64_tr_b16 a[228:229], v37 offset:0
    buffer_load_dwordx4 v22, s[48:51], s40 offen lds
    v_mfma_f32_16x16x32_bf16 v[92:95], a[232:235], a[220:223], v[92:95]
    ds_read_b64_tr_b16 a[230:231], v37 offset:2048
    s_add_u32 m0, s35, 101376
    v_mfma_f32_16x16x32_bf16 v[96:99], a[236:239], a[216:219], v[96:99]
    ds_read_b64_tr_b16 a[232:233], v38 offset:0
    v_mfma_f32_16x16x32_bf16 v[100:103], a[236:239], a[220:223], v[100:103]
    ds_read_b64_tr_b16 a[234:235], v38 offset:2048
    v_mfma_f32_16x16x32_bf16 v[136:139], v[60:63], a[216:219], v[136:139]
    s_waitcnt lgkmcnt(10)
    buffer_load_dwordx4 v23, s[48:51], s40 offen lds
    v_mfma_f32_16x16x32_bf16 v[104:107], a[240:243], a[216:219], v[104:107]
    ds_read_b64_tr_b16 a[236:237], v44 offset:0
    s_lshl_b32 s39, s38, 7
    v_mfma_f32_16x16x32_bf16 v[108:111], a[240:243], a[220:223], v[108:111]
    ds_read_b64_tr_b16 a[238:239], v44 offset:2048
    s_add_u32 s39, s39, s36
    v_mfma_f32_16x16x32_bf16 v[148:151], a[244:247], v[60:63], v[148:151]
    ds_read_b64_tr_b16 a[240:241], v39 offset:0
    s_mul_i32 s40, s38, 245760
    v_mfma_f32_16x16x32_bf16 v[132:135], a[220:223], a[220:223], v[132:135]
    ds_read_b64_tr_b16 a[242:243], v39 offset:2048
    s_waitcnt lgkmcnt(10)
    v_mfma_f32_16x16x32_bf16 v[112:115], a[248:251], a[216:219], v[112:115]
    ds_read_b64_tr_b16 a[244:245], v40 offset:0
    s_add_u32 s40, s40, s37
    v_mfma_f32_16x16x32_bf16 v[116:119], a[248:251], a[220:223], v[116:119]
    ds_read_b64_tr_b16 a[246:247], v40 offset:2048
    s_add_u32 s38, s38, 1
    v_mfma_f32_16x16x32_bf16 v[120:123], a[252:255], a[216:219], v[120:123]
    ds_read_b64_tr_b16 a[248:249], v41 offset:0
    s_cmp_eq_u32 s38, 10
    v_mfma_f32_16x16x32_bf16 v[124:127], a[252:255], a[220:223], v[124:127]
    ds_read_b64_tr_b16 a[250:251], v41 offset:2048
    s_cselect_b32 s38, 0, s38
    v_mfma_f32_16x16x32_bf16 v[140:143], v[60:63], a[220:223], v[140:143]
    s_waitcnt lgkmcnt(10)
    s_add_u32 m0, s43, 0
    v_mfma_f32_16x16x32_bf16 v[64:67], a[224:227], a[192:195], v[64:67]
    ds_read_b64_tr_b16 a[252:253], v45 offset:0
    s_add_u32 s41, s39, 0
    v_mfma_f32_16x16x32_bf16 v[68:71], a[224:227], a[196:199], v[68:71]
    ds_read_b64_tr_b16 a[254:255], v45 offset:2048
    buffer_load_dwordx4 v18, s[44:47], s41 offen lds
    v_mfma_f32_16x16x32_bf16 v[72:75], a[228:231], a[192:195], v[72:75]
    ds_read_b64_tr_b16 a[224:225], v42 offset:0
    s_add_u32 m0, s43, 1024
    v_mfma_f32_16x16x32_bf16 v[76:79], a[228:231], a[196:199], v[76:79]
    ds_read_b64_tr_b16 a[226:227], v42 offset:2048
    s_waitcnt lgkmcnt(10)
    v_mfma_f32_16x16x32_bf16 v[80:83], a[232:235], a[192:195], v[80:83]
    ds_read_b64_tr_b16 a[228:229], v43 offset:0
    s_add_u32 s41, s39, 10240
    v_mfma_f32_16x16x32_bf16 v[84:87], a[232:235], a[196:199], v[84:87]
    ds_read_b64_tr_b16 a[230:231], v43 offset:2048
    buffer_load_dwordx4 v18, s[44:47], s41 offen lds
    v_mfma_f32_16x16x32_bf16 v[144:147], a[236:239], v[60:63], v[144:147]
    ds_read_b64_tr_b16 a[232:233], v36 offset:8192
    s_add_u32 m0, s43, 2048
    v_mfma_f32_16x16x32_bf16 v[128:131], a[192:195], a[192:195], v[128:131]
    ds_read_b64_tr_b16 a[234:235], v36 offset:10240
    s_waitcnt lgkmcnt(10)
    v_mfma_f32_16x16x32_bf16 v[88:91], a[240:243], a[192:195], v[88:91]
    ds_read_b64_tr_b16 a[236:237], v37 offset:8192
    s_add_u32 s41, s39, 20480
    v_mfma_f32_16x16x32_bf16 v[92:95], a[240:243], a[196:199], v[92:95]
    ds_read_b64_tr_b16 a[238:239], v37 offset:10240
    buffer_load_dwordx4 v18, s[44:47], s41 offen lds
    v_mfma_f32_16x16x32_bf16 v[96:99], a[244:247], a[192:195], v[96:99]
    ds_read_b64_tr_b16 a[240:241], v38 offset:8192
    s_add_u32 m0, s43, 3072
    v_mfma_f32_16x16x32_bf16 v[100:103], a[244:247], a[196:199], v[100:103]
    ds_read_b64_tr_b16 a[242:243], v38 offset:10240
    s_add_u32 s41, s39, 30720
    v_mfma_f32_16x16x32_bf16 v[136:139], v[60:63], a[192:195], v[136:139]
    s_waitcnt lgkmcnt(10)
    v_mfma_f32_16x16x32_bf16 v[104:107], a[248:251], a[192:195], v[104:107]
    ds_read_b64_tr_b16 a[244:245], v44 offset:8192
    buffer_load_dwordx4 v18, s[44:47], s41 offen lds
    v_mfma_f32_16x16x32_bf16 v[108:111], a[248:251], a[196:199], v[108:111]
    ds_read_b64_tr_b16 a[246:247], v44 offset:10240
    s_add_u32 m0, s35, 0
    v_mfma_f32_16x16x32_bf16 v[148:151], a[252:255], v[60:63], v[148:151]
    ds_read_b64_tr_b16 a[248:249], v39 offset:8192
    v_mfma_f32_16x16x32_bf16 v[132:135], a[196:199], a[196:199], v[132:135]
    ds_read_b64_tr_b16 a[250:251], v39 offset:10240
    s_waitcnt lgkmcnt(10)
    v_mfma_f32_16x16x32_bf16 v[112:115], a[224:227], a[192:195], v[112:115]
    ds_read_b64_tr_b16 a[252:253], v40 offset:8192
    buffer_load_dwordx4 v20, s[48:51], s40 offen lds
    v_mfma_f32_16x16x32_bf16 v[116:119], a[224:227], a[196:199], v[116:119]
    ds_read_b64_tr_b16 a[254:255], v40 offset:10240
    s_add_u32 m0, s35, 1024
    v_mfma_f32_16x16x32_bf16 v[120:123], a[228:231], a[192:195], v[120:123]
    ds_read_b64_tr_b16 a[224:225], v41 offset:8192
    v_mfma_f32_16x16x32_bf16 v[124:127], a[228:231], a[196:199], v[124:127]
    ds_read_b64_tr_b16 a[226:227], v41 offset:10240
    v_mfma_f32_16x16x32_bf16 v[140:143], v[60:63], a[196:199], v[140:143]
    s_waitcnt lgkmcnt(10)
    buffer_load_dwordx4 v21, s[48:51], s40 offen lds
    v_mfma_f32_16x16x32_bf16 v[64:67], a[232:235], a[200:203], v[64:67]
    ds_read_b64_tr_b16 a[228:229], v45 offset:8192
    s_add_u32 m0, s35, 2048
    v_mfma_f32_16x16x32_bf16 v[68:71], a[232:235], a[204:207], v[68:71]
    ds_read_b64_tr_b16 a[230:231], v45 offset:10240
    v_mfma_f32_16x16x32_bf16 v[72:75], a[236:239], a[200:203], v[72:75]
    ds_read_b64_tr_b16 a[232:233], v42 offset:8192
    v_mfma_f32_16x16x32_bf16 v[76:79], a[236:239], a[204:207], v[76:79]
    ds_read_b64_tr_b16 a[234:235], v42 offset:10240
    s_waitcnt lgkmcnt(10)
    v_mfma_f32_16x16x32_bf16 v[80:83], a[240:243], a[200:203], v[80:83]
    ds_read_b64_tr_b16 a[236:237], v43 offset:8192
    buffer_load_dwordx4 v22, s[48:51], s40 offen lds
    v_mfma_f32_16x16x32_bf16 v[84:87], a[240:243], a[204:207], v[84:87]
    ds_read_b64_tr_b16 a[238:239], v43 offset:10240
    s_add_u32 m0, s35, 3072
    s_waitcnt vmcnt(7)
    s_waitcnt lgkmcnt(0)
    s_barrier
    buffer_load_dword v59, v16, s[52:55], 0 offen sc1
    ds_read_b128 a[208:211], v46 offset:32768
    ds_read_b128 a[212:215], v46 offset:34816
    ds_read_b128 a[216:219], v47 offset:32768
    ds_read_b128 a[220:223], v47 offset:34816
    v_mfma_f32_16x16x32_bf16 v[144:147], a[244:247], v[60:63], v[144:147]
    ds_read_b64_tr_b16 a[240:241], v36 offset:32768
    v_mfma_f32_16x16x32_bf16 v[128:131], a[200:203], a[200:203], v[128:131]
    ds_read_b64_tr_b16 a[242:243], v36 offset:34816
    s_waitcnt lgkmcnt(10)
    v_mfma_f32_16x16x32_bf16 v[88:91], a[248:251], a[200:203], v[88:91]
    ds_read_b64_tr_b16 a[244:245], v37 offset:32768
    buffer_load_dwordx4 v23, s[48:51], s40 offen lds
    v_mfma_f32_16x16x32_bf16 v[92:95], a[248:251], a[204:207], v[92:95]
    ds_read_b64_tr_b16 a[246:247], v37 offset:34816
    s_lshl_b32 s39, s38, 7
    v_mfma_f32_16x16x32_bf16 v[96:99], a[252:255], a[200:203], v[96:99]
    ds_read_b64_tr_b16 a[248:249], v38 offset:32768
    s_add_u32 s39, s39, s36
    v_mfma_f32_16x16x32_bf16 v[100:103], a[252:255], a[204:207], v[100:103]
    ds_read_b64_tr_b16 a[250:251], v38 offset:34816
    s_mul_i32 s40, s38, 245760
    v_mfma_f32_16x16x32_bf16 v[136:139], v[60:63], a[200:203], v[136:139]
    s_waitcnt lgkmcnt(10)
    s_add_u32 s40, s40, s37
    v_mfma_f32_16x16x32_bf16 v[104:107], a[224:227], a[200:203], v[104:107]
    ds_read_b64_tr_b16 a[252:253], v44 offset:32768
    s_add_u32 s38, s38, 1
    v_mfma_f32_16x16x32_bf16 v[108:111], a[224:227], a[204:207], v[108:111]
    ds_read_b64_tr_b16 a[254:255], v44 offset:34816
    s_cmp_eq_u32 s38, 10
    v_mfma_f32_16x16x32_bf16 v[148:151], a[228:231], v[60:63], v[148:151]
    ds_read_b64_tr_b16 a[224:225], v39 offset:32768
    s_cselect_b32 s38, 0, s38
    v_mfma_f32_16x16x32_bf16 v[132:135], a[204:207], a[204:207], v[132:135]
    ds_read_b64_tr_b16 a[226:227], v39 offset:34816
    s_waitcnt lgkmcnt(10)
    v_mfma_f32_16x16x32_bf16 v[112:115], a[232:235], a[200:203], v[112:115]
    ds_read_b64_tr_b16 a[228:229], v40 offset:32768
    s_add_u32 m0, s43, 32768
    v_mfma_f32_16x16x32_bf16 v[116:119], a[232:235], a[204:207], v[116:119]
    ds_read_b64_tr_b16 a[230:231], v40 offset:34816
    s_add_u32 s41, s39, 0
    v_mfma_f32_16x16x32_bf16 v[120:123], a[236:239], a[200:203], v[120:123]
    ds_read_b64_tr_b16 a[232:233], v41 offset:32768
    buffer_load_dwordx4 v18, s[44:47], s41 offen lds
    v_mfma_f32_16x16x32_bf16 v[124:127], a[236:239], a[204:207], v[124:127]
    ds_read_b64_tr_b16 a[234:235], v41 offset:34816
    s_add_u32 m0, s43, 33792
    v_mfma_f32_16x16x32_bf16 v[140:143], v[60:63], a[204:207], v[140:143]
    s_waitcnt lgkmcnt(10)
    s_add_u32 s41, s39, 10240
    v_mfma_f32_16x16x32_bf16 v[64:67], a[240:243], a[208:211], v[64:67]
    ds_read_b64_tr_b16 a[236:237], v45 offset:32768
    v_mfma_f32_16x16x32_bf16 v[68:71], a[240:243], a[212:215], v[68:71]
    ds_read_b64_tr_b16 a[238:239], v45 offset:34816
    buffer_load_dwordx4 v18, s[44:47], s41 offen lds
    v_mfma_f32_16x16x32_bf16 v[72:75], a[244:247], a[208:211], v[72:75]
    ds_read_b64_tr_b16 a[240:241], v42 offset:32768
    s_add_u32 m0, s43, 34816
    v_mfma_f32_16x16x32_bf16 v[76:79], a[244:247], a[212:215], v[76:79]
    ds_read_b64_tr_b16 a[242:243], v42 offset:34816
    s_waitcnt lgkmcnt(10)
    v_mfma_f32_16x16x32_bf16 v[80:83], a[248:251], a[208:211], v[80:83]
    ds_read_b64_tr_b16 a[244:245], v43 offset:32768
    s_add_u32 s41, s39, 20480
    v_mfma_f32_16x16x32_bf16 v[84:87], a[248:251], a[212:215], v[84:87]
    ds_read_b64_tr_b16 a[246:247], v43 offset:34816
    buffer_load_dwordx4 v18, s[44:47], s41 offen lds
    v_mfma_f32_16x16x32_bf16 v[144:147], a[252:255], v[60:63], v[144:147]
    ds_read_b64_tr_b16 a[248:249], v36 offset:40960
    s_add_u32 m0, s43, 35840
    v_mfma_f32_16x16x32_bf16 v[128:131], a[208:211], a[208:211], v[128:131]
    ds_read_b64_tr_b16 a[250:251], v36 offset:43008
    s_waitcnt lgkmcnt(10)
    v_mfma_f32_16x16x32_bf16 v[88:91], a[224:227], a[208:211], v[88:91]
    ds_read_b64_tr_b16 a[252:253], v37 offset:40960
    s_add_u32 s41, s39, 30720
    v_mfma_f32_16x16x32_bf16 v[92:95], a[224:227], a[212:215], v[92:95]
    ds_read_b64_tr_b16 a[254:255], v37 offset:43008
    buffer_load_dwordx4 v18, s[44:47], s41 offen lds
    v_mfma_f32_16x16x32_bf16 v[96:99], a[228:231], a[208:211], v[96:99]
    ds_read_b64_tr_b16 a[224:225], v38 offset:40960
    s_add_u32 m0, s35, 32768
    v_mfma_f32_16x16x32_bf16 v[100:103], a[228:231], a[212:215], v[100:103]
    ds_read_b64_tr_b16 a[226:227], v38 offset:43008
    v_mfma_f32_16x16x32_bf16 v[136:139], v[60:63], a[208:211], v[136:139]
    s_waitcnt lgkmcnt(10)
    v_mfma_f32_16x16x32_bf16 v[104:107], a[232:235], a[208:211], v[104:107]
    ds_read_b64_tr_b16 a[228:229], v44 offset:40960
    buffer_load_dwordx4 v20, s[48:51], s40 offen lds
    v_mfma_f32_16x16x32_bf16 v[108:111], a[232:235], a[212:215], v[108:111]
    ds_read_b64_tr_b16 a[230:231], v44 offset:43008
    s_add_u32 m0, s35, 33792
    v_mfma_f32_16x16x32_bf16 v[148:151], a[236:239], v[60:63], v[148:151]
    ds_read_b64_tr_b16 a[232:233], v39 offset:40960
    v_mfma_f32_16x16x32_bf16 v[132:135], a[212:215], a[212:215], v[132:135]
    ds_read_b64_tr_b16 a[234:235], v39 offset:43008
    s_waitcnt lgkmcnt(10)
    v_mfma_f32_16x16x32_bf16 v[112:115], a[240:243], a[208:211], v[112:115]
    ds_read_b64_tr_b16 a[236:237], v40 offset:40960
    buffer_load_dwordx4 v21, s[48:51], s40 offen lds
    v_mfma_f32_16x16x32_bf16 v[116:119], a[240:243], a[212:215], v[116:119]
    ds_read_b64_tr_b16 a[238:239], v40 offset:43008
    s_add_u32 m0, s35, 34816
    v_mfma_f32_16x16x32_bf16 v[120:123], a[244:247], a[208:211], v[120:123]
    ds_read_b64_tr_b16 a[240:241], v41 offset:40960
    v_mfma_f32_16x16x32_bf16 v[124:127], a[244:247], a[212:215], v[124:127]
    ds_read_b64_tr_b16 a[242:243], v41 offset:43008
    v_mfma_f32_16x16x32_bf16 v[140:143], v[60:63], a[212:215], v[140:143]
    s_waitcnt lgkmcnt(10)
    buffer_load_dwordx4 v22, s[48:51], s40 offen lds
    v_mfma_f32_16x16x32_bf16 v[64:67], a[248:251], a[216:219], v[64:67]
    ds_read_b64_tr_b16 a[244:245], v45 offset:40960
    s_add_u32 m0, s35, 35840
    v_mfma_f32_16x16x32_bf16 v[68:71], a[248:251], a[220:223], v[68:71]
    ds_read_b64_tr_b16 a[246:247], v45 offset:43008
    v_mfma_f32_16x16x32_bf16 v[72:75], a[252:255], a[216:219], v[72:75]
    ds_read_b64_tr_b16 a[248:249], v42 offset:40960
    v_mfma_f32_16x16x32_bf16 v[76:79], a[252:255], a[220:223], v[76:79]
    ds_read_b64_tr_b16 a[250:251], v42 offset:43008
    s_waitcnt lgkmcnt(10)
    v_mfma_f32_16x16x32_bf16 v[80:83], a[224:227], a[216:219], v[80:83]
    ds_read_b64_tr_b16 a[252:253], v43 offset:40960
    buffer_load_dwordx4 v23, s[48:51], s40 offen lds
    v_mfma_f32_16x16x32_bf16 v[84:87], a[224:227], a[220:223], v[84:87]
    ds_read_b64_tr_b16 a[254:255], v43 offset:43008
    s_lshl_b32 s39, s38, 7
    s_waitcnt vmcnt(8)
    s_waitcnt lgkmcnt(0)
    s_barrier
    ds_read_b128 a[192:195], v25 offset:0
    ds_read_b128 a[196:199], v25 offset:2048
    ds_read_b128 a[200:203], v19 offset:0
    ds_read_b128 a[204:207], v19 offset:2048
    v_mfma_f32_16x16x32_bf16 v[144:147], a[228:231], v[60:63], v[144:147]
    ds_read_b64_tr_b16 a[224:225], v26 offset:0
    s_add_u32 s39, s39, s36
    v_mfma_f32_16x16x32_bf16 v[128:131], a[216:219], a[216:219], v[128:131]
    ds_read_b64_tr_b16 a[226:227], v26 offset:2048
    s_waitcnt lgkmcnt(10)
    v_mfma_f32_16x16x32_bf16 v[88:91], a[232:235], a[216:219], v[88:91]
    ds_read_b64_tr_b16 a[228:229], v27 offset:0
    s_mul_i32 s40, s38, 245760
    v_mfma_f32_16x16x32_bf16 v[92:95], a[232:235], a[220:223], v[92:95]
    ds_read_b64_tr_b16 a[230:231], v27 offset:2048
    s_add_u32 s40, s40, s37
    v_mfma_f32_16x16x32_bf16 v[96:99], a[236:239], a[216:219], v[96:99]
    ds_read_b64_tr_b16 a[232:233], v28 offset:0
    s_add_u32 s38, s38, 1
    v_mfma_f32_16x16x32_bf16 v[100:103], a[236:239], a[220:223], v[100:103]
    ds_read_b64_tr_b16 a[234:235], v28 offset:2048
    s_cmp_eq_u32 s38, 10
    v_mfma_f32_16x16x32_bf16 v[136:139], v[60:63], a[216:219], v[136:139]
    s_waitcnt lgkmcnt(10)
    s_cselect_b32 s38, 0, s38
    v_mfma_f32_16x16x32_bf16 v[104:107], a[240:243], a[216:219], v[104:107]
    ds_read_b64_tr_b16 a[236:237], v34 offset:0
    s_add_u32 m0, s43, 65536
    v_mfma_f32_16x16x32_bf16 v[108:111], a[240:243], a[220:223], v[108:111]
    ds_read_b64_tr_b16 a[238:239], v34 offset:2048
    s_add_u32 s41, s39, 0
    v_mfma_f32_16x16x32_bf16 v[148:151], a[244:247], v[60:63], v[148:151]
    ds_read_b64_tr_b16 a[240:241], v29 offset:0
    buffer_load_dwordx4 v18, s[44:47], s41 offen lds
    v_mfma_f32_16x16x32_bf16 v[132:135], a[220:223], a[220:223], v[132:135]
    ds_read_b64_tr_b16 a[242:243], v29 offset:2048
    s_waitcnt lgkmcnt(10)
    v_mfma_f32_16x16x32_bf16 v[112:115], a[248:251], a[216:219], v[112:115]
    ds_read_b64_tr_b16 a[244:245], v30 offset:0
    s_add_u32 m0, s43, 66560
    v_mfma_f32_16x16x32_bf16 v[116:119], a[248:251], a[220:223], v[116:119]
    ds_read_b64_tr_b16 a[246:247], v30 offset:2048
    s_add_u32 s41, s39, 10240
    v_mfma_f32_16x16x32_bf16 v[120:123], a[252:255], a[216:219], v[120:123]
    ds_read_b64_tr_b16 a[248:249], v31 offset:0
    buffer_load_dwordx4 v18, s[44:47], s41 offen lds
    v_mfma_f32_16x16x32_bf16 v[124:127], a[252:255], a[220:223], v[124:127]
    ds_read_b64_tr_b16 a[250:251], v31 offset:2048
    s_add_u32 m0, s43, 67584
    v_mfma_f32_16x16x32_bf16 v[140:143], v[60:63], a[220:223], v[140:143]
    s_waitcnt lgkmcnt(10)
    s_add_u32 s41, s39, 20480
    v_mfma_f32_16x16x32_bf16 v[64:67], a[224:227], a[192:195], v[64:67]
    ds_read_b64_tr_b16 a[252:253], v35 offset:0
    v_mfma_f32_16x16x32_bf16 v[68:71], a[224:227], a[196:199], v[68:71]
    ds_read_b64_tr_b16 a[254:255], v35 offset:2048
    buffer_load_dwordx4 v18, s[44:47], s41 offen lds
    v_mfma_f32_16x16x32_bf16 v[72:75], a[228:231], a[192:195], v[72:75]
    ds_read_b64_tr_b16 a[224:225], v32 offset:0
    s_add_u32 m0, s43, 68608
    v_mfma_f32_16x16x32_bf16 v[76:79], a[228:231], a[196:199], v[76:79]
    ds_read_b64_tr_b16 a[226:227], v32 offset:2048
    s_waitcnt lgkmcnt(10)
    v_mfma_f32_16x16x32_bf16 v[80:83], a[232:235], a[192:195], v[80:83]
    ds_read_b64_tr_b16 a[228:229], v33 offset:0
    s_add_u32 s41, s39, 30720
    v_mfma_f32_16x16x32_bf16 v[84:87], a[232:235], a[196:199], v[84:87]
    ds_read_b64_tr_b16 a[230:231], v33 offset:2048
    buffer_load_dwordx4 v18, s[44:47], s41 offen lds
    v_mfma_f32_16x16x32_bf16 v[144:147], a[236:239], v[60:63], v[144:147]
    ds_read_b64_tr_b16 a[232:233], v26 offset:8192
    s_add_u32 m0, s35, 65536
    v_mfma_f32_16x16x32_bf16 v[128:131], a[192:195], a[192:195], v[128:131]
    ds_read_b64_tr_b16 a[234:235], v26 offset:10240
    s_waitcnt lgkmcnt(10)
    v_mfma_f32_16x16x32_bf16 v[88:91], a[240:243], a[192:195], v[88:91]
    ds_read_b64_tr_b16 a[236:237], v27 offset:8192
    v_mfma_f32_16x16x32_bf16 v[92:95], a[240:243], a[196:199], v[92:95]
    ds_read_b64_tr_b16 a[238:239], v27 offset:10240
    buffer_load_dwordx4 v20, s[48:51], s40 offen lds
    v_mfma_f32_16x16x32_bf16 v[96:99], a[244:247], a[192:195], v[96:99]
    ds_read_b64_tr_b16 a[240:241], v28 offset:8192
    s_add_u32 m0, s35, 66560
    v_mfma_f32_16x16x32_bf16 v[100:103], a[244:247], a[196:199], v[100:103]
    ds_read_b64_tr_b16 a[242:243], v28 offset:10240
    v_mfma_f32_16x16x32_bf16 v[136:139], v[60:63], a[192:195], v[136:139]
    s_waitcnt lgkmcnt(10)
    v_mfma_f32_16x16x32_bf16 v[104:107], a[248:251], a[192:195], v[104:107]
    ds_read_b64_tr_b16 a[244:245], v34 offset:8192
    buffer_load_dwordx4 v21, s[48:51], s40 offen lds
    v_mfma_f32_16x16x32_bf16 v[108:111], a[248:251], a[196:199], v[108:111]
    ds_read_b64_tr_b16 a[246:247], v34 offset:10240
    s_add_u32 m0, s35, 67584
    v_mfma_f32_16x16x32_bf16 v[148:151], a[252:255], v[60:63], v[148:151]
    ds_read_b64_tr_b16 a[248:249], v29 offset:8192
    v_mfma_f32_16x16x32_bf16 v[132:135], a[196:199], a[196:199], v[132:135]
    ds_read_b64_tr_b16 a[250:251], v29 offset:10240
    s_waitcnt lgkmcnt(10)
    v_mfma_f32_16x16x32_bf16 v[112:115], a[224:227], a[192:195], v[112:115]
    ds_read_b64_tr_b16 a[252:253], v30 offset:8192
    buffer_load_dwordx4 v22, s[48:51], s40 offen lds
    v_mfma_f32_16x16x32_bf16 v[116:119], a[224:227], a[196:199], v[116:119]
    ds_read_b64_tr_b16 a[254:255], v30 offset:10240
    s_add_u32 m0, s35, 68608
    v_mfma_f32_16x16x32_bf16 v[120:123], a[228:231], a[192:195], v[120:123]
    ds_read_b64_tr_b16 a[224:225], v31 offset:8192
    v_mfma_f32_16x16x32_bf16 v[124:127], a[228:231], a[196:199], v[124:127]
    ds_read_b64_tr_b16 a[226:227], v31 offset:10240
    v_mfma_f32_16x16x32_bf16 v[140:143], v[60:63], a[196:199], v[140:143]
    s_waitcnt lgkmcnt(10)
    buffer_load_dwordx4 v23, s[48:51], s40 offen lds
    v_mfma_f32_16x16x32_bf16 v[64:67], a[232:235], a[200:203], v[64:67]
    ds_read_b64_tr_b16 a[228:229], v35 offset:8192
    s_lshl_b32 s39, s38, 7
    v_mfma_f32_16x16x32_bf16 v[68:71], a[232:235], a[204:207], v[68:71]
    ds_read_b64_tr_b16 a[230:231], v35 offset:10240
    s_add_u32 s39, s39, s36
    v_mfma_f32_16x16x32_bf16 v[72:75], a[236:239], a[200:203], v[72:75]
    ds_read_b64_tr_b16 a[232:233], v32 offset:8192
    s_mul_i32 s40, s38, 245760
    v_mfma_f32_16x16x32_bf16 v[76:79], a[236:239], a[204:207], v[76:79]
    ds_read_b64_tr_b16 a[234:235], v32 offset:10240
    s_waitcnt lgkmcnt(10)
    v_mfma_f32_16x16x32_bf16 v[80:83], a[240:243], a[200:203], v[80:83]
    ds_read_b64_tr_b16 a[236:237], v33 offset:8192
    s_add_u32 s40, s40, s37
    v_mfma_f32_16x16x32_bf16 v[84:87], a[240:243], a[204:207], v[84:87]
    ds_read_b64_tr_b16 a[238:239], v33 offset:10240
    s_add_u32 s38, s38, 1
    s_waitcnt vmcnt(8)
    s_waitcnt lgkmcnt(0)
    s_barrier
    v_cmp_gt_u32 vcc, 1, v59
    s_mov_b32 s7, 0
    s_nop 3
    s_cbranch_vccz km_zq_ok
km_zq:
    s_sleep 8
    buffer_load_dword v59, v16, s[52:55], 0 offen sc1
    s_add_u32 s7, s7, 1
    s_waitcnt vmcnt(0)
    v_cmp_gt_u32 vcc, 1, v59
    s_cmp_lt_u32 s7, 0x40000
    s_nop 3
    s_cbranch_vccz km_zq_ok
    s_cbranch_scc1 km_zq
km_zq_ok:
    ds_read_b128 a[208:211], v25 offset:32768
    ds_read_b128 a[212:215], v25 offset:34816
    ds_read_b128 a[216:219], v19 offset:32768
    ds_read_b128 a[220:223], v19 offset:34816
    v_mfma_f32_16x16x32_bf16 v[144:147], a[244:247], v[60:63], v[144:147]
    ds_read_b64_tr_b16 a[240:241], v26 offset:32768
    s_cmp_eq_u32 s38, 10
    v_mfma_f32_16x16x32_bf16 v[128:131], a[200:203], a[200:203], v[128:131]
    ds_read_b64_tr_b16 a[242:243], v26 offset:34816
    s_waitcnt lgkmcnt(10)
    v_mfma_f32_16x16x32_bf16 v[88:91], a[248:251], a[200:203], v[88:91]
    ds_read_b64_tr_b16 a[244:245], v27 offset:32768
    s_cselect_b32 s38, 0, s38
    v_mfma_f32_16x16x32_bf16 v[92:95], a[248:251], a[204:207], v[92:95]
    ds_read_b64_tr_b16 a[246:247], v27 offset:34816
    s_add_u32 m0, s43, 98304
    v_mfma_f32_16x16x32_bf16 v[96:99], a[252:255], a[200:203], v[96:99]
    ds_read_b64_tr_b16 a[248:249], v28 offset:32768
    s_add_u32 s41, s39, 0
    v_mfma_f32_16x16x32_bf16 v[100:103], a[252:255], a[204:207], v[100:103]
    ds_read_b64_tr_b16 a[250:251], v28 offset:34816
    buffer_load_dwordx4 v18, s[44:47], s41 offen lds
    v_mfma_f32_16x16x32_bf16 v[136:139], v[60:63], a[200:203], v[136:139]
    s_waitcnt lgkmcnt(10)
    s_add_u32 m0, s43, 99328
    v_mfma_f32_16x16x32_bf16 v[104:107], a[224:227], a[200:203], v[104:107]
    ds_read_b64_tr_b16 a[252:253], v34 offset:32768
    s_add_u32 s41, s39, 10240
    v_mfma_f32_16x16x32_bf16 v[108:111], a[224:227], a[204:207], v[108:111]
    ds_read_b64_tr_b16 a[254:255], v34 offset:34816
    v_mfma_f32_16x16x32_bf16 v[148:151], a[228:231], v[60:63], v[148:151]
    ds_read_b64_tr_b16 a[224:225], v29 offset:32768
    buffer_load_dwordx4 v18, s[44:47], s41 offen lds
    v_mfma_f32_16x16x32_bf16 v[132:135], a[204:207], a[204:207], v[132:135]
    ds_read_b64_tr_b16 a[226:227], v29 offset:34816
    s_waitcnt lgkmcnt(10)
    v_mfma_f32_16x16x32_bf16 v[112:115], a[232:235], a[200:203], v[112:115]
    ds_read_b64_tr_b16 a[228:229], v30 offset:32768
    s_add_u32 m0, s43, 100352
    v_mfma_f32_16x16x32_bf16 v[116:119], a[232:235], a[204:207], v[116:119]
    ds_read_b64_tr_b16 a[230:231], v30 offset:34816
    s_add_u32 s41, s39, 20480
    v_mfma_f32_16x16x32_bf16 v[120:123], a[236:239], a[200:203], v[120:123]
    ds_read_b64_tr_b16 a[232:233], v31 offset:32768
    buffer_load_dwordx4 v18, s[44:47], s41 offen lds
    v_mfma_f32_16x16x32_bf16 v[124:127], a[236:239], a[204:207], v[124:127]
    ds_read_b64_tr_b16 a[234:235], v31 offset:34816
    s_add_u32 m0, s43, 101376
    v_mfma_f32_16x16x32_bf16 v[140:143], v[60:63], a[204:207], v[140:143]
    s_waitcnt lgkmcnt(10)
    s_add_u32 s41, s39, 30720
    v_mfma_f32_16x16x32_bf16 v[64:67], a[240:243], a[208:211], v[64:67]
    ds_read_b64_tr_b16 a[236:237], v35 offset:32768
    v_mfma_f32_16x16x32_bf16 v[68:71], a[240:243], a[212:215], v[68:71]
    ds_read_b64_tr_b16 a[238:239], v35 offset:34816
    buffer_load_dwordx4 v18, s[44:47], s41 offen lds
    v_mfma_f32_16x16x32_bf16 v[72:75], a[244:247], a[208:211], v[72:75]
    ds_read_b64_tr_b16 a[240:241], v32 offset:32768
    s_add_u32 m0, s35, 98304
    v_mfma_f32_16x16x32_bf16 v[76:79], a[244:247], a[212:215], v[76:79]
    ds_read_b64_tr_b16 a[242:243], v32 offset:34816
    s_waitcnt lgkmcnt(10)
    v_mfma_f32_16x16x32_bf16 v[80:83], a[248:251], a[208:211], v[80:83]
    ds_read_b64_tr_b16 a[244:245], v33 offset:32768
    v_mfma_f32_16x16x32_bf16 v[84:87], a[248:251], a[212:215], v[84:87]
    ds_read_b64_tr_b16 a[246:247], v33 offset:34816
    buffer_load_dwordx4 v20, s[48:51], s40 offen lds
    v_mfma_f32_16x16x32_bf16 v[144:147], a[252:255], v[60:63], v[144:147]
    ds_read_b64_tr_b16 a[248:249], v26 offset:40960
    s_add_u32 m0, s35, 99328
    v_mfma_f32_16x16x32_bf16 v[128:131], a[208:211], a[208:211], v[128:131]
    ds_read_b64_tr_b16 a[250:251], v26 offset:43008
    s_waitcnt lgkmcnt(10)
    v_mfma_f32_16x16x32_bf16 v[88:91], a[224:227], a[208:211], v[88:91]
    ds_read_b64_tr_b16 a[252:253], v27 offset:40960
    v_mfma_f32_16x16x32_bf16 v[92:95], a[224:227], a[212:215], v[92:95]
    ds_read_b64_tr_b16 a[254:255], v27 offset:43008
    buffer_load_dwordx4 v21, s[48:51], s40 offen lds
    v_mfma_f32_16x16x32_bf16 v[96:99], a[228:231], a[208:211], v[96:99]
    ds_read_b64_tr_b16 a[224:225], v28 offset:40960
    s_add_u32 m0, s35, 100352
    v_mfma_f32_16x16x32_bf16 v[100:103], a[228:231], a[212:215], v[100:103]
    ds_read_b64_tr_b16 a[226:227], v28 offset:43008
    v_mfma_f32_16x16x32_bf16 v[136:139], v[60:63], a[208:211], v[136:139]
    s_waitcnt lgkmcnt(10)
    v_mfma_f32_16x16x32_bf16 v[104:107], a[232:235], a[208:211], v[104:107]
    ds_read_b64_tr_b16 a[228:229], v34 offset:40960
    buffer_load_dwordx4 v22, s[48:51], s40 offen lds
    v_mfma_f32_16x16x32_bf16 v[108:111], a[232:235], a[212:215], v[108:111]
    ds_read_b64_tr_b16 a[230:231], v34 offset:43008
    s_add_u32 m0, s35, 101376
    v_mfma_f32_16x16x32_bf16 v[148:151], a[236:239], v[60:63], v[148:151]
    ds_read_b64_tr_b16 a[232:233], v29 offset:40960
    v_mfma_f32_16x16x32_bf16 v[132:135], a[212:215], a[212:215], v[132:135]
    ds_read_b64_tr_b16 a[234:235], v29 offset:43008
    s_waitcnt lgkmcnt(10)
    v_mfma_f32_16x16x32_bf16 v[112:115], a[240:243], a[208:211], v[112:115]
    ds_read_b64_tr_b16 a[236:237], v30 offset:40960
    buffer_load_dwordx4 v23, s[48:51], s40 offen lds
    v_mfma_f32_16x16x32_bf16 v[116:119], a[240:243], a[212:215], v[116:119]
    ds_read_b64_tr_b16 a[238:239], v30 offset:43008
    s_lshl_b32 s39, s38, 7
    v_mfma_f32_16x16x32_bf16 v[120:123], a[244:247], a[208:211], v[120:123]
    ds_read_b64_tr_b16 a[240:241], v31 offset:40960
    s_add_u32 s39, s39, s36
    v_mfma_f32_16x16x32_bf16 v[124:127], a[244:247], a[212:215], v[124:127]
    ds_read_b64_tr_b16 a[242:243], v31 offset:43008
    s_mul_i32 s40, s38, 245760
    v_mfma_f32_16x16x32_bf16 v[140:143], v[60:63], a[212:215], v[140:143]
    s_waitcnt lgkmcnt(10)
    s_add_u32 s40, s40, s37
    v_mfma_f32_16x16x32_bf16 v[64:67], a[248:251], a[216:219], v[64:67]
    ds_read_b64_tr_b16 a[244:245], v35 offset:40960
    s_add_u32 s38, s38, 1
    v_mfma_f32_16x16x32_bf16 v[68:71], a[248:251], a[220:223], v[68:71]
    ds_read_b64_tr_b16 a[246:247], v35 offset:43008
    s_cmp_eq_u32 s38, 10
    v_mfma_f32_16x16x32_bf16 v[72:75], a[252:255], a[216:219], v[72:75]
    ds_read_b64_tr_b16 a[248:249], v32 offset:40960
    s_cselect_b32 s38, 0, s38
    v_mfma_f32_16x16x32_bf16 v[76:79], a[252:255], a[220:223], v[76:79]
    ds_read_b64_tr_b16 a[250:251], v32 offset:43008
    s_waitcnt lgkmcnt(10)
    v_mfma_f32_16x16x32_bf16 v[80:83], a[224:227], a[216:219], v[80:83]
    ds_read_b64_tr_b16 a[252:253], v33 offset:40960
    s_add_u32 m0, s43, 0
    v_mfma_f32_16x16x32_bf16 v[84:87], a[224:227], a[220:223], v[84:87]
    ds_read_b64_tr_b16 a[254:255], v33 offset:43008
    s_add_u32 s41, s39, 0
    s_waitcnt vmcnt(8)
    s_waitcnt lgkmcnt(0)
    s_barrier
    ds_read_b128 a[192:195], v46 offset:0
    ds_read_b128 a[196:199], v46 offset:2048
    ds_read_b128 a[200:203], v47 offset:0
    ds_read_b128 a[204:207], v47 offset:2048
    v_mfma_f32_16x16x32_bf16 v[144:147], a[228:231], v[60:63], v[144:147]
    ds_read_b64_tr_b16 a[224:225], v36 offset:0
    buffer_load_dwordx4 v18, s[44:47], s41 offen lds
    v_mfma_f32_16x16x32_bf16 v[128:131], a[216:219], a[216:219], v[128:131]
    ds_read_b64_tr_b16 a[226:227], v36 offset:2048
    s_waitcnt lgkmcnt(10)
    v_mfma_f32_16x16x32_bf16 v[88:91], a[232:235], a[216:219], v[88:91]
    ds_read_b64_tr_b16 a[228:229], v37 offset:0
    s_add_u32 m0, s43, 1024
    v_mfma_f32_16x16x32_bf16 v[92:95], a[232:235], a[220:223], v[92:95]
    ds_read_b64_tr_b16 a[230:231], v37 offset:2048
    s_add_u32 s41, s39, 10240
    v_mfma_f32_16x16x32_bf16 v[96:99], a[236:239], a[216:219], v[96:99]
    ds_read_b64_tr_b16 a[232:233], v38 offset:0
    buffer_load_dwordx4 v18, s[44:47], s41 offen lds
    v_mfma_f32_16x16x32_bf16 v[100:103], a[236:239], a[220:223], v[100:103]
    ds_read_b64_tr_b16 a[234:235], v38 offset:2048
    s_add_u32 m0, s43, 2048
    v_mfma_f32_16x16x32_bf16 v[136:139], v[60:63], a[216:219], v[136:139]
    s_waitcnt lgkmcnt(10)
    s_add_u32 s41, s39, 20480
    v_mfma_f32_16x16x32_bf16 v[104:107], a[240:243], a[216:219], v[104:107]
    ds_read_b64_tr_b16 a[236:237], v44 offset:0
    v_mfma_f32_16x16x32_bf16 v[108:111], a[240:243], a[220:223], v[108:111]
    ds_read_b64_tr_b16 a[238:239], v44 offset:2048
    buffer_load_dwordx4 v18, s[44:47], s41 offen lds
    v_mfma_f32_16x16x32_bf16 v[148:151], a[244:247], v[60:63], v[148:151]
    ds_read_b64_tr_b16 a[240:241], v39 offset:0
    s_add_u32 m0, s43, 3072
    v_mfma_f32_16x16x32_bf16 v[132:135], a[220:223], a[220:223], v[132:135]
    ds_read_b64_tr_b16 a[242:243], v39 offset:2048
    s_waitcnt lgkmcnt(10)
    v_mfma_f32_16x16x32_bf16 v[112:115], a[248:251], a[216:219], v[112:115]
    ds_read_b64_tr_b16 a[244:245], v40 offset:0
    s_add_u32 s41, s39, 30720
    v_mfma_f32_16x16x32_bf16 v[116:119], a[248:251], a[220:223], v[116:119]
    ds_read_b64_tr_b16 a[246:247], v40 offset:2048
    buffer_load_dwordx4 v18, s[44:47], s41 offen lds
    v_mfma_f32_16x16x32_bf16 v[120:123], a[252:255], a[216:219], v[120:123]
    ds_read_b64_tr_b16 a[248:249], v41 offset:0
    s_add_u32 m0, s35, 0
    v_mfma_f32_16x16x32_bf16 v[124:127], a[252:255], a[220:223], v[124:127]
    ds_read_b64_tr_b16 a[250:251], v41 offset:2048
    v_mfma_f32_16x16x32_bf16 v[140:143], v[60:63], a[220:223], v[140:143]
    s_waitcnt lgkmcnt(10)
    v_mfma_f32_16x16x32_bf16 v[64:67], a[224:227], a[192:195], v[64:67]
    ds_read_b64_tr_b16 a[252:253], v45 offset:0
    buffer_load_dwordx4 v20, s[48:51], s40 offen lds
    v_mfma_f32_16x16x32_bf16 v[68:71], a[224:227], a[196:199], v[68:71]
    ds_read_b64_tr_b16 a[254:255], v45 offset:2048
    s_add_u32 m0, s35, 1024
    v_mfma_f32_16x16x32_bf16 v[72:75], a[228:231], a[192:195], v[72:75]
    ds_read_b64_tr_b16 a[224:225], v42 offset:0
    v_mfma_f32_16x16x32_bf16 v[76:79], a[228:231], a[196:199], v[76:79]
    ds_read_b64_tr_b16 a[226:227], v42 offset:2048
    s_waitcnt lgkmcnt(10)
    v_mfma_f32_16x16x32_bf16 v[80:83], a[232:235], a[192:195], v[80:83]
    ds_read_b64_tr_b16 a[228:229], v43 offset:0
    buffer_load_dwordx4 v21, s[48:51], s40 offen lds
    v_mfma_f32_16x16x32_bf16 v[84:87], a[232:235], a[196:199], v[84:87]
    ds_read_b64_tr_b16 a[230:231], v43 offset:2048
    s_add_u32 m0, s35, 2048
    v_mfma_f32_16x16x32_bf16 v[144:147], a[236:239], v[60:63], v[144:147]
    ds_read_b64_tr_b16 a[232:233], v36 offset:8192
    v_mfma_f32_16x16x32_bf16 v[128:131], a[192:195], a[192:195], v[128:131]
    ds_read_b64_tr_b16 a[234:235], v36 offset:10240
    s_waitcnt lgkmcnt(10)
    v_mfma_f32_16x16x32_bf16 v[88:91], a[240:243], a[192:195], v[88:91]
    ds_read_b64_tr_b16 a[236:237], v37 offset:8192
    buffer_load_dwordx4 v22, s[48:51], s40 offen lds
    v_mfma_f32_16x16x32_bf16 v[92:95], a[240:243], a[196:199], v[92:95]
    ds_read_b64_tr_b16 a[238:239], v37 offset:10240
    s_add_u32 m0, s35, 3072
    v_mfma_f32_16x16x32_bf16 v[96:99], a[244:247], a[192:195], v[96:99]
    ds_read_b64_tr_b16 a[240:241], v38 offset:8192
    v_mfma_f32_16x16x32_bf16 v[100:103], a[244:247], a[196:199], v[100:103]
    ds_read_b64_tr_b16 a[242:243], v38 offset:10240
    v_mfma_f32_16x16x32_bf16 v[136:139], v[60:63], a[192:195], v[136:139]
    s_waitcnt lgkmcnt(10)
    buffer_load_dwordx4 v23, s[48:51], s40 offen lds
    v_mfma_f32_16x16x32_bf16 v[104:107], a[248:251], a[192:195], v[104:107]
    ds_read_b64_tr_b16 a[244:245], v44 offset:8192
    s_lshl_b32 s39, s38, 7
    v_mfma_f32_16x16x32_bf16 v[108:111], a[248:251], a[196:199], v[108:111]
    ds_read_b64_tr_b16 a[246:247], v44 offset:10240
    s_add_u32 s39, s39, s36
    v_mfma_f32_16x16x32_bf16 v[148:151], a[252:255], v[60:63], v[148:151]
    ds_read_b64_tr_b16 a[248:249], v39 offset:8192
    s_mul_i32 s40, s38, 245760
    v_mfma_f32_16x16x32_bf16 v[132:135], a[196:199], a[196:199], v[132:135]
    ds_read_b64_tr_b16 a[250:251], v39 offset:10240
    s_waitcnt lgkmcnt(10)
    v_mfma_f32_16x16x32_bf16 v[112:115], a[224:227], a[192:195], v[112:115]
    ds_read_b64_tr_b16 a[252:253], v40 offset:8192
    s_add_u32 s40, s40, s37
    v_mfma_f32_16x16x32_bf16 v[116:119], a[224:227], a[196:199], v[116:119]
    ds_read_b64_tr_b16 a[254:255], v40 offset:10240
    s_add_u32 s38, s38, 1
    v_mfma_f32_16x16x32_bf16 v[120:123], a[228:231], a[192:195], v[120:123]
    ds_read_b64_tr_b16 a[224:225], v41 offset:8192
    s_cmp_eq_u32 s38, 10
    v_mfma_f32_16x16x32_bf16 v[124:127], a[228:231], a[196:199], v[124:127]
    ds_read_b64_tr_b16 a[226:227], v41 offset:10240
    s_cselect_b32 s38, 0, s38
    v_mfma_f32_16x16x32_bf16 v[140:143], v[60:63], a[196:199], v[140:143]
    s_waitcnt lgkmcnt(10)
    s_add_u32 m0, s43, 32768
    v_mfma_f32_16x16x32_bf16 v[64:67], a[232:235], a[200:203], v[64:67]
    ds_read_b64_tr_b16 a[228:229], v45 offset:8192
    s_add_u32 s41, s39, 0
    v_mfma_f32_16x16x32_bf16 v[68:71], a[232:235], a[204:207], v[68:71]
    ds_read_b64_tr_b16 a[230:231], v45 offset:10240
    buffer_load_dwordx4 v18, s[44:47], s41 offen lds
    v_mfma_f32_16x16x32_bf16 v[72:75], a[236:239], a[200:203], v[72:75]
    ds_read_b64_tr_b16 a[232:233], v42 offset:8192
    s_add_u32 m0, s43, 33792
    v_mfma_f32_16x16x32_bf16 v[76:79], a[236:239], a[204:207], v[76:79]
    ds_read_b64_tr_b16 a[234:235], v42 offset:10240
    s_waitcnt lgkmcnt(10)
    v_mfma_f32_16x16x32_bf16 v[80:83], a[240:243], a[200:203], v[80:83]
    ds_read_b64_tr_b16 a[236:237], v43 offset:8192
    s_add_u32 s41, s39, 10240
    v_mfma_f32_16x16x32_bf16 v[84:87], a[240:243], a[204:207], v[84:87]
    ds_read_b64_tr_b16 a[238:239], v43 offset:10240
    buffer_load_dwordx4 v18, s[44:47], s41 offen lds
    s_waitcnt vmcnt(10)
    s_waitcnt lgkmcnt(0)
    s_barrier
    buffer_load_dword v59, v201, s[72:75], s70 offen sc1
    ds_read_b128 a[208:211], v46 offset:32768
    ds_read_b128 a[212:215], v46 offset:34816
    ds_read_b128 a[216:219], v47 offset:32768
    ds_read_b128 a[220:223], v47 offset:34816
    v_mfma_f32_16x16x32_bf16 v[144:147], a[244:247], v[60:63], v[144:147]
    ds_read_b64_tr_b16 a[240:241], v36 offset:32768
    s_add_u32 m0, s43, 34816
    v_mfma_f32_16x16x32_bf16 v[128:131], a[200:203], a[200:203], v[128:131]
    ds_read_b64_tr_b16 a[242:243], v36 offset:34816
    s_waitcnt lgkmcnt(10)
    v_mfma_f32_16x16x32_bf16 v[88:91], a[248:251], a[200:203], v[88:91]
    ds_read_b64_tr_b16 a[244:245], v37 offset:32768
    s_add_u32 s41, s39, 20480
    v_mfma_f32_16x16x32_bf16 v[92:95], a[248:251], a[204:207], v[92:95]
    ds_read_b64_tr_b16 a[246:247], v37 offset:34816
    buffer_load_dwordx4 v18, s[44:47], s41 offen lds
    v_mfma_f32_16x16x32_bf16 v[96:99], a[252:255], a[200:203], v[96:99]
    ds_read_b64_tr_b16 a[248:249], v38 offset:32768
    s_add_u32 m0, s43, 35840
    v_mfma_f32_16x16x32_bf16 v[100:103], a[252:255], a[204:207], v[100:103]
    ds_read_b64_tr_b16 a[250:251], v38 offset:34816
    s_add_u32 s41, s39, 30720
    v_mfma_f32_16x16x32_bf16 v[136:139], v[60:63], a[200:203], v[136:139]
    s_waitcnt lgkmcnt(10)
    v_mfma_f32_16x16x32_bf16 v[104:107], a[224:227], a[200:203], v[104:107]
    ds_read_b64_tr_b16 a[252:253], v44 offset:32768
    buffer_load_dwordx4 v18, s[44:47], s41 offen lds
    v_mfma_f32_16x16x32_bf16 v[108:111], a[224:227], a[204:207], v[108:111]
    ds_read_b64_tr_b16 a[254:255], v44 offset:34816
    s_add_u32 m0, s35, 32768
    v_mfma_f32_16x16x32_bf16 v[148:151], a[228:231], v[60:63], v[148:151]
    ds_read_b64_tr_b16 a[224:225], v39 offset:32768
    v_mfma_f32_16x16x32_bf16 v[132:135], a[204:207], a[204:207], v[132:135]
    ds_read_b64_tr_b16 a[226:227], v39 offset:34816
    s_waitcnt lgkmcnt(10)
    v_mfma_f32_16x16x32_bf16 v[112:115], a[232:235], a[200:203], v[112:115]
    ds_read_b64_tr_b16 a[228:229], v40 offset:32768
    buffer_load_dwordx4 v20, s[48:51], s40 offen lds
    v_mfma_f32_16x16x32_bf16 v[116:119], a[232:235], a[204:207], v[116:119]
    ds_read_b64_tr_b16 a[230:231], v40 offset:34816
    s_add_u32 m0, s35, 33792
    v_mfma_f32_16x16x32_bf16 v[120:123], a[236:239], a[200:203], v[120:123]
    ds_read_b64_tr_b16 a[232:233], v41 offset:32768
    v_mfma_f32_16x16x32_bf16 v[124:127], a[236:239], a[204:207], v[124:127]
    ds_read_b64_tr_b16 a[234:235], v41 offset:34816
    v_mfma_f32_16x16x32_bf16 v[140:143], v[60:63], a[204:207], v[140:143]
    s_waitcnt lgkmcnt(10)
    buffer_load_dwordx4 v21, s[48:51], s40 offen lds
    v_mfma_f32_16x16x32_bf16 v[64:67], a[240:243], a[208:211], v[64:67]
    ds_read_b64_tr_b16 a[236:237], v45 offset:32768
    s_add_u32 m0, s35, 34816
    v_mfma_f32_16x16x32_bf16 v[68:71], a[240:243], a[212:215], v[68:71]
    ds_read_b64_tr_b16 a[238:239], v45 offset:34816
    v_mfma_f32_16x16x32_bf16 v[72:75], a[244:247], a[208:211], v[72:75]
    ds_read_b64_tr_b16 a[240:241], v42 offset:32768
    v_mfma_f32_16x16x32_bf16 v[76:79], a[244:247], a[212:215], v[76:79]
    ds_read_b64_tr_b16 a[242:243], v42 offset:34816
    s_waitcnt lgkmcnt(10)
    v_mfma_f32_16x16x32_bf16 v[80:83], a[248:251], a[208:211], v[80:83]
    ds_read_b64_tr_b16 a[244:245], v43 offset:32768
    buffer_load_dwordx4 v22, s[48:51], s40 offen lds
    v_mfma_f32_16x16x32_bf16 v[84:87], a[248:251], a[212:215], v[84:87]
    ds_read_b64_tr_b16 a[246:247], v43 offset:34816
    s_add_u32 m0, s35, 35840
    v_mfma_f32_16x16x32_bf16 v[144:147], a[252:255], v[60:63], v[144:147]
    ds_read_b64_tr_b16 a[248:249], v36 offset:40960
    v_mfma_f32_16x16x32_bf16 v[128:131], a[208:211], a[208:211], v[128:131]
    ds_read_b64_tr_b16 a[250:251], v36 offset:43008
    s_waitcnt lgkmcnt(10)
    v_mfma_f32_16x16x32_bf16 v[88:91], a[224:227], a[208:211], v[88:91]
    ds_read_b64_tr_b16 a[252:253], v37 offset:40960
    buffer_load_dwordx4 v23, s[48:51], s40 offen lds
    v_mfma_f32_16x16x32_bf16 v[92:95], a[224:227], a[212:215], v[92:95]
    ds_read_b64_tr_b16 a[254:255], v37 offset:43008
    v_mfma_f32_16x16x32_bf16 v[96:99], a[228:231], a[208:211], v[96:99]
    ds_read_b64_tr_b16 a[224:225], v38 offset:40960
    v_mfma_f32_16x16x32_bf16 v[100:103], a[228:231], a[212:215], v[100:103]
    ds_read_b64_tr_b16 a[226:227], v38 offset:43008
    v_mfma_f32_16x16x32_bf16 v[136:139], v[60:63], a[208:211], v[136:139]
    s_waitcnt lgkmcnt(10)
    v_mfma_f32_16x16x32_bf16 v[104:107], a[232:235], a[208:211], v[104:107]
    ds_read_b64_tr_b16 a[228:229], v44 offset:40960
    v_mfma_f32_16x16x32_bf16 v[108:111], a[232:235], a[212:215], v[108:111]
    ds_read_b64_tr_b16 a[230:231], v44 offset:43008
    v_mfma_f32_16x16x32_bf16 v[148:151], a[236:239], v[60:63], v[148:151]
    ds_read_b64_tr_b16 a[232:233], v39 offset:40960
    v_mfma_f32_16x16x32_bf16 v[132:135], a[212:215], a[212:215], v[132:135]
    ds_read_b64_tr_b16 a[234:235], v39 offset:43008
    s_waitcnt lgkmcnt(10)
    v_mfma_f32_16x16x32_bf16 v[112:115], a[240:243], a[208:211], v[112:115]
    ds_read_b64_tr_b16 a[236:237], v40 offset:40960
    v_mfma_f32_16x16x32_bf16 v[116:119], a[240:243], a[212:215], v[116:119]
    ds_read_b64_tr_b16 a[238:239], v40 offset:43008
    v_mfma_f32_16x16x32_bf16 v[120:123], a[244:247], a[208:211], v[120:123]
    ds_read_b64_tr_b16 a[240:241], v41 offset:40960
    v_mfma_f32_16x16x32_bf16 v[124:127], a[244:247], a[212:215], v[124:127]
    ds_read_b64_tr_b16 a[242:243], v41 offset:43008
    v_mfma_f32_16x16x32_bf16 v[140:143], v[60:63], a[212:215], v[140:143]
    s_waitcnt lgkmcnt(10)
    v_mfma_f32_16x16x32_bf16 v[64:67], a[248:251], a[216:219], v[64:67]
    ds_read_b64_tr_b16 a[244:245], v45 offset:40960
    v_mfma_f32_16x16x32_bf16 v[68:71], a[248:251], a[220:223], v[68:71]
    ds_read_b64_tr_b16 a[246:247], v45 offset:43008
    v_mfma_f32_16x16x32_bf16 v[72:75], a[252:255], a[216:219], v[72:75]
    ds_read_b64_tr_b16 a[248:249], v42 offset:40960
    v_mfma_f32_16x16x32_bf16 v[76:79], a[252:255], a[220:223], v[76:79]
    ds_read_b64_tr_b16 a[250:251], v42 offset:43008
    s_waitcnt lgkmcnt(10)
    v_mfma_f32_16x16x32_bf16 v[80:83], a[224:227], a[216:219], v[80:83]
    ds_read_b64_tr_b16 a[252:253], v43 offset:40960
    v_mfma_f32_16x16x32_bf16 v[84:87], a[224:227], a[220:223], v[84:87]
    ds_read_b64_tr_b16 a[254:255], v43 offset:43008
    s_waitcnt vmcnt(9)
    s_waitcnt lgkmcnt(0)
    s_barrier
    s_waitcnt vmcnt(6)
    v_cmp_eq_u32 vcc, 0, v59
    s_nop 1
    s_cmp_eq_u64 vcc, 0
    s_cselect_b32 s33, 1, 0
    s_cselect_b32 s5, s5, 67108864
    ds_read_b128 a[192:195], v25 offset:0
    ds_read_b128 a[196:199], v25 offset:2048
    ds_read_b128 a[200:203], v19 offset:0
    ds_read_b128 a[204:207], v19 offset:2048
    v_mfma_f32_16x16x32_bf16 v[144:147], a[228:231], v[60:63], v[144:147]
    ds_read_b64_tr_b16 a[224:225], v26 offset:0
    buffer_load_dwordx4 a[0:3], v200, s[60:63], s5 offen offset:0
    v_mfma_f32_16x16x32_bf16 v[128:131], a[216:219], a[216:219], v[128:131]
    ds_read_b64_tr_b16 a[226:227], v26 offset:2048
    s_waitcnt lgkmcnt(10)
    v_mfma_f32_16x16x32_bf16 v[88:91], a[232:235], a[216:219], v[88:91]
    ds_read_b64_tr_b16 a[228:229], v27 offset:0
    v_mfma_f32_16x16x32_bf16 v[92:95], a[232:235], a[220:223], v[92:95]
    ds_read_b64_tr_b16 a[230:231], v27 offset:2048
    v_mfma_f32_16x16x32_bf16 v[96:99], a[236:239], a[216:219], v[96:99]
    ds_read_b64_tr_b16 a[232:233], v28 offset:0
    buffer_load_dwordx4 a[4:7], v200, s[60:63], s5 offen offset:1024
    v_mfma_f32_16x16x32_bf16 v[100:103], a[236:239], a[220:223], v[100:103]
    ds_read_b64_tr_b16 a[234:235], v28 offset:2048
    v_mfma_f32_16x16x32_bf16 v[136:139], v[60:63], a[216:219], v[136:139]
    s_waitcnt lgkmcnt(10)
    v_mfma_f32_16x16x32_bf16 v[104:107], a[240:243], a[216:219], v[104:107]
    ds_read_b64_tr_b16 a[236:237], v34 offset:0
    v_mfma_f32_16x16x32_bf16 v[108:111], a[240:243], a[220:223], v[108:111]
    ds_read_b64_tr_b16 a[238:239], v34 offset:2048
    buffer_load_dwordx4 a[8:11], v200, s[60:63], s5 offen offset:2048
    v_mfma_f32_16x16x32_bf16 v[148:151], a[244:247], v[60:63], v[148:151]
    ds_read_b64_tr_b16 a[240:241], v29 offset:0
    v_mfma_f32_16x16x32_bf16 v[132:135], a[220:223], a[220:223], v[132:135]
    ds_read_b64_tr_b16 a[242:243], v29 offset:2048
    s_waitcnt lgkmcnt(10)
    v_mfma_f32_16x16x32_bf16 v[112:115], a[248:251], a[216:219], v[112:115]
    ds_read_b64_tr_b16 a[244:245], v30 offset:0
    v_mfma_f32_16x16x32_bf16 v[116:119], a[248:251], a[220:223], v[116:119]
    ds_read_b64_tr_b16 a[246:247], v30 offset:2048
    buffer_load_dwordx4 a[12:15], v200, s[60:63], s5 offen offset:3072
    v_mfma_f32_16x16x32_bf16 v[120:123], a[252:255], a[216:219], v[120:123]
    ds_read_b64_tr_b16 a[248:249], v31 offset:0
    s_add_u32 s5, s5, 4096
    v_mfma_f32_16x16x32_bf16 v[124:127], a[252:255], a[220:223], v[124:127]
    ds_read_b64_tr_b16 a[250:251], v31 offset:2048
    v_mfma_f32_16x16x32_bf16 v[140:143], v[60:63], a[220:223], v[140:143]
    s_waitcnt lgkmcnt(10)
    v_mfma_f32_16x16x32_bf16 v[64:67], a[224:227], a[192:195], v[64:67]
    ds_read_b64_tr_b16 a[252:253], v35 offset:0
    buffer_load_dwordx4 a[16:19], v200, s[60:63], s5 offen offset:0
    v_mfma_f32_16x16x32_bf16 v[68:71], a[224:227], a[196:199], v[68:71]
    ds_read_b64_tr_b16 a[254:255], v35 offset:2048
    v_mfma_f32_16x16x32_bf16 v[72:75], a[228:231], a[192:195], v[72:75]
    ds_read_b64_tr_b16 a[224:225], v32 offset:0
    v_mfma_f32_16x16x32_bf16 v[76:79], a[228:231], a[196:199], v[76:79]
    ds_read_b64_tr_b16 a[226:227], v32 offset:2048
    s_waitcnt lgkmcnt(10)
    v_mfma_f32_16x16x32_bf16 v[80:83], a[232:235], a[192:195], v[80:83]
    ds_read_b64_tr_b16 a[228:229], v33 offset:0
    buffer_load_dwordx4 a[20:23], v200, s[60:63], s5 offen offset:1024
    v_mfma_f32_16x16x32_bf16 v[84:87], a[232:235], a[196:199], v[84:87]
    ds_read_b64_tr_b16 a[230:231], v33 offset:2048
    v_mfma_f32_16x16x32_bf16 v[144:147], a[236:239], v[60:63], v[144:147]
    ds_read_b64_tr_b16 a[232:233], v26 offset:8192
    v_mfma_f32_16x16x32_bf16 v[128:131], a[192:195], a[192:195], v[128:131]
    ds_read_b64_tr_b16 a[234:235], v26 offset:10240
    s_waitcnt lgkmcnt(10)
    v_mfma_f32_16x16x32_bf16 v[88:91], a[240:243], a[192:195], v[88:91]
    ds_read_b64_tr_b16 a[236:237], v27 offset:8192
    buffer_load_dwordx4 a[24:27], v200, s[60:63], s5 offen offset:2048
    v_mfma_f32_16x16x32_bf16 v[92:95], a[240:243], a[196:199], v[92:95]
    ds_read_b64_tr_b16 a[238:239], v27 offset:10240
    v_mfma_f32_16x16x32_bf16 v[96:99], a[244:247], a[192:195], v[96:99]
    ds_read_b64_tr_b16 a[240:241], v28 offset:8192
    v_mfma_f32_16x16x32_bf16 v[100:103], a[244:247], a[196:199], v[100:103]
    ds_read_b64_tr_b16 a[242:243], v28 offset:10240
    v_mfma_f32_16x16x32_bf16 v[136:139], v[60:63], a[192:195], v[136:139]
    s_waitcnt lgkmcnt(10)
    buffer_load_dwordx4 a[28:31], v200, s[60:63], s5 offen offset:3072
    v_mfma_f32_16x16x32_bf16 v[104:107], a[248:251], a[192:195], v[104:107]
    ds_read_b64_tr_b16 a[244:245], v34 offset:8192
    s_add_u32 s5, s5, 4096
    v_mfma_f32_16x16x32_bf16 v[108:111], a[248:251], a[196:199], v[108:111]
    ds_read_b64_tr_b16 a[246:247], v34 offset:10240
    v_mfma_f32_16x16x32_bf16 v[148:151], a[252:255], v[60:63], v[148:151]
    ds_read_b64_tr_b16 a[248:249], v29 offset:8192
    v_mfma_f32_16x16x32_bf16 v[132:135], a[196:199], a[196:199], v[132:135]
    ds_read_b64_tr_b16 a[250:251], v29 offset:10240
    s_waitcnt lgkmcnt(10)
    v_mfma_f32_16x16x32_bf16 v[112:115], a[224:227], a[192:195], v[112:115]
    ds_read_b64_tr_b16 a[252:253], v30 offset:8192
    buffer_load_dwordx4 a[32:35], v200, s[60:63], s5 offen offset:0
    v_mfma_f32_16x16x32_bf16 v[116:119], a[224:227], a[196:199], v[116:119]
    ds_read_b64_tr_b16 a[254:255], v30 offset:10240
    v_mfma_f32_16x16x32_bf16 v[120:123], a[228:231], a[192:195], v[120:123]
    ds_read_b64_tr_b16 a[224:225], v31 offset:8192
    v_mfma_f32_16x16x32_bf16 v[124:127], a[228:231], a[196:199], v[124:127]
    ds_read_b64_tr_b16 a[226:227], v31 offset:10240
    v_mfma_f32_16x16x32_bf16 v[140:143], v[60:63], a[196:199], v[140:143]
    s_waitcnt lgkmcnt(10)
    buffer_load_dwordx4 a[36:39], v200, s[60:63], s5 offen offset:1024
    v_mfma_f32_16x16x32_bf16 v[64:67], a[232:235], a[200:203], v[64:67]
    ds_read_b64_tr_b16 a[228:229], v35 offset:8192
    v_mfma_f32_16x16x32_bf16 v[68:71], a[232:235], a[204:207], v[68:71]
    ds_read_b64_tr_b16 a[230:231], v35 offset:10240
    v_mfma_f32_16x16x32_bf16 v[72:75], a[236:239], a[200:203], v[72:75]
    ds_read_b64_tr_b16 a[232:233], v32 offset:8192
    v_mfma_f32_16x16x32_bf16 v[76:79], a[236:239], a[204:207], v[76:79]
    ds_read_b64_tr_b16 a[234:235], v32 offset:10240
    s_waitcnt lgkmcnt(10)
    v_mfma_f32_16x16x32_bf16 v[80:83], a[240:243], a[200:203], v[80:83]
    ds_read_b64_tr_b16 a[236:237], v33 offset:8192
    v_mfma_f32_16x16x32_bf16 v[84:87], a[240:243], a[204:207], v[84:87]
    ds_read_b64_tr_b16 a[238:239], v33 offset:10240
    s_waitcnt vmcnt(10)
    s_waitcnt lgkmcnt(0)
    s_barrier
    ds_read_b128 a[208:211], v25 offset:32768
    ds_read_b128 a[212:215], v25 offset:34816
    ds_read_b128 a[216:219], v19 offset:32768
    ds_read_b128 a[220:223], v19 offset:34816
    v_mfma_f32_16x16x32_bf16 v[144:147], a[244:247], v[60:63], v[144:147]
    ds_read_b64_tr_b16 a[240:241], v34 offset:32768
    buffer_load_dwordx4 a[40:43], v200, s[60:63], s5 offen offset:2048
    v_mfma_f32_16x16x32_bf16 v[128:131], a[200:203], a[200:203], v[128:131]
    ds_read_b64_tr_b16 a[242:243], v34 offset:34816
    s_waitcnt lgkmcnt(10)
    v_mfma_f32_16x16x32_bf16 v[88:91], a[248:251], a[200:203], v[88:91]
    ds_read_b64_tr_b16 a[244:245], v35 offset:32768
    v_mfma_f32_16x16x32_bf16 v[92:95], a[248:251], a[204:207], v[92:95]
    ds_read_b64_tr_b16 a[246:247], v35 offset:34816
    v_mfma_f32_16x16x32_bf16 v[96:99], a[252:255], a[200:203], v[96:99]
    ds_read_b64_tr_b16 a[248:249], v34 offset:40960
    buffer_load_dwordx4 a[44:47], v200, s[60:63], s5 offen offset:3072
    v_mfma_f32_16x16x32_bf16 v[100:103], a[252:255], a[204:207], v[100:103]
    ds_read_b64_tr_b16 a[250:251], v34 offset:43008
    s_add_u32 s5, s5, 4096
    v_mfma_f32_16x16x32_bf16 v[136:139], v[60:63], a[200:203], v[136:139]
    s_waitcnt lgkmcnt(10)
    v_mfma_f32_16x16x32_bf16 v[104:107], a[224:227], a[200:203], v[104:107]
    ds_read_b64_tr_b16 a[252:253], v35 offset:40960
    v_mfma_f32_16x16x32_bf16 v[108:111], a[224:227], a[204:207], v[108:111]
    ds_read_b64_tr_b16 a[254:255], v35 offset:43008
    buffer_load_dwordx4 a[48:51], v200, s[60:63], s5 offen offset:0
    v_mfma_f32_16x16x32_bf16 v[148:151], a[228:231], v[60:63], v[148:151]
    ds_read_b64_tr_b16 a[224:225], v26 offset:32768
    v_mfma_f32_16x16x32_bf16 v[132:135], a[204:207], a[204:207], v[132:135]
    ds_read_b64_tr_b16 a[226:227], v26 offset:34816
    s_waitcnt lgkmcnt(10)
    v_mfma_f32_16x16x32_bf16 v[112:115], a[232:235], a[200:203], v[112:115]
    ds_read_b64_tr_b16 a[228:229], v27 offset:32768
    v_mfma_f32_16x16x32_bf16 v[116:119], a[232:235], a[204:207], v[116:119]
    ds_read_b64_tr_b16 a[230:231], v27 offset:34816
    buffer_load_dwordx4 a[52:55], v200, s[60:63], s5 offen offset:1024
    v_mfma_f32_16x16x32_bf16 v[120:123], a[236:239], a[200:203], v[120:123]
    ds_read_b64_tr_b16 a[232:233], v28 offset:32768
    v_mfma_f32_16x16x32_bf16 v[124:127], a[236:239], a[204:207], v[124:127]
    ds_read_b64_tr_b16 a[234:235], v28 offset:34816
    v_mfma_f32_16x16x32_bf16 v[140:143], v[60:63], a[204:207], v[140:143]
    s_waitcnt lgkmcnt(10)
    v_mfma_f32_16x16x32_bf16 v[144:147], a[240:243], v[60:63], v[144:147]
    ds_read_b64_tr_b16 a[236:237], v29 offset:32768
    buffer_load_dwordx4 a[56:59], v200, s[60:63], s5 offen offset:2048
    v_mfma_f32_16x16x32_bf16 v[128:131], a[208:211], a[208:211], v[128:131]
    ds_read_b64_tr_b16 a[238:239], v29 offset:34816
    v_mfma_f32_16x16x32_bf16 v[136:139], v[60:63], a[208:211], v[136:139]
    v_mfma_f32_16x16x32_bf16 v[148:151], a[244:247], v[60:63], v[148:151]
    ds_read_b64_tr_b16 a[240:241], v30 offset:32768
    v_mfma_f32_16x16x32_bf16 v[132:135], a[212:215], a[212:215], v[132:135]
    ds_read_b64_tr_b16 a[242:243], v30 offset:34816
    buffer_load_dwordx4 a[60:63], v200, s[60:63], s5 offen offset:3072
    v_mfma_f32_16x16x32_bf16 v[140:143], v[60:63], a[212:215], v[140:143]
    s_waitcnt lgkmcnt(10)
    s_add_u32 s5, s5, 4096
    v_mfma_f32_16x16x32_bf16 v[144:147], a[248:251], v[60:63], v[144:147]
    ds_read_b64_tr_b16 a[244:245], v31 offset:32768
    v_mfma_f32_16x16x32_bf16 v[128:131], a[216:219], a[216:219], v[128:131]
    ds_read_b64_tr_b16 a[246:247], v31 offset:34816
    v_mfma_f32_16x16x32_bf16 v[136:139], v[60:63], a[216:219], v[136:139]
    buffer_load_dwordx4 a[64:67], v200, s[60:63], s5 offen offset:0
    v_mfma_f32_16x16x32_bf16 v[148:151], a[252:255], v[60:63], v[148:151]
    ds_read_b64_tr_b16 a[248:249], v32 offset:32768
    v_mfma_f32_16x16x32_bf16 v[132:135], a[220:223], a[220:223], v[132:135]
    ds_read_b64_tr_b16 a[250:251], v32 offset:34816
    v_mfma_f32_16x16x32_bf16 v[140:143], v[60:63], a[220:223], v[140:143]
    s_waitcnt lgkmcnt(10)
    v_mfma_f32_16x16x32_bf16 v[64:67], a[224:227], a[208:211], v[64:67]
    ds_read_b64_tr_b16 a[252:253], v33 offset:32768
    buffer_load_dwordx4 a[68:71], v200, s[60:63], s5 offen offset:1024
    v_mfma_f32_16x16x32_bf16 v[68:71], a[224:227], a[212:215], v[68:71]
    ds_read_b64_tr_b16 a[254:255], v33 offset:34816
    v_mfma_f32_16x16x32_bf16 v[72:75], a[228:231], a[208:211], v[72:75]
    ds_read_b64_tr_b16 a[224:225], v26 offset:40960
    v_mfma_f32_16x16x32_bf16 v[76:79], a[228:231], a[212:215], v[76:79]
    ds_read_b64_tr_b16 a[226:227], v26 offset:43008
    s_waitcnt lgkmcnt(10)
    v_mfma_f32_16x16x32_bf16 v[80:83], a[232:235], a[208:211], v[80:83]
    ds_read_b64_tr_b16 a[228:229], v27 offset:40960
    buffer_load_dwordx4 a[72:75], v200, s[60:63], s5 offen offset:2048
    v_mfma_f32_16x16x32_bf16 v[84:87], a[232:235], a[212:215], v[84:87]
    ds_read_b64_tr_b16 a[230:231], v27 offset:43008
    v_mfma_f32_16x16x32_bf16 v[88:91], a[236:239], a[208:211], v[88:91]
    ds_read_b64_tr_b16 a[232:233], v28 offset:40960
    v_mfma_f32_16x16x32_bf16 v[92:95], a[236:239], a[212:215], v[92:95]
    ds_read_b64_tr_b16 a[234:235], v28 offset:43008
    s_waitcnt lgkmcnt(10)
    v_mfma_f32_16x16x32_bf16 v[96:99], a[240:243], a[208:211], v[96:99]
    ds_read_b64_tr_b16 a[236:237], v29 offset:40960
    buffer_load_dwordx4 a[76:79], v200, s[60:63], s5 offen offset:3072
    v_mfma_f32_16x16x32_bf16 v[100:103], a[240:243], a[212:215], v[100:103]
    ds_read_b64_tr_b16 a[238:239], v29 offset:43008
    ds_write_b128 v9, v[144:147]
    v_mfma_f32_16x16x32_bf16 v[104:107], a[244:247], a[208:211], v[104:107]
    ds_read_b64_tr_b16 a[240:241], v30 offset:40960
    ds_write_b128 v9, v[148:151] offset:256
    v_mfma_f32_16x16x32_bf16 v[108:111], a[244:247], a[212:215], v[108:111]
    ds_read_b64_tr_b16 a[242:243], v30 offset:43008
    s_waitcnt lgkmcnt(10)
    v_mfma_f32_16x16x32_bf16 v[112:115], a[248:251], a[208:211], v[112:115]
    ds_read_b64_tr_b16 a[244:245], v31 offset:40960
    v_cndmask_b32 v128, v128, v129, s[64:65]
    v_mfma_f32_16x16x32_bf16 v[116:119], a[248:251], a[212:215], v[116:119]
    ds_read_b64_tr_b16 a[246:247], v31 offset:43008
    v_cndmask_b32 v128, v128, v130, s[66:67]
    v_mfma_f32_16x16x32_bf16 v[120:123], a[252:255], a[208:211], v[120:123]
    ds_read_b64_tr_b16 a[248:249], v32 offset:40960
    v_cndmask_b32 v128, v128, v131, s[68:69]
    v_mfma_f32_16x16x32_bf16 v[124:127], a[252:255], a[212:215], v[124:127]
    ds_read_b64_tr_b16 a[250:251], v32 offset:43008
    s_waitcnt lgkmcnt(10)
    v_mfma_f32_16x16x32_bf16 v[64:67], a[224:227], a[216:219], v[64:67]
    ds_read_b64_tr_b16 a[252:253], v33 offset:40960
    ds_bpermute_b32 v129, v17, v128
    v_mfma_f32_16x16x32_bf16 v[68:71], a[224:227], a[220:223], v[68:71]
    ds_read_b64_tr_b16 a[254:255], v33 offset:43008
    v_cndmask_b32 v132, v132, v133, s[64:65]
    v_mfma_f32_16x16x32_bf16 v[72:75], a[228:231], a[216:219], v[72:75]
    v_cndmask_b32 v132, v132, v134, s[66:67]
    v_cndmask_b32 v132, v132, v135, s[68:69]
    v_mfma_f32_16x16x32_bf16 v[76:79], a[228:231], a[220:223], v[76:79]
    ds_bpermute_b32 v133, v17, v132
    v_mul_f32 v136, 0x3acccccd, v136
    v_mfma_f32_16x16x32_bf16 v[80:83], a[232:235], a[216:219], v[80:83]
    v_mul_f32 v140, 0x3acccccd, v140
    s_waitcnt lgkmcnt(2)
    v_mul_f32 v129, 0x3acccccd, v129
    v_mfma_f32_16x16x32_bf16 v[84:87], a[232:235], a[220:223], v[84:87]
    s_waitcnt lgkmcnt(0)
    v_mul_f32 v133, 0x3acccccd, v133
    v_fma_f32 v129, -v136, v136, v129
    v_mfma_f32_16x16x32_bf16 v[88:91], a[236:239], a[216:219], v[88:91]
    v_fma_f32 v133, -v140, v140, v133
    v_max_f32 v129, 0, v129
    v_mfma_f32_16x16x32_bf16 v[92:95], a[236:239], a[220:223], v[92:95]
    v_max_f32 v133, 0, v133
    v_cvt_pk_bf16_f32 v52, v136, v136
    v_mfma_f32_16x16x32_bf16 v[96:99], a[240:243], a[216:219], v[96:99]
    v_cvt_pk_bf16_f32 v53, v140, v140
    v_and_b32 v52, 0xffff0000, v52
    v_mfma_f32_16x16x32_bf16 v[100:103], a[240:243], a[220:223], v[100:103]
    v_and_b32 v53, 0xffff0000, v53
    v_cvt_pk_bf16_f32 v56, v129, v129
    v_mfma_f32_16x16x32_bf16 v[104:107], a[244:247], a[216:219], v[104:107]
    v_cvt_pk_bf16_f32 v57, v133, v133
    v_and_b32 v56, 0xffff0000, v56
    v_mfma_f32_16x16x32_bf16 v[108:111], a[244:247], a[220:223], v[108:111]
    v_and_b32 v57, 0xffff0000, v57
    v_add_f32 v56, 0x3727c5ac, v56
    v_mfma_f32_16x16x32_bf16 v[112:115], a[248:251], a[216:219], v[112:115]
    v_add_f32 v57, 0x3727c5ac, v57
    v_cvt_pk_bf16_f32 v56, v56, v56
    v_mfma_f32_16x16x32_bf16 v[116:119], a[248:251], a[220:223], v[116:119]
    v_cvt_pk_bf16_f32 v57, v57, v57
    v_and_b32 v56, 0xffff0000, v56
    v_mfma_f32_16x16x32_bf16 v[120:123], a[252:255], a[216:219], v[120:123]
    v_and_b32 v57, 0xffff0000, v57
    v_sqrt_f32 v56, v56
    v_mfma_f32_16x16x32_bf16 v[124:127], a[252:255], a[220:223], v[124:127]
    v_sqrt_f32 v57, v57
    v_cvt_pk_bf16_f32 v56, v56, v56
    v_cvt_pk_bf16_f32 v57, v57, v57
    v_and_b32 v56, 0xffff0000, v56
    v_and_b32 v57, 0xffff0000, v57
    v_rcp_f32 v54, v56
    v_rcp_f32 v55, v57
    v_mul_f32 v52, v52, v54
    v_mul_f32 v53, v53, v55
    v_mov_b32 v20, v52
    v_mov_b32 v22, v53
    v_mov_b32 v24, v54
    v_mov_b32 v26, v55
    v_mov_b32 v56, 0x358637bd
    v_mov_b32 v58, 0x3fb8aa3b
    s_waitcnt lgkmcnt(0)
    s_barrier
    ds_read_b128 v[128:131], v8 offset:0
    ds_read_b128 v[132:135], v8 offset:64
    ds_read_b128 v[136:139], v8 offset:128
    ds_read_b128 v[140:143], v8 offset:192
    ds_read_b128 v[144:147], v8 offset:256
    ds_read_b128 v[148:151], v8 offset:320
    ds_read_b128 v[152:155], v8 offset:384
    ds_read_b128 v[156:159], v8 offset:448
    s_waitcnt lgkmcnt(7)
    v_pk_fma_f32 v[28:29], v[128:129], v[20:21], v[56:57] op_sel_hi:[1,0,0] neg_lo:[1,0,0] neg_hi:[1,0,0]
    v_pk_fma_f32 v[32:33], v[128:129], v[22:23], v[56:57] op_sel_hi:[1,0,0] neg_lo:[1,0,0] neg_hi:[1,0,0]
    v_pk_fma_f32 v[30:31], v[130:131], v[20:21], v[56:57] op_sel_hi:[1,0,0] neg_lo:[1,0,0] neg_hi:[1,0,0]
    v_pk_fma_f32 v[34:35], v[130:131], v[22:23], v[56:57] op_sel_hi:[1,0,0] neg_lo:[1,0,0] neg_hi:[1,0,0]
    v_pk_fma_f32 v[64:65], v[64:65], v[24:25], v[28:29] op_sel_hi:[1,0,1]
    v_pk_fma_f32 v[68:69], v[68:69], v[26:27], v[32:33] op_sel_hi:[1,0,1]
    v_pk_fma_f32 v[66:67], v[66:67], v[24:25], v[30:31] op_sel_hi:[1,0,1]
    v_pk_fma_f32 v[70:71], v[70:71], v[26:27], v[34:35] op_sel_hi:[1,0,1]
    v_pk_mul_f32 v[28:29], v[64:65], v[58:59] op_sel_hi:[1,0]
    v_pk_mul_f32 v[32:33], v[68:69], v[58:59] op_sel_hi:[1,0]
    v_pk_mul_f32 v[30:31], v[66:67], v[58:59] op_sel_hi:[1,0]
    v_pk_mul_f32 v[34:35], v[70:71], v[58:59] op_sel_hi:[1,0]
    v_exp_f32 v28, v28 clamp
    v_exp_f32 v32, v32 clamp
    v_exp_f32 v29, v29 clamp
    v_exp_f32 v33, v33 clamp
    v_exp_f32 v30, v30 clamp
    v_exp_f32 v34, v34 clamp
    v_exp_f32 v31, v31 clamp
    v_exp_f32 v35, v35 clamp
    v_max_f32 v64, v56, v64
    v_max_f32 v68, v56, v68
    v_max_f32 v65, v56, v65
    v_max_f32 v69, v56, v69
    v_max_f32 v66, v56, v66
    v_max_f32 v70, v56, v70
    v_max_f32 v67, v56, v67
    v_max_f32 v71, v56, v71
    v_pk_add_f32 v[64:65], v[64:65], v[28:29]
    v_pk_add_f32 v[68:69], v[68:69], v[32:33]
    v_pk_add_f32 v[66:67], v[66:67], v[30:31]
    v_pk_add_f32 v[70:71], v[70:71], v[34:35]
    v_cvt_pk_bf16_f32 v64, v64, v65
    v_cvt_pk_bf16_f32 v68, v68, v69
    v_cvt_pk_bf16_f32 v65, v66, v67
    v_cvt_pk_bf16_f32 v69, v70, v71
    buffer_store_dwordx2 v[64:65], v160, s[56:59], s34 offen sc1
    buffer_store_dwordx2 v[68:69], v161, s[56:59], s34 offen sc1
    s_waitcnt lgkmcnt(6)
    v_pk_fma_f32 v[28:29], v[132:133], v[20:21], v[56:57] op_sel_hi:[1,0,0] neg_lo:[1,0,0] neg_hi:[1,0,0]
    v_pk_fma_f32 v[32:33], v[132:133], v[22:23], v[56:57] op_sel_hi:[1,0,0] neg_lo:[1,0,0] neg_hi:[1,0,0]
    s_add_u32 s5, s5, 4096
    buffer_load_dwordx4 a[80:83], v200, s[60:63], s5 offen offset:0
    v_pk_fma_f32 v[30:31], v[134:135], v[20:21], v[56:57] op_sel_hi:[1,0,0] neg_lo:[1,0,0] neg_hi:[1,0,0]
    v_pk_fma_f32 v[34:35], v[134:135], v[22:23], v[56:57] op_sel_hi:[1,0,0] neg_lo:[1,0,0] neg_hi:[1,0,0]
    v_pk_fma_f32 v[72:73], v[72:73], v[24:25], v[28:29] op_sel_hi:[1,0,1]
    v_pk_fma_f32 v[76:77], v[76:77], v[26:27], v[32:33] op_sel_hi:[1,0,1]
    v_pk_fma_f32 v[74:75], v[74:75], v[24:25], v[30:31] op_sel_hi:[1,0,1]
    v_pk_fma_f32 v[78:79], v[78:79], v[26:27], v[34:35] op_sel_hi:[1,0,1]
    v_pk_mul_f32 v[28:29], v[72:73], v[58:59] op_sel_hi:[1,0]
    v_pk_mul_f32 v[32:33], v[76:77], v[58:59] op_sel_hi:[1,0]
    v_pk_mul_f32 v[30:31], v[74:75], v[58:59] op_sel_hi:[1,0]
    v_pk_mul_f32 v[34:35], v[78:79], v[58:59] op_sel_hi:[1,0]
    v_exp_f32 v28, v28 clamp
    v_exp_f32 v32, v32 clamp
    v_exp_f32 v29, v29 clamp
    v_exp_f32 v33, v33 clamp
    v_exp_f32 v30, v30 clamp
    v_exp_f32 v34, v34 clamp
    v_exp_f32 v31, v31 clamp
    v_exp_f32 v35, v35 clamp
    v_max_f32 v72, v56, v72
    v_max_f32 v76, v56, v76
    v_max_f32 v73, v56, v73
    v_max_f32 v77, v56, v77
    v_max_f32 v74, v56, v74
    v_max_f32 v78, v56, v78
    v_max_f32 v75, v56, v75
    v_max_f32 v79, v56, v79
    v_pk_add_f32 v[72:73], v[72:73], v[28:29]
    v_pk_add_f32 v[76:77], v[76:77], v[32:33]
    v_pk_add_f32 v[74:75], v[74:75], v[30:31]
    v_pk_add_f32 v[78:79], v[78:79], v[34:35]
    v_cvt_pk_bf16_f32 v72, v72, v73
    v_cvt_pk_bf16_f32 v76, v76, v77
    v_cvt_pk_bf16_f32 v73, v74, v75
    v_cvt_pk_bf16_f32 v77, v78, v79
    buffer_store_dwordx2 v[72:73], v162, s[56:59], s34 offen sc1
    buffer_store_dwordx2 v[76:77], v163, s[56:59], s34 offen sc1
    s_waitcnt lgkmcnt(5)
    v_pk_fma_f32 v[28:29], v[136:137], v[20:21], v[56:57] op_sel_hi:[1,0,0] neg_lo:[1,0,0] neg_hi:[1,0,0]
    v_pk_fma_f32 v[32:33], v[136:137], v[22:23], v[56:57] op_sel_hi:[1,0,0] neg_lo:[1,0,0] neg_hi:[1,0,0]
    v_pk_fma_f32 v[30:31], v[138:139], v[20:21], v[56:57] op_sel_hi:[1,0,0] neg_lo:[1,0,0] neg_hi:[1,0,0]
    v_pk_fma_f32 v[34:35], v[138:139], v[22:23], v[56:57] op_sel_hi:[1,0,0] neg_lo:[1,0,0] neg_hi:[1,0,0]
    buffer_load_dwordx4 a[84:87], v200, s[60:63], s5 offen offset:1024
    v_pk_fma_f32 v[80:81], v[80:81], v[24:25], v[28:29] op_sel_hi:[1,0,1]
    v_pk_fma_f32 v[84:85], v[84:85], v[26:27], v[32:33] op_sel_hi:[1,0,1]
    v_pk_fma_f32 v[82:83], v[82:83], v[24:25], v[30:31] op_sel_hi:[1,0,1]
    v_pk_fma_f32 v[86:87], v[86:87], v[26:27], v[34:35] op_sel_hi:[1,0,1]
    v_pk_mul_f32 v[28:29], v[80:81], v[58:59] op_sel_hi:[1,0]
    v_pk_mul_f32 v[32:33], v[84:85], v[58:59] op_sel_hi:[1,0]
    v_pk_mul_f32 v[30:31], v[82:83], v[58:59] op_sel_hi:[1,0]
    v_pk_mul_f32 v[34:35], v[86:87], v[58:59] op_sel_hi:[1,0]
    v_exp_f32 v28, v28 clamp
    v_exp_f32 v32, v32 clamp
    v_exp_f32 v29, v29 clamp
    v_exp_f32 v33, v33 clamp
    v_exp_f32 v30, v30 clamp
    v_exp_f32 v34, v34 clamp
    v_exp_f32 v31, v31 clamp
    v_exp_f32 v35, v35 clamp
    v_max_f32 v80, v56, v80
    v_max_f32 v84, v56, v84
    v_max_f32 v81, v56, v81
    v_max_f32 v85, v56, v85
    v_max_f32 v82, v56, v82
    v_max_f32 v86, v56, v86
    v_max_f32 v83, v56, v83
    v_max_f32 v87, v56, v87
    v_pk_add_f32 v[80:81], v[80:81], v[28:29]
    v_pk_add_f32 v[84:85], v[84:85], v[32:33]
    v_pk_add_f32 v[82:83], v[82:83], v[30:31]
    v_pk_add_f32 v[86:87], v[86:87], v[34:35]
    v_cvt_pk_bf16_f32 v80, v80, v81
    v_cvt_pk_bf16_f32 v84, v84, v85
    v_cvt_pk_bf16_f32 v81, v82, v83
    v_cvt_pk_bf16_f32 v85, v86, v87
    buffer_store_dwordx2 v[80:81], v164, s[56:59], s34 offen sc1
    buffer_store_dwordx2 v[84:85], v165, s[56:59], s34 offen sc1
    s_waitcnt lgkmcnt(4)
    v_pk_fma_f32 v[28:29], v[140:141], v[20:21], v[56:57] op_sel_hi:[1,0,0] neg_lo:[1,0,0] neg_hi:[1,0,0]
    v_pk_fma_f32 v[32:33], v[140:141], v[22:23], v[56:57] op_sel_hi:[1,0,0] neg_lo:[1,0,0] neg_hi:[1,0,0]
    v_pk_fma_f32 v[30:31], v[142:143], v[20:21], v[56:57] op_sel_hi:[1,0,0] neg_lo:[1,0,0] neg_hi:[1,0,0]
    v_pk_fma_f32 v[34:35], v[142:143], v[22:23], v[56:57] op_sel_hi:[1,0,0] neg_lo:[1,0,0] neg_hi:[1,0,0]
    v_pk_fma_f32 v[88:89], v[88:89], v[24:25], v[28:29] op_sel_hi:[1,0,1]
    v_pk_fma_f32 v[92:93], v[92:93], v[26:27], v[32:33] op_sel_hi:[1,0,1]
    buffer_load_dwordx4 a[88:91], v200, s[60:63], s5 offen offset:2048
    v_pk_fma_f32 v[90:91], v[90:91], v[24:25], v[30:31] op_sel_hi:[1,0,1]
    v_pk_fma_f32 v[94:95], v[94:95], v[26:27], v[34:35] op_sel_hi:[1,0,1]
    v_pk_mul_f32 v[28:29], v[88:89], v[58:59] op_sel_hi:[1,0]
    v_pk_mul_f32 v[32:33], v[92:93], v[58:59] op_sel_hi:[1,0]
    v_pk_mul_f32 v[30:31], v[90:91], v[58:59] op_sel_hi:[1,0]
    v_pk_mul_f32 v[34:35], v[94:95], v[58:59] op_sel_hi:[1,0]
    v_exp_f32 v28, v28 clamp
    v_exp_f32 v32, v32 clamp
    v_exp_f32 v29, v29 clamp
    v_exp_f32 v33, v33 clamp
    v_exp_f32 v30, v30 clamp
    v_exp_f32 v34, v34 clamp
    v_exp_f32 v31, v31 clamp
    v_exp_f32 v35, v35 clamp
    v_max_f32 v88, v56, v88
    v_max_f32 v92, v56, v92
    v_max_f32 v89, v56, v89
    v_max_f32 v93, v56, v93
    v_max_f32 v90, v56, v90
    v_max_f32 v94, v56, v94
    v_max_f32 v91, v56, v91
    v_max_f32 v95, v56, v95
    v_pk_add_f32 v[88:89], v[88:89], v[28:29]
    v_pk_add_f32 v[92:93], v[92:93], v[32:33]
    v_pk_add_f32 v[90:91], v[90:91], v[30:31]
    v_pk_add_f32 v[94:95], v[94:95], v[34:35]
    v_cvt_pk_bf16_f32 v88, v88, v89
    v_cvt_pk_bf16_f32 v92, v92, v93
    v_cvt_pk_bf16_f32 v89, v90, v91
    v_cvt_pk_bf16_f32 v93, v94, v95
    buffer_store_dwordx2 v[88:89], v166, s[56:59], s34 offen sc1
    buffer_store_dwordx2 v[92:93], v167, s[56:59], s34 offen sc1
    s_waitcnt lgkmcnt(3)
    v_pk_fma_f32 v[28:29], v[144:145], v[20:21], v[56:57] op_sel_hi:[1,0,0] neg_lo:[1,0,0] neg_hi:[1,0,0]
    v_pk_fma_f32 v[32:33], v[144:145], v[22:23], v[56:57] op_sel_hi:[1,0,0] neg_lo:[1,0,0] neg_hi:[1,0,0]
    v_pk_fma_f32 v[30:31], v[146:147], v[20:21], v[56:57] op_sel_hi:[1,0,0] neg_lo:[1,0,0] neg_hi:[1,0,0]
    v_pk_fma_f32 v[34:35], v[146:147], v[22:23], v[56:57] op_sel_hi:[1,0,0] neg_lo:[1,0,0] neg_hi:[1,0,0]
    v_pk_fma_f32 v[96:97], v[96:97], v[24:25], v[28:29] op_sel_hi:[1,0,1]
    v_pk_fma_f32 v[100:101], v[100:101], v[26:27], v[32:33] op_sel_hi:[1,0,1]
    v_pk_fma_f32 v[98:99], v[98:99], v[24:25], v[30:31] op_sel_hi:[1,0,1]
    v_pk_fma_f32 v[102:103], v[102:103], v[26:27], v[34:35] op_sel_hi:[1,0,1]
    buffer_load_dwordx4 a[92:95], v200, s[60:63], s5 offen offset:3072
    v_pk_mul_f32 v[28:29], v[96:97], v[58:59] op_sel_hi:[1,0]
    v_pk_mul_f32 v[32:33], v[100:101], v[58:59] op_sel_hi:[1,0]
    v_pk_mul_f32 v[30:31], v[98:99], v[58:59] op_sel_hi:[1,0]
    v_pk_mul_f32 v[34:35], v[102:103], v[58:59] op_sel_hi:[1,0]
    v_exp_f32 v28, v28 clamp
    v_exp_f32 v32, v32 clamp
    v_exp_f32 v29, v29 clamp
    v_exp_f32 v33, v33 clamp
    v_exp_f32 v30, v30 clamp
    v_exp_f32 v34, v34 clamp
    v_exp_f32 v31, v31 clamp
    v_exp_f32 v35, v35 clamp
    v_max_f32 v96, v56, v96
    v_max_f32 v100, v56, v100
    v_max_f32 v97, v56, v97
    v_max_f32 v101, v56, v101
    v_max_f32 v98, v56, v98
    v_max_f32 v102, v56, v102
    v_max_f32 v99, v56, v99
    v_max_f32 v103, v56, v103
    v_pk_add_f32 v[96:97], v[96:97], v[28:29]
    v_pk_add_f32 v[100:101], v[100:101], v[32:33]
    v_pk_add_f32 v[98:99], v[98:99], v[30:31]
    v_pk_add_f32 v[102:103], v[102:103], v[34:35]
    v_cvt_pk_bf16_f32 v96, v96, v97
    v_cvt_pk_bf16_f32 v100, v100, v101
    v_cvt_pk_bf16_f32 v97, v98, v99
    v_cvt_pk_bf16_f32 v101, v102, v103
    buffer_store_dwordx2 v[96:97], v168, s[56:59], s34 offen sc1
    buffer_store_dwordx2 v[100:101], v169, s[56:59], s34 offen sc1
    s_waitcnt lgkmcnt(2)
    v_pk_fma_f32 v[28:29], v[148:149], v[20:21], v[56:57] op_sel_hi:[1,0,0] neg_lo:[1,0,0] neg_hi:[1,0,0]
    v_pk_fma_f32 v[32:33], v[148:149], v[22:23], v[56:57] op_sel_hi:[1,0,0] neg_lo:[1,0,0] neg_hi:[1,0,0]
    v_pk_fma_f32 v[30:31], v[150:151], v[20:21], v[56:57] op_sel_hi:[1,0,0] neg_lo:[1,0,0] neg_hi:[1,0,0]
    v_pk_fma_f32 v[34:35], v[150:151], v[22:23], v[56:57] op_sel_hi:[1,0,0] neg_lo:[1,0,0] neg_hi:[1,0,0]
    v_pk_fma_f32 v[104:105], v[104:105], v[24:25], v[28:29] op_sel_hi:[1,0,1]
    v_pk_fma_f32 v[108:109], v[108:109], v[26:27], v[32:33] op_sel_hi:[1,0,1]
    v_pk_fma_f32 v[106:107], v[106:107], v[24:25], v[30:31] op_sel_hi:[1,0,1]
    v_pk_fma_f32 v[110:111], v[110:111], v[26:27], v[34:35] op_sel_hi:[1,0,1]
    v_pk_mul_f32 v[28:29], v[104:105], v[58:59] op_sel_hi:[1,0]
    v_pk_mul_f32 v[32:33], v[108:109], v[58:59] op_sel_hi:[1,0]
    s_add_u32 s5, s5, 4096
    buffer_load_dwordx4 a[96:99], v200, s[60:63], s5 offen offset:0
    v_pk_mul_f32 v[30:31], v[106:107], v[58:59] op_sel_hi:[1,0]
    v_pk_mul_f32 v[34:35], v[110:111], v[58:59] op_sel_hi:[1,0]
    v_exp_f32 v28, v28 clamp
    v_exp_f32 v32, v32 clamp
    v_exp_f32 v29, v29 clamp
    v_exp_f32 v33, v33 clamp
    v_exp_f32 v30, v30 clamp
    v_exp_f32 v34, v34 clamp
    v_exp_f32 v31, v31 clamp
    v_exp_f32 v35, v35 clamp
    v_max_f32 v104, v56, v104
    v_max_f32 v108, v56, v108
    v_max_f32 v105, v56, v105
    v_max_f32 v109, v56, v109
    v_max_f32 v106, v56, v106
    v_max_f32 v110, v56, v110
    v_max_f32 v107, v56, v107
    v_max_f32 v111, v56, v111
    v_pk_add_f32 v[104:105], v[104:105], v[28:29]
    v_pk_add_f32 v[108:109], v[108:109], v[32:33]
    v_pk_add_f32 v[106:107], v[106:107], v[30:31]
    v_pk_add_f32 v[110:111], v[110:111], v[34:35]
    v_cvt_pk_bf16_f32 v104, v104, v105
    v_cvt_pk_bf16_f32 v108, v108, v109
    v_cvt_pk_bf16_f32 v105, v106, v107
    v_cvt_pk_bf16_f32 v109, v110, v111
    buffer_store_dwordx2 v[104:105], v170, s[56:59], s34 offen sc1
    buffer_store_dwordx2 v[108:109], v171, s[56:59], s34 offen sc1
    s_waitcnt lgkmcnt(1)
    v_pk_fma_f32 v[28:29], v[152:153], v[20:21], v[56:57] op_sel_hi:[1,0,0] neg_lo:[1,0,0] neg_hi:[1,0,0]
    v_pk_fma_f32 v[32:33], v[152:153], v[22:23], v[56:57] op_sel_hi:[1,0,0] neg_lo:[1,0,0] neg_hi:[1,0,0]
    v_pk_fma_f32 v[30:31], v[154:155], v[20:21], v[56:57] op_sel_hi:[1,0,0] neg_lo:[1,0,0] neg_hi:[1,0,0]
    v_pk_fma_f32 v[34:35], v[154:155], v[22:23], v[56:57] op_sel_hi:[1,0,0] neg_lo:[1,0,0] neg_hi:[1,0,0]
    v_pk_fma_f32 v[112:113], v[112:113], v[24:25], v[28:29] op_sel_hi:[1,0,1]
    v_pk_fma_f32 v[116:117], v[116:117], v[26:27], v[32:33] op_sel_hi:[1,0,1]
    v_pk_fma_f32 v[114:115], v[114:115], v[24:25], v[30:31] op_sel_hi:[1,0,1]
    v_pk_fma_f32 v[118:119], v[118:119], v[26:27], v[34:35] op_sel_hi:[1,0,1]
    v_pk_mul_f32 v[28:29], v[112:113], v[58:59] op_sel_hi:[1,0]
    v_pk_mul_f32 v[32:33], v[116:117], v[58:59] op_sel_hi:[1,0]
    v_pk_mul_f32 v[30:31], v[114:115], v[58:59] op_sel_hi:[1,0]
    v_pk_mul_f32 v[34:35], v[118:119], v[58:59] op_sel_hi:[1,0]
    buffer_load_dwordx4 a[100:103], v200, s[60:63], s5 offen offset:1024
    v_exp_f32 v28, v28 clamp
    v_exp_f32 v32, v32 clamp
    v_exp_f32 v29, v29 clamp
    v_exp_f32 v33, v33 clamp
    v_exp_f32 v30, v30 clamp
    v_exp_f32 v34, v34 clamp
    v_exp_f32 v31, v31 clamp
    v_exp_f32 v35, v35 clamp
    v_max_f32 v112, v56, v112
    v_max_f32 v116, v56, v116
    v_max_f32 v113, v56, v113
    v_max_f32 v117, v56, v117
    v_max_f32 v114, v56, v114
    v_max_f32 v118, v56, v118
    v_max_f32 v115, v56, v115
    v_max_f32 v119, v56, v119
    v_pk_add_f32 v[112:113], v[112:113], v[28:29]
    v_pk_add_f32 v[116:117], v[116:117], v[32:33]
    v_pk_add_f32 v[114:115], v[114:115], v[30:31]
    v_pk_add_f32 v[118:119], v[118:119], v[34:35]
    v_cvt_pk_bf16_f32 v112, v112, v113
    v_cvt_pk_bf16_f32 v116, v116, v117
    v_cvt_pk_bf16_f32 v113, v114, v115
    v_cvt_pk_bf16_f32 v117, v118, v119
    buffer_store_dwordx2 v[112:113], v172, s[56:59], s34 offen sc1
    buffer_store_dwordx2 v[116:117], v173, s[56:59], s34 offen sc1
    s_waitcnt lgkmcnt(0)
    v_pk_fma_f32 v[28:29], v[156:157], v[20:21], v[56:57] op_sel_hi:[1,0,0] neg_lo:[1,0,0] neg_hi:[1,0,0]
    v_pk_fma_f32 v[32:33], v[156:157], v[22:23], v[56:57] op_sel_hi:[1,0,0] neg_lo:[1,0,0] neg_hi:[1,0,0]
    v_pk_fma_f32 v[30:31], v[158:159], v[20:21], v[56:57] op_sel_hi:[1,0,0] neg_lo:[1,0,0] neg_hi:[1,0,0]
    v_pk_fma_f32 v[34:35], v[158:159], v[22:23], v[56:57] op_sel_hi:[1,0,0] neg_lo:[1,0,0] neg_hi:[1,0,0]
    v_pk_fma_f32 v[120:121], v[120:121], v[24:25], v[28:29] op_sel_hi:[1,0,1]
    v_pk_fma_f32 v[124:125], v[124:125], v[26:27], v[32:33] op_sel_hi:[1,0,1]
    v_pk_fma_f32 v[122:123], v[122:123], v[24:25], v[30:31] op_sel_hi:[1,0,1]
    v_pk_fma_f32 v[126:127], v[126:127], v[26:27], v[34:35] op_sel_hi:[1,0,1]
    v_pk_mul_f32 v[28:29], v[120:121], v[58:59] op_sel_hi:[1,0]
    v_pk_mul_f32 v[32:33], v[124:125], v[58:59] op_sel_hi:[1,0]
    v_pk_mul_f32 v[30:31], v[122:123], v[58:59] op_sel_hi:[1,0]
    v_pk_mul_f32 v[34:35], v[126:127], v[58:59] op_sel_hi:[1,0]
    v_exp_f32 v28, v28 clamp
    v_exp_f32 v32, v32 clamp
    buffer_load_dwordx4 a[104:107], v200, s[60:63], s5 offen offset:2048
    v_exp_f32 v29, v29 clamp
    v_exp_f32 v33, v33 clamp
    v_exp_f32 v30, v30 clamp
    v_exp_f32 v34, v34 clamp
    v_exp_f32 v31, v31 clamp
    v_exp_f32 v35, v35 clamp
    v_max_f32 v120, v56, v120
    v_max_f32 v124, v56, v124
    v_max_f32 v121, v56, v121
    v_max_f32 v125, v56, v125
    v_max_f32 v122, v56, v122
    v_max_f32 v126, v56, v126
    v_max_f32 v123, v56, v123
    v_max_f32 v127, v56, v127
    v_pk_add_f32 v[120:121], v[120:121], v[28:29]
    v_pk_add_f32 v[124:125], v[124:125], v[32:33]
    v_pk_add_f32 v[122:123], v[122:123], v[30:31]
    v_pk_add_f32 v[126:127], v[126:127], v[34:35]
    v_cvt_pk_bf16_f32 v120, v120, v121
    v_cvt_pk_bf16_f32 v124, v124, v125
    v_cvt_pk_bf16_f32 v121, v122, v123
    v_cvt_pk_bf16_f32 v125, v126, v127
    buffer_store_dwordx2 v[120:121], v174, s[56:59], s34 offen sc1
    buffer_store_dwordx2 v[124:125], v175, s[56:59], s34 offen sc1
    s_add_u32 s44, s26, 20072448
    s_addc_u32 s45, s27, 0
    s_mov_b32 s46, 98304
    s_mov_b32 s47, 0x20000
    s_mul_i32 s4, s30, 5
    s_add_u32 s4, s4, s31
    s_lshl_b32 s4, s4, 7
    s_add_u32 s4, s4, 65536
    buffer_load_dwordx4 a[108:111], v200, s[60:63], s5 offen offset:3072
    s_add_u32 s5, s5, 4096
    buffer_load_dwordx4 a[112:115], v200, s[60:63], s5 offen offset:0
    buffer_load_dwordx4 a[116:119], v200, s[60:63], s5 offen offset:1024
    buffer_load_dwordx4 a[120:123], v200, s[60:63], s5 offen offset:2048
    buffer_load_dwordx4 a[124:127], v200, s[60:63], s5 offen offset:3072
    s_add_u32 s5, s5, 4096
    buffer_load_dwordx4 a[128:131], v200, s[60:63], s5 offen offset:0
    s_waitcnt vmcnt(6)
    s_barrier
    s_cmp_eq_u32 s3, 0
    s_cbranch_scc0 km_qf
    v_mov_b32 v17, 1
    s_mov_b64 exec, 1
    buffer_store_dword v17, v16, s[44:47], s4 offen sc1
    s_mov_b64 exec, -1
km_qf:
    buffer_load_dwordx4 a[132:135], v200, s[60:63], s5 offen offset:1024
    buffer_load_dwordx4 a[136:139], v200, s[60:63], s5 offen offset:2048
    buffer_load_dwordx4 a[140:143], v200, s[60:63], s5 offen offset:3072
    s_add_u32 s5, s5, 4096
    buffer_load_dwordx4 a[144:147], v200, s[60:63], s5 offen offset:0
    buffer_load_dwordx4 a[148:151], v200, s[60:63], s5 offen offset:1024
    buffer_load_dwordx4 a[152:155], v200, s[60:63], s5 offen offset:2048
    buffer_load_dwordx4 a[156:159], v200, s[60:63], s5 offen offset:3072
    s_add_u32 s5, s5, 4096
    buffer_load_dwordx4 a[160:163], v200, s[60:63], s5 offen offset:0
    buffer_load_dwordx4 a[164:167], v200, s[60:63], s5 offen offset:1024
    buffer_load_dwordx4 a[168:171], v200, s[60:63], s5 offen offset:2048
    buffer_load_dwordx4 a[172:175], v200, s[60:63], s5 offen offset:3072
    s_add_u32 s5, s5, 4096
    buffer_load_dwordx4 a[176:179], v200, s[60:63], s5 offen offset:0
    buffer_load_dwordx4 a[180:183], v200, s[60:63], s5 offen offset:1024
    buffer_load_dwordx4 a[184:187], v200, s[60:63], s5 offen offset:2048
    buffer_load_dwordx4 a[188:191], v200, s[60:63], s5 offen offset:3072
    s_mov_b32 s39, 1
    s_cmp_eq_u32 s33, 0
    s_cbranch_scc0 km_A
km_we:
    s_mov_b32 s39, 1
km_wo:
    s_add_u32 s60, s26, 6746112
    s_addc_u32 s61, s27, 0
    s_mov_b32 s62, 819200
    s_mov_b32 s63, 0x20000
    s_lshr_b32 s5, s2, 6
    s_lshl_b32 s5, s5, 2
    s_add_u32 s5, s5, s3
    s_mul_i32 s5, s5, 51200
    s_add_u32 s44, s26, 20072448
    s_addc_u32 s45, s27, 0
    s_mov_b32 s46, 98304
    s_mov_b32 s47, 0x20000
    s_mov_b32 s70, 77824
    v_min_u32 v201, 19, v1
    v_lshlrev_b32 v201, 2, v201
    buffer_load_dword v59, v201, s[44:47], s70 offen sc1
    s_waitcnt vmcnt(0)
    v_cmp_gt_u32 vcc, 1, v59
    s_mov_b32 s7, 0
    s_nop 3
    s_cbranch_vccz km_c2_ok
km_c2:
    s_sleep 16
    buffer_load_dword v59, v201, s[44:47], s70 offen sc1
    s_add_u32 s7, s7, 1
    s_waitcnt vmcnt(0)
    v_cmp_gt_u32 vcc, 1, v59
    s_cmp_lt_u32 s7, 0x40000
    s_nop 3
    s_cbranch_vccz km_c2_ok
    s_cbranch_scc1 km_c2
km_c2_ok:
    buffer_load_dwordx4 a[0:3], v200, s[60:63], s5 offen offset:0
    buffer_load_dwordx4 a[4:7], v200, s[60:63], s5 offen offset:1024
    buffer_load_dwordx4 a[8:11], v200, s[60:63], s5 offen offset:2048
    buffer_load_dwordx4 a[12:15], v200, s[60:63], s5 offen offset:3072
    s_add_u32 s5, s5, 4096
    buffer_load_dwordx4 a[16:19], v200, s[60:63], s5 offen offset:0
    buffer_load_dwordx4 a[20:23], v200, s[60:63], s5 offen offset:1024
    buffer_load_dwordx4 a[24:27], v200, s[60:63], s5 offen offset:2048
    buffer_load_dwordx4 a[28:31], v200, s[60:63], s5 offen offset:3072
    s_add_u32 s5, s5, 4096
    buffer_load_dwordx4 a[32:35], v200, s[60:63], s5 offen offset:0
    buffer_load_dwordx4 a[36:39], v200, s[60:63], s5 offen offset:1024
    buffer_load_dwordx4 a[40:43], v200, s[60:63], s5 offen offset:2048
    buffer_load_dwordx4 a[44:47], v200, s[60:63], s5 offen offset:3072
    s_add_u32 s5, s5, 4096
    buffer_load_dwordx4 a[48:51], v200, s[60:63], s5 offen offset:0
    buffer_load_dwordx4 a[52:55], v200, s[60:63], s5 offen offset:1024
    buffer_load_dwordx4 a[56:59], v200, s[60:63], s5 offen offset:2048
    buffer_load_dwordx4 a[60:63], v200, s[60:63], s5 offen offset:3072
    s_add_u32 s5, s5, 4096
    buffer_load_dwordx4 a[64:67], v200, s[60:63], s5 offen offset:0
    buffer_load_dwordx4 a[68:71], v200, s[60:63], s5 offen offset:1024
    buffer_load_dwordx4 a[72:75], v200, s[60:63], s5 offen offset:2048
    buffer_load_dwordx4 a[76:79], v200, s[60:63], s5 offen offset:3072
    s_add_u32 s5, s5, 4096
    buffer_load_dwordx4 a[80:83], v200, s[60:63], s5 offen offset:0
    buffer_load_dwordx4 a[84:87], v200, s[60:63], s5 offen offset:1024
    buffer_load_dwordx4 a[88:91], v200, s[60:63], s5 offen offset:2048
    buffer_load_dwordx4 a[92:95], v200, s[60:63], s5 offen offset:3072
    s_add_u32 s5, s5, 4096
    buffer_load_dwordx4 a[96:99], v200, s[60:63], s5 offen offset:0
    buffer_load_dwordx4 a[100:103], v200, s[60:63], s5 offen offset:1024
    buffer_load_dwordx4 a[104:107], v200, s[60:63], s5 offen offset:2048
    buffer_load_dwordx4 a[108:111], v200, s[60:63], s5 offen offset:3072
    s_add_u32 s5, s5, 4096
    buffer_load_dwordx4 a[112:115], v200, s[60:63], s5 offen offset:0
    buffer_load_dwordx4 a[116:119], v200, s[60:63], s5 offen offset:1024
    buffer_load_dwordx4 a[120:123], v200, s[60:63], s5 offen offset:2048
    buffer_load_dwordx4 a[124:127], v200, s[60:63], s5 offen offset:3072
    s_add_u32 s5, s5, 4096
    buffer_load_dwordx4 a[128:131], v200, s[60:63], s5 offen offset:0
    buffer_load_dwordx4 a[132:135], v200, s[60:63], s5 offen offset:1024
    buffer_load_dwordx4 a[136:139], v200, s[60:63], s5 offen offset:2048
    buffer_load_dwordx4 a[140:143], v200, s[60:63], s5 offen offset:3072
    s_add_u32 s5, s5, 4096
    buffer_load_dwordx4 a[144:147], v200, s[60:63], s5 offen offset:0
    buffer_load_dwordx4 a[148:151], v200, s[60:63], s5 offen offset:1024
    buffer_load_dwordx4 a[152:155], v200, s[60:63], s5 offen offset:2048
    buffer_load_dwordx4 a[156:159], v200, s[60:63], s5 offen offset:3072
    s_add_u32 s5, s5, 4096
    buffer_load_dwordx4 a[160:163], v200, s[60:63], s5 offen offset:0
    buffer_load_dwordx4 a[164:167], v200, s[60:63], s5 offen offset:1024
    buffer_load_dwordx4 a[168:171], v200, s[60:63], s5 offen offset:2048
    buffer_load_dwordx4 a[172:175], v200, s[60:63], s5 offen offset:3072
    s_add_u32 s5, s5, 4096
    buffer_load_dwordx4 a[176:179], v200, s[60:63], s5 offen offset:0
    buffer_load_dwordx4 a[180:183], v200, s[60:63], s5 offen offset:1024
    buffer_load_dwordx4 a[184:187], v200, s[60:63], s5 offen offset:2048
    buffer_load_dwordx4 a[188:191], v200, s[60:63], s5 offen offset:3072
    s_branch km_A
km_rl:
    s_sub_u32 s29, s29, 26
    s_lshl_b32 s29, s29, 3
    s_add_u32 s29, s29, s28
    v_mov_b32 v16, 0
    v_mov_b32 v17, 1
    s_cmp_ge_u32 s29, 40
    s_cbranch_scc0 km_rl_nc
    s_getpc_b64 s[44:45]
km_pc:
    s_sub_u32 s44, s44, km_pc-sequential_preLN__linear_attn_block__geglu_ffn__prompt_kernel
    s_subb_u32 s45, s45, 0
    s_mov_b32 s46, text_end-sequential_preLN__linear_attn_block__geglu_ffn__prompt_kernel
    s_mov_b32 s47, 0x20000
    s_lshl_b32 s41, s3, 14
    v_lshlrev_b32 v4, 7, v1
    buffer_load_dword v100, v4, s[44:47], s41 offen
    s_add_u32 s41, s41, 8192
    buffer_load_dword v101, v4, s[44:47], s41 offen
km_rl_nc:
    s_cmp_lg_u32 s29, 37
    s_cbranch_scc1 km_rl_go
    s_waitcnt lgkmcnt(0)
    s_add_u32 s48, s26, 7565312
    s_addc_u32 s49, s27, 0
    s_mov_b32 s50, 53760
    s_mov_b32 s51, 0x20000
    s_add_u32 s56, s26, 20072448
    s_addc_u32 s57, s27, 0
    s_mov_b32 s58, 98304
    s_mov_b32 s59, 0x20000
    v_mov_b32 v8, 0
    v_mov_b32 v9, 0
    v_mov_b32 v10, 0
    v_mov_b32 v11, 0
    v_lshlrev_b32 v12, 4, v0
    s_mov_b32 s41, 0
    buffer_store_dwordx4 v[8:11], v12, s[48:51], s41 offen sc1
    buffer_store_dwordx4 v[8:11], v12, s[56:59], s41 offen sc1
    s_add_u32 s41, s41, 4096
    buffer_store_dwordx4 v[8:11], v12, s[48:51], s41 offen sc1
    buffer_store_dwordx4 v[8:11], v12, s[56:59], s41 offen sc1
    s_add_u32 s41, s41, 4096
    buffer_store_dwordx4 v[8:11], v12, s[48:51], s41 offen sc1
    buffer_store_dwordx4 v[8:11], v12, s[56:59], s41 offen sc1
    s_add_u32 s41, s41, 4096
    buffer_store_dwordx4 v[8:11], v12, s[48:51], s41 offen sc1
    buffer_store_dwordx4 v[8:11], v12, s[56:59], s41 offen sc1
    s_add_u32 s41, s41, 4096
    buffer_store_dwordx4 v[8:11], v12, s[48:51], s41 offen sc1
    buffer_store_dwordx4 v[8:11], v12, s[56:59], s41 offen sc1
    s_add_u32 s41, s41, 4096
    buffer_store_dwordx4 v[8:11], v12, s[48:51], s41 offen sc1
    buffer_store_dwordx4 v[8:11], v12, s[56:59], s41 offen sc1
    s_add_u32 s41, s41, 4096
    buffer_store_dwordx4 v[8:11], v12, s[48:51], s41 offen sc1
    buffer_store_dwordx4 v[8:11], v12, s[56:59], s41 offen sc1
    s_add_u32 s41, s41, 4096
    buffer_store_dwordx4 v[8:11], v12, s[48:51], s41 offen sc1
    buffer_store_dwordx4 v[8:11], v12, s[56:59], s41 offen sc1
    s_add_u32 s41, s41, 4096
    buffer_store_dwordx4 v[8:11], v12, s[48:51], s41 offen sc1
    buffer_store_dwordx4 v[8:11], v12, s[56:59], s41 offen sc1
    s_add_u32 s41, s41, 4096
    buffer_store_dwordx4 v[8:11], v12, s[48:51], s41 offen sc1
    buffer_store_dwordx4 v[8:11], v12, s[56:59], s41 offen sc1
    s_add_u32 s41, s41, 4096
    buffer_store_dwordx4 v[8:11], v12, s[48:51], s41 offen sc1
    buffer_store_dwordx4 v[8:11], v12, s[56:59], s41 offen sc1
    s_add_u32 s41, s41, 4096
    buffer_store_dwordx4 v[8:11], v12, s[48:51], s41 offen sc1
    buffer_store_dwordx4 v[8:11], v12, s[56:59], s41 offen sc1
    s_add_u32 s41, s41, 4096
    buffer_store_dwordx4 v[8:11], v12, s[48:51], s41 offen sc1
    buffer_store_dwordx4 v[8:11], v12, s[56:59], s41 offen sc1
    s_add_u32 s41, s41, 4096
    buffer_store_dwordx4 v[8:11], v12, s[48:51], s41 offen sc1
    buffer_store_dwordx4 v[8:11], v12, s[56:59], s41 offen sc1
    s_add_u32 s41, s41, 4096
    buffer_store_dwordx4 v[8:11], v12, s[56:59], s41 offen sc1
    s_add_u32 s41, s41, 4096
    buffer_store_dwordx4 v[8:11], v12, s[56:59], s41 offen sc1
    s_add_u32 s41, s41, 4096
    buffer_store_dwordx4 v[8:11], v12, s[56:59], s41 offen sc1
    s_add_u32 s41, s41, 4096
    buffer_store_dwordx4 v[8:11], v12, s[56:59], s41 offen sc1
    s_add_u32 s41, s41, 4096
    buffer_store_dwordx4 v[8:11], v12, s[56:59], s41 offen sc1
    s_add_u32 s41, s41, 4096
    buffer_store_dwordx4 v[8:11], v12, s[56:59], s41 offen sc1
    s_add_u32 s41, s41, 4096
    buffer_store_dwordx4 v[8:11], v12, s[56:59], s41 offen sc1
    s_add_u32 s41, s41, 4096
    buffer_store_dwordx4 v[8:11], v12, s[56:59], s41 offen sc1
    s_add_u32 s41, s41, 4096
    buffer_store_dwordx4 v[8:11], v12, s[56:59], s41 offen sc1
    s_add_u32 s41, s41, 4096
    buffer_store_dwordx4 v[8:11], v12, s[56:59], s41 offen sc1
    s_add_u32 s41, s41, 4096
    s_mov_b32 s52, s24
    s_mov_b32 s53, s25
    s_mov_b32 s54, 256
    s_mov_b32 s55, 0x20000
    s_waitcnt vmcnt(0)
    s_barrier
    s_cmp_eq_u32 s3, 0
    s_cbranch_scc0 km_rl_x
    v_mov_b32 v18, 1
    s_mov_b64 exec, 1
    buffer_store_dword v18, v16, s[52:55], 0 offen sc1
    s_mov_b64 exec, -1
    s_branch km_rl_x
km_rl_go:
    v_lshrrev_b32 v2, 3, v1
    v_and_b32 v3, 7, v1
    v_lshlrev_b32 v3, 4, v3
    v_lshlrev_b32 v4, 4, v1
    v_bfe_u32 v5, v1, 2, 2
    v_and_b32 v6, 3, v1
    v_lshrrev_b32 v7, 5, v1
    v_bfe_u32 v8, v1, 4, 1
    s_lshl_b32 s44, s3, 10
    s_cmp_lt_u32 s29, 27
    s_cbranch_scc0 km_rl_notg
    v_mul_u32_u24 v9, 3456, v2
    v_add_u32 v9, v9, v3
    s_mul_i32 s43, s3, 27648
    s_lshl_b32 s45, s29, 7
    s_add_u32 s43, s43, s45
    s_waitcnt lgkmcnt(0)
    s_mov_b32 s48, s16
    s_mov_b32 s49, s17
    s_mov_b32 s50, 2211840
    s_mov_b32 s51, 0x20000
    s_mov_b32 s64, s18
    s_mov_b32 s65, s19
    s_mov_b32 s66, 2211840
    s_mov_b32 s67, 0x20000
    s_add_u32 m0, s44, 0
    s_nop 0
    buffer_load_dwordx4 v9, s[48:51], s43 offen lds
    s_add_u32 m0, s44, 40960
    s_nop 0
    buffer_load_dwordx4 v9, s[64:67], s43 offen lds
    s_add_u32 s43, s43, 110592
    s_add_u32 m0, s44, 4096
    s_nop 0
    buffer_load_dwordx4 v9, s[48:51], s43 offen lds
    s_add_u32 m0, s44, 45056
    s_nop 0
    buffer_load_dwordx4 v9, s[64:67], s43 offen lds
    s_add_u32 s43, s43, 110592
    s_add_u32 m0, s44, 8192
    s_nop 0
    buffer_load_dwordx4 v9, s[48:51], s43 offen lds
    s_add_u32 m0, s44, 49152
    s_nop 0
    buffer_load_dwordx4 v9, s[64:67], s43 offen lds
    s_add_u32 s43, s43, 110592
    s_add_u32 m0, s44, 12288
    s_nop 0
    buffer_load_dwordx4 v9, s[48:51], s43 offen lds
    s_add_u32 m0, s44, 53248
    s_nop 0
    buffer_load_dwordx4 v9, s[64:67], s43 offen lds
    s_add_u32 s43, s43, 110592
    s_add_u32 m0, s44, 16384
    s_nop 0
    buffer_load_dwordx4 v9, s[48:51], s43 offen lds
    s_add_u32 m0, s44, 57344
    s_nop 0
    buffer_load_dwordx4 v9, s[64:67], s43 offen lds
    s_add_u32 s43, s43, 110592
    s_add_u32 m0, s44, 20480
    s_nop 0
    buffer_load_dwordx4 v9, s[48:51], s43 offen lds
    s_add_u32 m0, s44, 61440
    s_nop 0
    buffer_load_dwordx4 v9, s[64:67], s43 offen lds
    s_add_u32 s43, s43, 110592
    s_add_u32 m0, s44, 24576
    s_nop 0
    buffer_load_dwordx4 v9, s[48:51], s43 offen lds
    s_add_u32 m0, s44, 65536
    s_nop 0
    buffer_load_dwordx4 v9, s[64:67], s43 offen lds
    s_add_u32 s43, s43, 110592
    s_add_u32 m0, s44, 28672
    s_nop 0
    buffer_load_dwordx4 v9, s[48:51], s43 offen lds
    s_add_u32 m0, s44, 69632
    s_nop 0
    buffer_load_dwordx4 v9, s[64:67], s43 offen lds
    s_add_u32 s43, s43, 110592
    s_add_u32 m0, s44, 32768
    s_nop 0
    buffer_load_dwordx4 v9, s[48:51], s43 offen lds
    s_add_u32 m0, s44, 73728
    s_nop 0
    buffer_load_dwordx4 v9, s[64:67], s43 offen lds
    s_add_u32 s43, s43, 110592
    s_add_u32 m0, s44, 36864
    s_nop 0
    buffer_load_dwordx4 v9, s[48:51], s43 offen lds
    s_add_u32 m0, s44, 77824
    s_nop 0
    buffer_load_dwordx4 v9, s[64:67], s43 offen lds
    s_add_u32 s43, s43, 110592
    s_add_u32 m0, s44, 81920
    s_nop 0
    buffer_load_dwordx4 v9, s[48:51], s43 offen lds
    s_add_u32 m0, s44, 122880
    s_nop 0
    buffer_load_dwordx4 v9, s[64:67], s43 offen lds
    s_add_u32 s43, s43, 110592
    s_add_u32 m0, s44, 86016
    s_nop 0
    buffer_load_dwordx4 v9, s[48:51], s43 offen lds
    s_add_u32 m0, s44, 126976
    s_nop 0
    buffer_load_dwordx4 v9, s[64:67], s43 offen lds
    s_add_u32 s43, s43, 110592
    s_add_u32 m0, s44, 90112
    s_nop 0
    buffer_load_dwordx4 v9, s[48:51], s43 offen lds
    s_add_u32 m0, s44, 131072
    s_nop 0
    buffer_load_dwordx4 v9, s[64:67], s43 offen lds
    s_add_u32 s43, s43, 110592
    s_add_u32 m0, s44, 94208
    s_nop 0
    buffer_load_dwordx4 v9, s[48:51], s43 offen lds
    s_add_u32 m0, s44, 135168
    s_nop 0
    buffer_load_dwordx4 v9, s[64:67], s43 offen lds
    s_add_u32 s43, s43, 110592
    s_add_u32 m0, s44, 98304
    s_nop 0
    buffer_load_dwordx4 v9, s[48:51], s43 offen lds
    s_add_u32 m0, s44, 139264
    s_nop 0
    buffer_load_dwordx4 v9, s[64:67], s43 offen lds
    s_add_u32 s43, s43, 110592
    s_add_u32 m0, s44, 102400
    s_nop 0
    buffer_load_dwordx4 v9, s[48:51], s43 offen lds
    s_add_u32 m0, s44, 143360
    s_nop 0
    buffer_load_dwordx4 v9, s[64:67], s43 offen lds
    s_add_u32 s43, s43, 110592
    s_add_u32 m0, s44, 106496
    s_nop 0
    buffer_load_dwordx4 v9, s[48:51], s43 offen lds
    s_add_u32 m0, s44, 147456
    s_nop 0
    buffer_load_dwordx4 v9, s[64:67], s43 offen lds
    s_add_u32 s43, s43, 110592
    s_add_u32 m0, s44, 110592
    s_nop 0
    buffer_load_dwordx4 v9, s[48:51], s43 offen lds
    s_add_u32 m0, s44, 151552
    s_nop 0
    buffer_load_dwordx4 v9, s[64:67], s43 offen lds
    s_add_u32 s43, s43, 110592
    s_add_u32 m0, s44, 114688
    s_nop 0
    buffer_load_dwordx4 v9, s[48:51], s43 offen lds
    s_add_u32 m0, s44, 155648
    s_nop 0
    buffer_load_dwordx4 v9, s[64:67], s43 offen lds
    s_add_u32 s43, s43, 110592
    s_add_u32 m0, s44, 118784
    s_nop 0
    buffer_load_dwordx4 v9, s[48:51], s43 offen lds
    s_add_u32 m0, s44, 159744
    s_nop 0
    buffer_load_dwordx4 v9, s[64:67], s43 offen lds
    s_add_u32 s43, s43, 110592
    s_mov_b32 s56, s26
    s_mov_b32 s57, s27
    s_mov_b32 s58, 4423680
    s_mov_b32 s59, 0x20000
    s_add_u32 s60, s26, 4423680
    s_addc_u32 s61, s27, 0
    s_mov_b32 s62, 110592
    s_mov_b32 s63, 0x20000
    s_mov_b32 s52, s24
    s_mov_b32 s53, s25
    s_mov_b32 s54, 256
    s_mov_b32 s55, 0x20000
    v_lshrrev_b32 v10, 1, v6
    v_mul_u32_u24 v10, 40960, v10
    v_lshl_add_u32 v11, v7, 2, v5
    v_lshl_add_u32 v10, v11, 7, v10
    v_lshl_add_u32 v10, v8, 4, v10
    v_and_b32 v11, 1, v6
    v_lshl_add_u32 v10, v11, 3, v10
    s_lshl_b32 s45, s3, 5
    v_add_u32 v10, s45, v10
    v_add_u32 v11, 81920, v10
    v_mov_b32 v12, 0x3f803f80
    v_mov_b32 v13, 0x3f803f80
    v_mov_b32 v14, 0x3f803f80
    v_mov_b32 v15, 0x3f803f80
    s_lshl_b32 s45, s29, 2
    s_add_u32 s45, s45, s3
    s_mul_i32 s46, s45, 40960
    s_lshl_b32 s45, s45, 10
    s_waitcnt vmcnt(20)
    s_barrier
    ds_read_b64_tr_b16 v[64:65], v10 offset:0
    ds_read_b64_tr_b16 v[66:67], v10 offset:1024
    ds_read_b64_tr_b16 v[68:69], v10 offset:2048
    ds_read_b64_tr_b16 v[70:71], v10 offset:3072
    ds_read_b64_tr_b16 v[72:73], v10 offset:4096
    ds_read_b64_tr_b16 v[74:75], v10 offset:5120
    ds_read_b64_tr_b16 v[76:77], v10 offset:6144
    ds_read_b64_tr_b16 v[78:79], v10 offset:7168
    ds_read_b64_tr_b16 v[80:81], v10 offset:8192
    ds_read_b64_tr_b16 v[82:83], v10 offset:9216
    ds_read_b64_tr_b16 v[84:85], v10 offset:10240
    ds_read_b64_tr_b16 v[86:87], v10 offset:11264
    s_waitcnt lgkmcnt(10)
    v_mfma_f32_32x32x16_bf16 v[32:47], v[12:15], v[64:67], 0
    buffer_store_dwordx4 v[64:67], v4, s[56:59], s46 offen offset:0 sc1
    s_nop 1
    ds_read_b64_tr_b16 v[64:65], v10 offset:12288
    ds_read_b64_tr_b16 v[66:67], v10 offset:13312
    s_waitcnt lgkmcnt(10)
    v_mfma_f32_32x32x16_bf16 v[32:47], v[12:15], v[68:71], v[32:47]
    buffer_store_dwordx4 v[68:71], v4, s[56:59], s46 offen offset:1024 sc1
    s_nop 1
    ds_read_b64_tr_b16 v[68:69], v10 offset:14336
    ds_read_b64_tr_b16 v[70:71], v10 offset:15360
    s_waitcnt lgkmcnt(10)
    v_mfma_f32_32x32x16_bf16 v[32:47], v[12:15], v[72:75], v[32:47]
    buffer_store_dwordx4 v[72:75], v4, s[56:59], s46 offen offset:2048 sc1
    s_nop 1
    ds_read_b64_tr_b16 v[72:73], v10 offset:16384
    ds_read_b64_tr_b16 v[74:75], v10 offset:17408
    s_waitcnt lgkmcnt(10)
    v_mfma_f32_32x32x16_bf16 v[32:47], v[12:15], v[76:79], v[32:47]
    buffer_store_dwordx4 v[76:79], v4, s[56:59], s46 offen offset:3072 sc1
    s_add_u32 s46, s46, 4096
    s_nop 0
    ds_read_b64_tr_b16 v[76:77], v10 offset:18432
    ds_read_b64_tr_b16 v[78:79], v10 offset:19456
    s_waitcnt lgkmcnt(10)
    v_mfma_f32_32x32x16_bf16 v[32:47], v[12:15], v[80:83], v[32:47]
    buffer_store_dwordx4 v[80:83], v4, s[56:59], s46 offen offset:0 sc1
    s_nop 1
    ds_read_b64_tr_b16 v[80:81], v10 offset:20480
    ds_read_b64_tr_b16 v[82:83], v10 offset:21504
    s_waitcnt lgkmcnt(10)
    v_mfma_f32_32x32x16_bf16 v[32:47], v[12:15], v[84:87], v[32:47]
    buffer_store_dwordx4 v[84:87], v4, s[56:59], s46 offen offset:1024 sc1
    s_nop 1
    ds_read_b64_tr_b16 v[84:85], v10 offset:22528
    ds_read_b64_tr_b16 v[86:87], v10 offset:23552
    s_waitcnt lgkmcnt(10)
    v_mfma_f32_32x32x16_bf16 v[32:47], v[12:15], v[64:67], v[32:47]
    buffer_store_dwordx4 v[64:67], v4, s[56:59], s46 offen offset:2048 sc1
    s_nop 1
    ds_read_b64_tr_b16 v[64:65], v10 offset:24576
    ds_read_b64_tr_b16 v[66:67], v10 offset:25600
    s_waitcnt lgkmcnt(10)
    v_mfma_f32_32x32x16_bf16 v[32:47], v[12:15], v[68:71], v[32:47]
    buffer_store_dwordx4 v[68:71], v4, s[56:59], s46 offen offset:3072 sc1
    s_add_u32 s46, s46, 4096
    s_nop 0
    ds_read_b64_tr_b16 v[68:69], v10 offset:26624
    ds_read_b64_tr_b16 v[70:71], v10 offset:27648
    s_waitcnt lgkmcnt(10)
    v_mfma_f32_32x32x16_bf16 v[32:47], v[12:15], v[72:75], v[32:47]
    buffer_store_dwordx4 v[72:75], v4, s[56:59], s46 offen offset:0 sc1
    s_nop 1
    ds_read_b64_tr_b16 v[72:73], v10 offset:28672
    ds_read_b64_tr_b16 v[74:75], v10 offset:29696
    s_waitcnt lgkmcnt(10)
    v_mfma_f32_32x32x16_bf16 v[32:47], v[12:15], v[76:79], v[32:47]
    buffer_store_dwordx4 v[76:79], v4, s[56:59], s46 offen offset:1024 sc1
    s_nop 1
    ds_read_b64_tr_b16 v[76:77], v10 offset:30720
    ds_read_b64_tr_b16 v[78:79], v10 offset:31744
    s_waitcnt lgkmcnt(10)
    v_mfma_f32_32x32x16_bf16 v[32:47], v[12:15], v[80:83], v[32:47]
    buffer_store_dwordx4 v[80:83], v4, s[56:59], s46 offen offset:2048 sc1
    s_nop 1
    ds_read_b64_tr_b16 v[80:81], v10 offset:32768
    ds_read_b64_tr_b16 v[82:83], v10 offset:33792
    s_waitcnt lgkmcnt(10)
    v_mfma_f32_32x32x16_bf16 v[32:47], v[12:15], v[84:87], v[32:47]
    buffer_store_dwordx4 v[84:87], v4, s[56:59], s46 offen offset:3072 sc1
    s_add_u32 s46, s46, 4096
    s_nop 0
    ds_read_b64_tr_b16 v[84:85], v10 offset:34816
    ds_read_b64_tr_b16 v[86:87], v10 offset:35840
    s_waitcnt lgkmcnt(10)
    v_mfma_f32_32x32x16_bf16 v[32:47], v[12:15], v[64:67], v[32:47]
    buffer_store_dwordx4 v[64:67], v4, s[56:59], s46 offen offset:0 sc1
    s_nop 1
    ds_read_b64_tr_b16 v[64:65], v10 offset:36864
    ds_read_b64_tr_b16 v[66:67], v10 offset:37888
    s_waitcnt lgkmcnt(10)
    v_mfma_f32_32x32x16_bf16 v[32:47], v[12:15], v[68:71], v[32:47]
    buffer_store_dwordx4 v[68:71], v4, s[56:59], s46 offen offset:1024 sc1
    s_nop 1
    ds_read_b64_tr_b16 v[68:69], v10 offset:38912
    ds_read_b64_tr_b16 v[70:71], v10 offset:39936
    s_waitcnt lgkmcnt(10)
    v_mfma_f32_32x32x16_bf16 v[32:47], v[12:15], v[72:75], v[32:47]
    buffer_store_dwordx4 v[72:75], v4, s[56:59], s46 offen offset:2048 sc1
    s_waitcnt lgkmcnt(8)
    v_mfma_f32_32x32x16_bf16 v[32:47], v[12:15], v[76:79], v[32:47]
    buffer_store_dwordx4 v[76:79], v4, s[56:59], s46 offen offset:3072 sc1
    s_add_u32 s46, s46, 4096
    s_waitcnt lgkmcnt(6)
    v_mfma_f32_32x32x16_bf16 v[32:47], v[12:15], v[80:83], v[32:47]
    buffer_store_dwordx4 v[80:83], v4, s[56:59], s46 offen offset:0 sc1
    s_waitcnt lgkmcnt(4)
    v_mfma_f32_32x32x16_bf16 v[32:47], v[12:15], v[84:87], v[32:47]
    buffer_store_dwordx4 v[84:87], v4, s[56:59], s46 offen offset:1024 sc1
    s_waitcnt lgkmcnt(2)
    v_mfma_f32_32x32x16_bf16 v[32:47], v[12:15], v[64:67], v[32:47]
    buffer_store_dwordx4 v[64:67], v4, s[56:59], s46 offen offset:2048 sc1
    s_waitcnt lgkmcnt(0)
    v_mfma_f32_32x32x16_bf16 v[32:47], v[12:15], v[68:71], v[32:47]
    buffer_store_dwordx4 v[68:71], v4, s[56:59], s46 offen offset:3072 sc1
    s_add_u32 s46, s46, 4096
    s_waitcnt vmcnt(20)
    s_barrier
    ds_read_b64_tr_b16 v[64:65], v11 offset:0
    ds_read_b64_tr_b16 v[66:67], v11 offset:1024
    ds_read_b64_tr_b16 v[68:69], v11 offset:2048
    ds_read_b64_tr_b16 v[70:71], v11 offset:3072
    ds_read_b64_tr_b16 v[72:73], v11 offset:4096
    ds_read_b64_tr_b16 v[74:75], v11 offset:5120
    ds_read_b64_tr_b16 v[76:77], v11 offset:6144
    ds_read_b64_tr_b16 v[78:79], v11 offset:7168
    ds_read_b64_tr_b16 v[80:81], v11 offset:8192
    ds_read_b64_tr_b16 v[82:83], v11 offset:9216
    ds_read_b64_tr_b16 v[84:85], v11 offset:10240
    ds_read_b64_tr_b16 v[86:87], v11 offset:11264
    s_waitcnt lgkmcnt(10)
    v_mfma_f32_32x32x16_bf16 v[48:63], v[12:15], v[64:67], 0
    buffer_store_dwordx4 v[64:67], v4, s[56:59], s46 offen offset:0 sc1
    s_nop 1
    ds_read_b64_tr_b16 v[64:65], v11 offset:12288
    ds_read_b64_tr_b16 v[66:67], v11 offset:13312
    s_waitcnt lgkmcnt(10)
    v_mfma_f32_32x32x16_bf16 v[48:63], v[12:15], v[68:71], v[48:63]
    buffer_store_dwordx4 v[68:71], v4, s[56:59], s46 offen offset:1024 sc1
    s_nop 1
    ds_read_b64_tr_b16 v[68:69], v11 offset:14336
    ds_read_b64_tr_b16 v[70:71], v11 offset:15360
    s_waitcnt lgkmcnt(10)
    v_mfma_f32_32x32x16_bf16 v[48:63], v[12:15], v[72:75], v[48:63]
    buffer_store_dwordx4 v[72:75], v4, s[56:59], s46 offen offset:2048 sc1
    s_nop 1
    ds_read_b64_tr_b16 v[72:73], v11 offset:16384
    ds_read_b64_tr_b16 v[74:75], v11 offset:17408
    s_waitcnt lgkmcnt(10)
    v_mfma_f32_32x32x16_bf16 v[48:63], v[12:15], v[76:79], v[48:63]
    buffer_store_dwordx4 v[76:79], v4, s[56:59], s46 offen offset:3072 sc1
    s_add_u32 s46, s46, 4096
    s_nop 0
    ds_read_b64_tr_b16 v[76:77], v11 offset:18432
    ds_read_b64_tr_b16 v[78:79], v11 offset:19456
    s_waitcnt lgkmcnt(10)
    v_mfma_f32_32x32x16_bf16 v[48:63], v[12:15], v[80:83], v[48:63]
    buffer_store_dwordx4 v[80:83], v4, s[56:59], s46 offen offset:0 sc1
    s_nop 1
    ds_read_b64_tr_b16 v[80:81], v11 offset:20480
    ds_read_b64_tr_b16 v[82:83], v11 offset:21504
    s_waitcnt lgkmcnt(10)
    v_mfma_f32_32x32x16_bf16 v[48:63], v[12:15], v[84:87], v[48:63]
    buffer_store_dwordx4 v[84:87], v4, s[56:59], s46 offen offset:1024 sc1
    s_nop 1
    ds_read_b64_tr_b16 v[84:85], v11 offset:22528
    ds_read_b64_tr_b16 v[86:87], v11 offset:23552
    s_waitcnt lgkmcnt(10)
    v_mfma_f32_32x32x16_bf16 v[48:63], v[12:15], v[64:67], v[48:63]
    buffer_store_dwordx4 v[64:67], v4, s[56:59], s46 offen offset:2048 sc1
    s_nop 1
    ds_read_b64_tr_b16 v[64:65], v11 offset:24576
    ds_read_b64_tr_b16 v[66:67], v11 offset:25600
    s_waitcnt lgkmcnt(10)
    v_mfma_f32_32x32x16_bf16 v[48:63], v[12:15], v[68:71], v[48:63]
    buffer_store_dwordx4 v[68:71], v4, s[56:59], s46 offen offset:3072 sc1
    s_add_u32 s46, s46, 4096
    s_nop 0
    ds_read_b64_tr_b16 v[68:69], v11 offset:26624
    ds_read_b64_tr_b16 v[70:71], v11 offset:27648
    s_waitcnt lgkmcnt(10)
    v_mfma_f32_32x32x16_bf16 v[48:63], v[12:15], v[72:75], v[48:63]
    buffer_store_dwordx4 v[72:75], v4, s[56:59], s46 offen offset:0 sc1
    s_nop 1
    ds_read_b64_tr_b16 v[72:73], v11 offset:28672
    ds_read_b64_tr_b16 v[74:75], v11 offset:29696
    s_waitcnt lgkmcnt(10)
    v_mfma_f32_32x32x16_bf16 v[48:63], v[12:15], v[76:79], v[48:63]
    buffer_store_dwordx4 v[76:79], v4, s[56:59], s46 offen offset:1024 sc1
    s_nop 1
    ds_read_b64_tr_b16 v[76:77], v11 offset:30720
    ds_read_b64_tr_b16 v[78:79], v11 offset:31744
    s_waitcnt lgkmcnt(10)
    v_mfma_f32_32x32x16_bf16 v[48:63], v[12:15], v[80:83], v[48:63]
    buffer_store_dwordx4 v[80:83], v4, s[56:59], s46 offen offset:2048 sc1
    s_nop 1
    ds_read_b64_tr_b16 v[80:81], v11 offset:32768
    ds_read_b64_tr_b16 v[82:83], v11 offset:33792
    s_waitcnt lgkmcnt(10)
    v_mfma_f32_32x32x16_bf16 v[48:63], v[12:15], v[84:87], v[48:63]
    buffer_store_dwordx4 v[84:87], v4, s[56:59], s46 offen offset:3072 sc1
    s_add_u32 s46, s46, 4096
    s_nop 0
    ds_read_b64_tr_b16 v[84:85], v11 offset:34816
    ds_read_b64_tr_b16 v[86:87], v11 offset:35840
    s_waitcnt lgkmcnt(10)
    v_mfma_f32_32x32x16_bf16 v[48:63], v[12:15], v[64:67], v[48:63]
    buffer_store_dwordx4 v[64:67], v4, s[56:59], s46 offen offset:0 sc1
    s_nop 1
    ds_read_b64_tr_b16 v[64:65], v11 offset:36864
    ds_read_b64_tr_b16 v[66:67], v11 offset:37888
    s_waitcnt lgkmcnt(10)
    v_mfma_f32_32x32x16_bf16 v[48:63], v[12:15], v[68:71], v[48:63]
    buffer_store_dwordx4 v[68:71], v4, s[56:59], s46 offen offset:1024 sc1
    s_nop 1
    ds_read_b64_tr_b16 v[68:69], v11 offset:38912
    ds_read_b64_tr_b16 v[70:71], v11 offset:39936
    s_waitcnt lgkmcnt(10)
    v_mfma_f32_32x32x16_bf16 v[48:63], v[12:15], v[72:75], v[48:63]
    buffer_store_dwordx4 v[72:75], v4, s[56:59], s46 offen offset:2048 sc1
    s_waitcnt lgkmcnt(8)
    v_mfma_f32_32x32x16_bf16 v[48:63], v[12:15], v[76:79], v[48:63]
    buffer_store_dwordx4 v[76:79], v4, s[56:59], s46 offen offset:3072 sc1
    s_add_u32 s46, s46, 4096
    s_waitcnt lgkmcnt(6)
    v_mfma_f32_32x32x16_bf16 v[48:63], v[12:15], v[80:83], v[48:63]
    buffer_store_dwordx4 v[80:83], v4, s[56:59], s46 offen offset:0 sc1
    s_waitcnt lgkmcnt(4)
    v_mfma_f32_32x32x16_bf16 v[48:63], v[12:15], v[84:87], v[48:63]
    buffer_store_dwordx4 v[84:87], v4, s[56:59], s46 offen offset:1024 sc1
    s_waitcnt lgkmcnt(2)
    v_mfma_f32_32x32x16_bf16 v[48:63], v[12:15], v[64:67], v[48:63]
    buffer_store_dwordx4 v[64:67], v4, s[56:59], s46 offen offset:2048 sc1
    s_waitcnt lgkmcnt(0)
    v_mfma_f32_32x32x16_bf16 v[48:63], v[12:15], v[68:71], v[48:63]
    buffer_store_dwordx4 v[68:71], v4, s[56:59], s46 offen offset:3072 sc1
    s_add_u32 s46, s46, 4096
    v_cmp_eq_u32 vcc, 1, v7
    s_nop 8
    v_cndmask_b32 v32, v32, v48, vcc
    v_cvt_pk_bf16_f32 v48, v32, v32
    v_lshlrev_b32 v48, 16, v48
    v_sub_f32 v33, v32, v48
    v_cvt_pk_bf16_f32 v48, v33, v33
    v_lshlrev_b32 v48, 16, v48
    v_sub_f32 v34, v33, v48
    v_cvt_pk_bf16_f32 v36, v32, v33
    v_cvt_pk_bf16_f32 v37, v34, v32
    v_cvt_pk_bf16_f32 v38, v33, v34
    v_mov_b32 v39, v36
    buffer_store_dwordx4 v[36:39], v4, s[60:63], s45 offen sc1
    s_waitcnt vmcnt(0)
    s_barrier
    s_cmp_eq_u32 s3, 0
    s_cbranch_scc0 km_ag
    buffer_load_dword v18, v16, s[52:55], 0 offen sc1
    s_waitcnt vmcnt(0)
    v_cmp_gt_u32 vcc, 1, v18
    s_mov_b32 s7, 0
    s_nop 3
    s_cbranch_vccz km_ag_z_ok
km_ag_z:
    s_sleep 8
    buffer_load_dword v18, v16, s[52:55], 0 offen sc1
    s_add_u32 s7, s7, 1
    s_waitcnt vmcnt(0)
    v_cmp_gt_u32 vcc, 1, v18
    s_cmp_lt_u32 s7, 0x40000
    s_nop 3
    s_cbranch_vccz km_ag_z_ok
    s_cbranch_scc1 km_ag_z
km_ag_z_ok:
    s_add_u32 s48, s26, 20151296
    s_addc_u32 s49, s27, 0
    s_mov_b32 s50, 128
    s_mov_b32 s51, 0x20000
    s_lshl_b32 s40, s29, 2
    v_mov_b32 v18, 1
    s_mov_b64 exec, 1
    buffer_store_dword v18, v16, s[48:51], s40 offen sc1
    s_mov_b64 exec, -1
km_ag:
    s_branch km_rl_x
km_rl_notg:
    v_mul_u32_u24 v9, 1280, v2
    v_add_u32 v9, v9, v3
    v_lshlrev_b32 v20, 4, v7
    v_lshl_add_u32 v20, v8, 2, v20
    v_add_u32 v20, v20, v5
    v_lshlrev_b32 v20, 7, v20
    v_lshl_add_u32 v20, v6, 3, v20
    s_lshl_b32 s45, s3, 5
    v_add_u32 v20, s45, v20
    v_add_u32 v21, 0x10000, v20
    s_waitcnt lgkmcnt(0)
    s_mov_b32 s64, s20
    s_mov_b32 s65, s21
    s_mov_b32 s66, 2211840
    s_mov_b32 s67, 0x20000
    s_add_u32 s68, s26, 4534272
    s_addc_u32 s69, s27, 0
    s_mov_b32 s70, 2211840
    s_mov_b32 s71, 0x20000
    s_mov_b32 s52, s24
    s_mov_b32 s53, s25
    s_mov_b32 s54, 256
    s_mov_b32 s55, 0x20000
    s_mov_b32 s48, s12
    s_mov_b32 s49, s13
    s_mov_b32 s50, 819200
    s_mov_b32 s51, 0x20000
    s_add_u32 s56, s26, 6746112
    s_addc_u32 s57, s27, 0
    s_mov_b32 s58, 819200
    s_mov_b32 s59, 0x20000
    s_cmp_gt_u32 s29, 37
    s_cselect_b32 s39, 28, 27
    s_sub_u32 s39, s29, s39
    s_lshr_b32 s40, s39, 1
    s_and_b32 s41, s39, 1
    s_mul_i32 s43, s41, 409600
    s_mul_i32 s45, s3, 10240
    s_add_u32 s43, s43, s45
    s_lshl_b32 s45, s40, 7
    s_add_u32 s43, s43, s45
    s_add_u32 m0, s44, 0
    s_nop 0
    buffer_load_dwordx4 v9, s[48:51], s43 offen lds
    s_add_u32 s43, s43, 40960
    s_add_u32 m0, s44, 4096
    s_nop 0
    buffer_load_dwordx4 v9, s[48:51], s43 offen lds
    s_add_u32 s43, s43, 40960
    s_add_u32 m0, s44, 8192
    s_nop 0
    buffer_load_dwordx4 v9, s[48:51], s43 offen lds
    s_add_u32 s43, s43, 40960
    s_add_u32 m0, s44, 12288
    s_nop 0
    buffer_load_dwordx4 v9, s[48:51], s43 offen lds
    s_add_u32 s43, s43, 40960
    s_add_u32 m0, s44, 16384
    s_nop 0
    buffer_load_dwordx4 v9, s[48:51], s43 offen lds
    s_add_u32 s43, s43, 40960
    s_add_u32 m0, s44, 20480
    s_nop 0
    buffer_load_dwordx4 v9, s[48:51], s43 offen lds
    s_add_u32 s43, s43, 40960
    s_add_u32 m0, s44, 24576
    s_nop 0
    buffer_load_dwordx4 v9, s[48:51], s43 offen lds
    s_add_u32 s43, s43, 40960
    s_add_u32 m0, s44, 28672
    s_nop 0
    buffer_load_dwordx4 v9, s[48:51], s43 offen lds
    s_add_u32 s43, s43, 40960
    s_add_u32 m0, s44, 32768
    s_nop 0
    buffer_load_dwordx4 v9, s[48:51], s43 offen lds
    s_add_u32 s43, s43, 40960
    s_add_u32 m0, s44, 36864
    s_nop 0
    buffer_load_dwordx4 v9, s[48:51], s43 offen lds
    s_lshr_b32 s46, s3, 1
    s_lshl_b32 s47, s41, 1
    s_add_u32 s47, s47, s46
    s_and_b32 s41, s3, 1
    s_lshl_b32 s45, s40, 1
    s_add_u32 s45, s45, 0
    s_mul_i32 s42, s45, 52429
    s_lshr_b32 s42, s42, 18
    s_mul_i32 s43, s42, 5
    s_sub_u32 s45, s45, s43
    s_lshl_b32 s42, s42, 2
    s_add_u32 s42, s42, s47
    s_mul_i32 s42, s42, 50
    s_add_u32 s42, s42, s45
    s_mul_i32 s43, s41, 25
    s_add_u32 s42, s42, s43
    s_lshl_b32 s74, s42, 10
    s_lshl_b32 s45, s40, 1
    s_add_u32 s45, s45, 1
    s_mul_i32 s42, s45, 52429
    s_lshr_b32 s42, s42, 18
    s_mul_i32 s43, s42, 5
    s_sub_u32 s45, s45, s43
    s_lshl_b32 s42, s42, 2
    s_add_u32 s42, s42, s47
    s_mul_i32 s42, s42, 50
    s_add_u32 s42, s42, s45
    s_mul_i32 s43, s41, 25
    s_add_u32 s42, s42, s43
    s_lshl_b32 s75, s42, 10
    v_lshlrev_b32 v10, 7, v5
    v_lshl_add_u32 v10, v8, 5, v10
    v_lshl_add_u32 v10, v6, 3, v10
    s_mul_i32 s45, s3, 10240
    v_add_u32 v10, s45, v10
    v_mul_u32_u24 v11, 2560, v7
    v_add_u32 v11, v11, v10
    v_lshl_add_u32 v10, v7, 9, v10
    s_waitcnt vmcnt(0)
    s_barrier
    ds_read_b64_tr_b16 v[64:65], v10 offset:0
    ds_read_b64_tr_b16 v[66:67], v10 offset:1024
    ds_read_b64_tr_b16 v[68:69], v10 offset:64
    ds_read_b64_tr_b16 v[70:71], v10 offset:1088
    ds_read_b64_tr_b16 v[72:73], v11 offset:2048
    ds_read_b64_tr_b16 v[74:75], v10 offset:2560
    ds_read_b64_tr_b16 v[76:77], v11 offset:2112
    ds_read_b64_tr_b16 v[78:79], v10 offset:2624
    ds_read_b64_tr_b16 v[80:81], v10 offset:3584
    ds_read_b64_tr_b16 v[82:83], v10 offset:5120
    ds_read_b64_tr_b16 v[84:85], v10 offset:3648
    ds_read_b64_tr_b16 v[86:87], v10 offset:5184
    s_waitcnt lgkmcnt(10)
    buffer_store_dwordx4 v[64:67], v4, s[56:59], s74 offen sc1
    s_add_u32 s74, s74, 5120
    s_nop 0
    ds_read_b64_tr_b16 v[64:65], v10 offset:6144
    ds_read_b64_tr_b16 v[66:67], v11 offset:7168
    s_waitcnt lgkmcnt(10)
    buffer_store_dwordx4 v[68:71], v4, s[56:59], s75 offen sc1
    s_add_u32 s75, s75, 5120
    s_nop 0
    ds_read_b64_tr_b16 v[68:69], v10 offset:6208
    ds_read_b64_tr_b16 v[70:71], v11 offset:7232
    s_waitcnt lgkmcnt(10)
    buffer_store_dwordx4 v[72:75], v4, s[56:59], s74 offen sc1
    s_add_u32 s74, s74, 5120
    s_nop 0
    ds_read_b64_tr_b16 v[72:73], v10 offset:7680
    ds_read_b64_tr_b16 v[74:75], v10 offset:8704
    s_waitcnt lgkmcnt(10)
    buffer_store_dwordx4 v[76:79], v4, s[56:59], s75 offen sc1
    s_add_u32 s75, s75, 5120
    s_nop 0
    ds_read_b64_tr_b16 v[76:77], v10 offset:7744
    ds_read_b64_tr_b16 v[78:79], v10 offset:8768
    s_waitcnt lgkmcnt(10)
    buffer_store_dwordx4 v[80:83], v4, s[56:59], s74 offen sc1
    s_add_u32 s74, s74, 5120
    s_waitcnt lgkmcnt(8)
    buffer_store_dwordx4 v[84:87], v4, s[56:59], s75 offen sc1
    s_add_u32 s75, s75, 5120
    s_waitcnt lgkmcnt(6)
    buffer_store_dwordx4 v[64:67], v4, s[56:59], s74 offen sc1
    s_add_u32 s74, s74, 5120
    s_waitcnt lgkmcnt(4)
    buffer_store_dwordx4 v[68:71], v4, s[56:59], s75 offen sc1
    s_add_u32 s75, s75, 5120
    s_waitcnt lgkmcnt(2)
    buffer_store_dwordx4 v[72:75], v4, s[56:59], s74 offen sc1
    s_add_u32 s74, s74, 5120
    s_waitcnt lgkmcnt(0)
    buffer_store_dwordx4 v[76:79], v4, s[56:59], s75 offen sc1
    s_add_u32 s75, s75, 5120
    s_waitcnt vmcnt(0)
    s_barrier
    s_cmp_eq_u32 s3, 0
    s_cbranch_scc0 km_ao
    buffer_load_dword v18, v16, s[52:55], 0 offen sc1
    s_waitcnt vmcnt(0)
    v_cmp_gt_u32 vcc, 1, v18
    s_mov_b32 s7, 0
    s_nop 3
    s_cbranch_vccz km_ao_z_ok
km_ao_z:
    s_sleep 8
    buffer_load_dword v18, v16, s[52:55], 0 offen sc1
    s_add_u32 s7, s7, 1
    s_waitcnt vmcnt(0)
    v_cmp_gt_u32 vcc, 1, v18
    s_cmp_lt_u32 s7, 0x40000
    s_nop 3
    s_cbranch_vccz km_ao_z_ok
    s_cbranch_scc1 km_ao_z
km_ao_z_ok:
    s_add_u32 s48, s26, 20150272
    s_addc_u32 s49, s27, 0
    s_mov_b32 s50, 128
    s_mov_b32 s51, 0x20000
    s_lshl_b32 s41, s39, 2
    v_mov_b32 v18, 1
    s_mov_b64 exec, 1
    buffer_store_dword v18, v16, s[48:51], s41 offen sc1
    s_mov_b64 exec, -1
km_ao:
    s_and_b32 s42, s39, 1
    s_mul_i32 s43, s42, 1105920
    s_mul_i32 s45, s3, 10240
    s_add_u32 s43, s43, s45
    s_lshl_b32 s45, s40, 7
    s_add_u32 s43, s43, s45
    s_add_u32 m0, s44, 0
    s_nop 0
    buffer_load_dwordx4 v9, s[64:67], s43 offen lds
    s_add_u32 s43, s43, 40960
    s_add_u32 m0, s44, 4096
    s_nop 0
    buffer_load_dwordx4 v9, s[64:67], s43 offen lds
    s_add_u32 s43, s43, 40960
    s_add_u32 m0, s44, 8192
    s_nop 0
    buffer_load_dwordx4 v9, s[64:67], s43 offen lds
    s_add_u32 s43, s43, 40960
    s_add_u32 m0, s44, 12288
    s_nop 0
    buffer_load_dwordx4 v9, s[64:67], s43 offen lds
    s_add_u32 s43, s43, 40960
    s_add_u32 m0, s44, 16384
    s_nop 0
    buffer_load_dwordx4 v9, s[64:67], s43 offen lds
    s_add_u32 s43, s43, 40960
    s_add_u32 m0, s44, 20480
    s_nop 0
    buffer_load_dwordx4 v9, s[64:67], s43 offen lds
    s_add_u32 s43, s43, 40960
    s_add_u32 m0, s44, 24576
    s_nop 0
    buffer_load_dwordx4 v9, s[64:67], s43 offen lds
    s_add_u32 s43, s43, 40960
    s_add_u32 m0, s44, 28672
    s_nop 0
    buffer_load_dwordx4 v9, s[64:67], s43 offen lds
    s_add_u32 s43, s43, 40960
    s_add_u32 m0, s44, 32768
    s_nop 0
    buffer_load_dwordx4 v9, s[64:67], s43 offen lds
    s_add_u32 s43, s43, 40960
    s_add_u32 m0, s44, 36864
    s_nop 0
    buffer_load_dwordx4 v9, s[64:67], s43 offen lds
    s_add_u32 s43, s43, 40960
    s_add_u32 m0, s44, 40960
    s_nop 0
    buffer_load_dwordx4 v9, s[64:67], s43 offen lds
    s_add_u32 s43, s43, 40960
    s_add_u32 m0, s44, 45056
    s_nop 0
    buffer_load_dwordx4 v9, s[64:67], s43 offen lds
    s_add_u32 s43, s43, 40960
    s_add_u32 m0, s44, 49152
    s_nop 0
    buffer_load_dwordx4 v9, s[64:67], s43 offen lds
    s_add_u32 s43, s43, 40960
    s_add_u32 m0, s44, 53248
    s_nop 0
    buffer_load_dwordx4 v9, s[64:67], s43 offen lds
    s_add_u32 s43, s43, 40960
    s_add_u32 m0, s44, 57344
    s_nop 0
    buffer_load_dwordx4 v9, s[64:67], s43 offen lds
    s_add_u32 s43, s43, 40960
    s_add_u32 m0, s44, 61440
    s_nop 0
    buffer_load_dwordx4 v9, s[64:67], s43 offen lds
    s_add_u32 s43, s43, 40960
    s_add_u32 m0, s44, 65536
    s_nop 0
    buffer_load_dwordx4 v9, s[64:67], s43 offen lds
    s_add_u32 s43, s43, 40960
    s_add_u32 m0, s44, 69632
    s_nop 0
    buffer_load_dwordx4 v9, s[64:67], s43 offen lds
    s_add_u32 s43, s43, 40960
    s_add_u32 m0, s44, 73728
    s_nop 0
    buffer_load_dwordx4 v9, s[64:67], s43 offen lds
    s_add_u32 s43, s43, 40960
    s_add_u32 m0, s44, 77824
    s_nop 0
    buffer_load_dwordx4 v9, s[64:67], s43 offen lds
    s_add_u32 s43, s43, 40960
    s_add_u32 m0, s44, 81920
    s_nop 0
    buffer_load_dwordx4 v9, s[64:67], s43 offen lds
    s_add_u32 s43, s43, 40960
    s_add_u32 m0, s44, 86016
    s_nop 0
    buffer_load_dwordx4 v9, s[64:67], s43 offen lds
    s_add_u32 s43, s43, 40960
    s_add_u32 m0, s44, 90112
    s_nop 0
    buffer_load_dwordx4 v9, s[64:67], s43 offen lds
    s_add_u32 s43, s43, 40960
    s_add_u32 m0, s44, 94208
    s_nop 0
    buffer_load_dwordx4 v9, s[64:67], s43 offen lds
    s_add_u32 s43, s43, 40960
    s_add_u32 m0, s44, 98304
    s_nop 0
    buffer_load_dwordx4 v9, s[64:67], s43 offen lds
    s_add_u32 s43, s43, 40960
    s_add_u32 m0, s44, 102400
    s_nop 0
    buffer_load_dwordx4 v9, s[64:67], s43 offen lds
    s_add_u32 s43, s43, 40960
    s_add_u32 m0, s44, 106496
    s_nop 0
    buffer_load_dwordx4 v9, s[64:67], s43 offen lds
    s_lshl_b32 s45, s40, 2
    s_add_u32 s45, s45, s3
    s_mul_i32 s46, s45, 52429
    s_lshr_b32 s46, s46, 18
    s_mul_i32 s47, s46, 5
    s_sub_u32 s45, s45, s47
    s_mul_i32 s46, s46, 54
    s_mul_i32 s47, s42, 27
    s_add_u32 s46, s46, s47
    s_mul_i32 s46, s46, 5
    s_add_u32 s46, s46, s45
    s_lshl_b32 s72, s46, 10
    s_waitcnt vmcnt(18)
    s_barrier
    ds_read_b64_tr_b16 v[64:65], v20 offset:0
    ds_read_b64_tr_b16 v[66:67], v20 offset:1024
    ds_read_b64_tr_b16 v[68:69], v20 offset:4096
    ds_read_b64_tr_b16 v[70:71], v20 offset:5120
    ds_read_b64_tr_b16 v[72:73], v20 offset:8192
    ds_read_b64_tr_b16 v[74:75], v20 offset:9216
    ds_read_b64_tr_b16 v[76:77], v20 offset:12288
    ds_read_b64_tr_b16 v[78:79], v20 offset:13312
    ds_read_b64_tr_b16 v[80:81], v20 offset:16384
    ds_read_b64_tr_b16 v[82:83], v20 offset:17408
    ds_read_b64_tr_b16 v[84:85], v20 offset:20480
    ds_read_b64_tr_b16 v[86:87], v20 offset:21504
    s_waitcnt lgkmcnt(10)
    buffer_store_dwordx4 v[64:67], v4, s[68:71], s72 offen sc1
    s_add_u32 s72, s72, 5120
    s_nop 0
    ds_read_b64_tr_b16 v[64:65], v20 offset:24576
    ds_read_b64_tr_b16 v[66:67], v20 offset:25600
    s_waitcnt lgkmcnt(10)
    buffer_store_dwordx4 v[68:71], v4, s[68:71], s72 offen sc1
    s_add_u32 s72, s72, 5120
    s_nop 0
    ds_read_b64_tr_b16 v[68:69], v20 offset:28672
    ds_read_b64_tr_b16 v[70:71], v20 offset:29696
    s_waitcnt lgkmcnt(10)
    buffer_store_dwordx4 v[72:75], v4, s[68:71], s72 offen sc1
    s_add_u32 s72, s72, 5120
    s_nop 0
    ds_read_b64_tr_b16 v[72:73], v20 offset:32768
    ds_read_b64_tr_b16 v[74:75], v20 offset:33792
    s_waitcnt lgkmcnt(10)
    buffer_store_dwordx4 v[76:79], v4, s[68:71], s72 offen sc1
    s_add_u32 s72, s72, 5120
    s_waitcnt vmcnt(13)
    s_barrier
    ds_read_b64_tr_b16 v[76:77], v20 offset:36864
    ds_read_b64_tr_b16 v[78:79], v20 offset:37888
    s_waitcnt lgkmcnt(10)
    buffer_store_dwordx4 v[80:83], v4, s[68:71], s72 offen sc1
    s_add_u32 s72, s72, 5120
    s_nop 0
    ds_read_b64_tr_b16 v[80:81], v20 offset:40960
    ds_read_b64_tr_b16 v[82:83], v20 offset:41984
    s_waitcnt lgkmcnt(10)
    buffer_store_dwordx4 v[84:87], v4, s[68:71], s72 offen sc1
    s_add_u32 s72, s72, 5120
    s_nop 0
    ds_read_b64_tr_b16 v[84:85], v20 offset:45056
    ds_read_b64_tr_b16 v[86:87], v20 offset:46080
    s_waitcnt lgkmcnt(10)
    buffer_store_dwordx4 v[64:67], v4, s[68:71], s72 offen sc1
    s_add_u32 s72, s72, 5120
    s_nop 0
    ds_read_b64_tr_b16 v[64:65], v20 offset:49152
    ds_read_b64_tr_b16 v[66:67], v20 offset:50176
    s_waitcnt lgkmcnt(10)
    buffer_store_dwordx4 v[68:71], v4, s[68:71], s72 offen sc1
    s_add_u32 s72, s72, 5120
    s_nop 0
    ds_read_b64_tr_b16 v[68:69], v20 offset:53248
    ds_read_b64_tr_b16 v[70:71], v20 offset:54272
    s_waitcnt lgkmcnt(10)
    buffer_store_dwordx4 v[72:75], v4, s[68:71], s72 offen sc1
    s_add_u32 s72, s72, 5120
    s_nop 0
    ds_read_b64_tr_b16 v[72:73], v20 offset:57344
    ds_read_b64_tr_b16 v[74:75], v20 offset:58368
    s_waitcnt lgkmcnt(10)
    buffer_store_dwordx4 v[76:79], v4, s[68:71], s72 offen sc1
    s_add_u32 s72, s72, 5120
    s_nop 0
    ds_read_b64_tr_b16 v[76:77], v20 offset:61440
    ds_read_b64_tr_b16 v[78:79], v20 offset:62464
    s_waitcnt lgkmcnt(10)
    buffer_store_dwordx4 v[80:83], v4, s[68:71], s72 offen sc1
    s_add_u32 s72, s72, 5120
    s_nop 0
    ds_read_b64_tr_b16 v[80:81], v21 offset:0
    ds_read_b64_tr_b16 v[82:83], v21 offset:1024
    s_waitcnt lgkmcnt(10)
    buffer_store_dwordx4 v[84:87], v4, s[68:71], s72 offen sc1
    s_add_u32 s72, s72, 5120
    s_nop 0
    ds_read_b64_tr_b16 v[84:85], v21 offset:4096
    ds_read_b64_tr_b16 v[86:87], v21 offset:5120
    s_waitcnt lgkmcnt(10)
    buffer_store_dwordx4 v[64:67], v4, s[68:71], s72 offen sc1
    s_add_u32 s72, s72, 5120
    s_waitcnt vmcnt(13)
    s_barrier
    ds_read_b64_tr_b16 v[64:65], v21 offset:8192
    ds_read_b64_tr_b16 v[66:67], v21 offset:9216
    s_waitcnt lgkmcnt(10)
    buffer_store_dwordx4 v[68:71], v4, s[68:71], s72 offen sc1
    s_add_u32 s72, s72, 5120
    s_nop 0
    ds_read_b64_tr_b16 v[68:69], v21 offset:12288
    ds_read_b64_tr_b16 v[70:71], v21 offset:13312
    s_waitcnt lgkmcnt(10)
    buffer_store_dwordx4 v[72:75], v4, s[68:71], s72 offen sc1
    s_add_u32 s72, s72, 5120
    s_nop 0
    ds_read_b64_tr_b16 v[72:73], v21 offset:16384
    ds_read_b64_tr_b16 v[74:75], v21 offset:17408
    s_waitcnt lgkmcnt(10)
    buffer_store_dwordx4 v[76:79], v4, s[68:71], s72 offen sc1
    s_add_u32 s72, s72, 5120
    s_nop 0
    ds_read_b64_tr_b16 v[76:77], v21 offset:20480
    ds_read_b64_tr_b16 v[78:79], v21 offset:21504
    s_waitcnt lgkmcnt(10)
    buffer_store_dwordx4 v[80:83], v4, s[68:71], s72 offen sc1
    s_add_u32 s72, s72, 5120
    s_nop 0
    ds_read_b64_tr_b16 v[80:81], v21 offset:24576
    ds_read_b64_tr_b16 v[82:83], v21 offset:25600
    s_waitcnt lgkmcnt(10)
    buffer_store_dwordx4 v[84:87], v4, s[68:71], s72 offen sc1
    s_add_u32 s72, s72, 5120
    s_nop 0
    ds_read_b64_tr_b16 v[84:85], v21 offset:28672
    ds_read_b64_tr_b16 v[86:87], v21 offset:29696
    s_waitcnt lgkmcnt(10)
    buffer_store_dwordx4 v[64:67], v4, s[68:71], s72 offen sc1
    s_add_u32 s72, s72, 5120
    s_nop 0
    ds_read_b64_tr_b16 v[64:65], v21 offset:32768
    ds_read_b64_tr_b16 v[66:67], v21 offset:33792
    s_waitcnt lgkmcnt(10)
    buffer_store_dwordx4 v[68:71], v4, s[68:71], s72 offen sc1
    s_add_u32 s72, s72, 5120
    s_nop 0
    ds_read_b64_tr_b16 v[68:69], v21 offset:36864
    ds_read_b64_tr_b16 v[70:71], v21 offset:37888
    s_waitcnt lgkmcnt(10)
    buffer_store_dwordx4 v[72:75], v4, s[68:71], s72 offen sc1
    s_add_u32 s72, s72, 5120
    s_nop 0
    ds_read_b64_tr_b16 v[72:73], v21 offset:40960
    ds_read_b64_tr_b16 v[74:75], v21 offset:41984
    s_waitcnt lgkmcnt(10)
    buffer_store_dwordx4 v[76:79], v4, s[68:71], s72 offen sc1
    s_add_u32 s72, s72, 5120
    s_waitcnt lgkmcnt(8)
    buffer_store_dwordx4 v[80:83], v4, s[68:71], s72 offen sc1
    s_add_u32 s72, s72, 5120
    s_waitcnt lgkmcnt(6)
    buffer_store_dwordx4 v[84:87], v4, s[68:71], s72 offen sc1
    s_add_u32 s72, s72, 5120
    s_waitcnt lgkmcnt(4)
    buffer_store_dwordx4 v[64:67], v4, s[68:71], s72 offen sc1
    s_add_u32 s72, s72, 5120
    s_waitcnt lgkmcnt(2)
    buffer_store_dwordx4 v[68:71], v4, s[68:71], s72 offen sc1
    s_add_u32 s72, s72, 5120
    s_waitcnt lgkmcnt(0)
    buffer_store_dwordx4 v[72:75], v4, s[68:71], s72 offen sc1
    s_waitcnt vmcnt(0)
    s_barrier
    s_cmp_eq_u32 s3, 0
    s_cbranch_scc0 km_ad
    buffer_load_dword v18, v16, s[52:55], 0 offen sc1
    s_waitcnt vmcnt(0)
    v_cmp_gt_u32 vcc, 1, v18
    s_mov_b32 s7, 0
    s_nop 3
    s_cbranch_vccz km_ad_z_ok
km_ad_z:
    s_sleep 8
    buffer_load_dword v18, v16, s[52:55], 0 offen sc1
    s_add_u32 s7, s7, 1
    s_waitcnt vmcnt(0)
    v_cmp_gt_u32 vcc, 1, v18
    s_cmp_lt_u32 s7, 0x40000
    s_nop 3
    s_cbranch_vccz km_ad_z_ok
    s_cbranch_scc1 km_ad_z
km_ad_z_ok:
    s_add_u32 s48, s26, 20152320
    s_addc_u32 s49, s27, 0
    s_mov_b32 s50, 128
    s_mov_b32 s51, 0x20000
    s_lshl_b32 s40, s39, 2
    v_mov_b32 v18, 1
    s_mov_b64 exec, 1
    buffer_store_dword v18, v16, s[48:51], s40 offen sc1
    s_mov_b64 exec, -1
km_ad:
    s_branch km_rl_x
km_rl_x:
    v_lshlrev_b32 v200, 4, v1
    buffer_load_dword v59, v16, s[52:55], 0 offen sc1
    s_waitcnt vmcnt(0)
    v_cmp_gt_u32 vcc, 1, v59
    s_mov_b32 s7, 0
    s_nop 3
    s_cbranch_vccz km_zr_ok
km_zr:
    s_sleep 8
    buffer_load_dword v59, v16, s[52:55], 0 offen sc1
    s_add_u32 s7, s7, 1
    s_waitcnt vmcnt(0)
    v_cmp_gt_u32 vcc, 1, v59
    s_cmp_lt_u32 s7, 0x40000
    s_nop 3
    s_cbranch_vccz km_zr_ok
    s_cbranch_scc1 km_zr
km_zr_ok:
    s_cmp_lt_u32 s29, 27
    s_cselect_b32 s39, 1, 0
    s_branch km_wo
km_A:
    s_lshr_b32 s29, s2, 3
    s_lshl_b32 s30, s28, 3
    s_and_b32 s31, s29, 7
    s_add_u32 s30, s30, s31
    s_lshr_b32 s31, s29, 3
    v_and_b32 v10, 7, v1
    v_min_u32 v10, 4, v10
    v_lshlrev_b32 v10, 7, v10
    s_lshr_b32 s34, s30, 2
    s_mul_i32 s34, s34, 640
    s_add_u32 s34, s34, 65536
    s_add_u32 s48, s26, 20072448
    s_addc_u32 s49, s27, 0
    s_mov_b32 s50, 98304
    s_mov_b32 s51, 0x20000
    buffer_load_dword v26, v10, s[48:51], s34 offen sc1
    v_and_b32 v2, 31, v1
    v_lshrrev_b32 v3, 5, v1
    v_lshlrev_b32 v4, 4, v1
    v_lshlrev_b32 v9, 3, v2
    v_add_u32 v9, 1024, v9
    v_lshl_add_u32 v9, v3, 26, v9
    s_lshl_b32 s33, s30, 5
    s_lshl_b32 s32, s3, 3
    s_add_u32 s33, s33, s32
    s_mul_i32 s33, s33, 1280
    s_mul_i32 s32, s3, 13440
    v_mov_b32 v136, 0
    v_lshlrev_b32 v136, 7, v136
    v_min_u32 v137, 26, v1
    v_lshlrev_b32 v137, 2, v137
    v_min_u32 v138, 19, v1
    v_lshlrev_b32 v138, 2, v138
    s_add_u32 s40, s26, 7565312
    s_addc_u32 s41, s27, 0
    s_mov_b32 s42, 53760
    s_mov_b32 s43, 0x20000
    s_add_u32 s44, s26, 7751680
    s_addc_u32 s45, s27, 0
    s_mov_b32 s46, 2621440
    s_mov_b32 s47, 0x20000
    s_barrier
    s_waitcnt vmcnt(0)
    v_cmp_gt_u32 vcc, 1, v26
    s_mov_b32 s7, 0
    s_nop 3
    s_cbranch_vccz km_wq_ok
km_wq:
    s_sleep 8
    buffer_load_dword v26, v10, s[48:51], s34 offen sc1
    s_add_u32 s7, s7, 1
    s_waitcnt vmcnt(0)
    v_cmp_gt_u32 vcc, 1, v26
    s_cmp_lt_u32 s7, 0x40000
    s_nop 3
    s_cbranch_vccz km_wq_ok
    s_cbranch_scc1 km_wq
km_wq_ok:
    buffer_load_dwordx4 a[200:203], v4, s[44:47], s33 offen offset:0
    buffer_load_dwordx2 a[204:205], v9, s[44:47], s33 offen offset:0
    buffer_load_dwordx4 a[206:209], v4, s[44:47], s33 offen offset:1280
    buffer_load_dwordx2 a[210:211], v9, s[44:47], s33 offen offset:1280
    s_add_u32 s33, s33, 2560
    buffer_load_dwordx4 a[212:215], v4, s[44:47], s33 offen offset:0
    buffer_load_dwordx2 a[216:217], v9, s[44:47], s33 offen offset:0
    buffer_load_dwordx4 a[218:221], v4, s[44:47], s33 offen offset:1280
    buffer_load_dwordx2 a[222:223], v9, s[44:47], s33 offen offset:1280
    s_add_u32 s33, s33, 2560
    buffer_load_dwordx4 a[224:227], v4, s[44:47], s33 offen offset:0
    buffer_load_dwordx2 a[228:229], v9, s[44:47], s33 offen offset:0
    buffer_load_dwordx4 a[230:233], v4, s[44:47], s33 offen offset:1280
    buffer_load_dwordx2 a[234:235], v9, s[44:47], s33 offen offset:1280
    s_add_u32 s33, s33, 2560
    buffer_load_dwordx4 a[236:239], v4, s[44:47], s33 offen offset:0
    buffer_load_dwordx2 a[240:241], v9, s[44:47], s33 offen offset:0
    buffer_load_dwordx4 a[242:245], v4, s[44:47], s33 offen offset:1280
    buffer_load_dwordx2 a[246:247], v9, s[44:47], s33 offen offset:1280
    s_add_u32 s33, s33, 2560
    s_add_u32 s5, s5, 4096
    buffer_load_dwordx4 a[192:195], v4, s[60:63], s5 offen
    buffer_load_dwordx4 a[196:199], v4, s[60:63], s5 offen offset:1024
    s_mov_b32 s34, 78848
    s_mov_b32 s33, 79872
    buffer_load_dword v28, v137, s[48:51], s34 offen sc1
    s_lshl_b32 s5, s3, 7
    s_add_u32 s5, s5, 82432
    buffer_load_dword v26, v136, s[48:51], s5 offen sc1
    s_mov_b32 s61, s39
    v_mov_b32 v7, 0x100000
    v_cmp_gt_u32 vcc, 20, v2
    s_nop 1
    v_cndmask_b32 v5, v7, v2, vcc
    v_subrev_u32 v8, 4, v2
    v_cmp_gt_u32 vcc, 24, v2
    s_nop 1
    v_cndmask_b32 v6, v7, v8, vcc
    v_cmp_gt_u32 vcc, 20, v2
    s_nop 1
    v_cndmask_b32 v6, v6, v7, vcc
    v_cmp_gt_u32 vcc, 16, v2
    s_nop 1
    v_cndmask_b32 v6, v6, v2, vcc
    v_and_b32 v8, 27, v2
    v_cmp_eq_u32 vcc, 24, v8
    s_nop 1
    v_cndmask_b32 v5, v5, 20, vcc
    v_cndmask_b32 v6, v6, 20, vcc
    v_lshlrev_b32 v5, 4, v5
    v_lshlrev_b32 v6, 4, v6
    v_lshl_add_u32 v7, v3, 26, v5
    v_lshl_add_u32 v8, v3, 26, v6
    v_mul_u32_u24 v9, 672, v3
    v_add_u32 v5, v5, v9
    v_add_u32 v6, v6, v9
    s_mov_b32 s52, s8
    s_mov_b32 s53, s9
    s_mov_b32 s54, 2621440
    s_mov_b32 s55, 0x20000
    s_add_u32 s56, s26, 10373120
    s_addc_u32 s57, s27, 0
    s_mov_b32 s58, 2621440
    s_mov_b32 s59, 0x20000
    s_add_u32 s72, s26, 7620608
    s_addc_u32 s73, s27, 0
    s_mov_b32 s74, 131072
    s_mov_b32 s75, 0x20000
    s_mov_b32 s68, s26
    s_mov_b32 s69, s27
    s_mov_b32 s70, 4423680
    s_mov_b32 s71, 0x20000
    s_add_u32 s44, s26, 4534272
    s_addc_u32 s45, s27, 0
    s_mov_b32 s46, 2211840
    s_mov_b32 s47, 0x20000
    v_lshrrev_b32 v10, 2, v1
    s_and_b32 s37, s3, 1
    s_lshl_b32 s37, s37, 4
    v_add_u32 v14, s37, v10
    v_and_b32 v15, 3, v1
    v_mul_u32_u24 v10, 1280, v14
    v_lshl_add_u32 v10, v15, 3, v10
    s_lshr_b32 s39, s3, 1
    s_mul_i32 s35, s30, 40960
    s_mul_i32 s36, s31, 320
    s_add_u32 s35, s35, s36
    s_mul_i32 s36, s39, 160
    s_add_u32 s35, s35, s36
    s_mul_i32 s36, s30, 40
    s_mul_i32 s37, s31, 10
    s_add_u32 s36, s36, s37
    s_mul_i32 s37, s39, 5
    s_add_u32 s36, s36, s37
    s_lshl_b32 s36, s36, 10
    s_mul_i32 s37, s3, 20480
    s_add_u32 s37, s37, 81920
    v_lshlrev_b32 v3, 6, v3
    v_xor_b32 v11, v3, v4
    v_add_u32 v11, s37, v11
    v_xor_b32 v9, 128, v11
    v_lshlrev_b32 v13, 4, v14
    v_and_b32 v2, 1, v15
    v_lshl_add_u32 v2, v2, 9, v13
    v_lshrrev_b32 v3, 1, v15
    v_lshl_add_u32 v12, v3, 10, v2
    v_lshlrev_b32 v27, 6, v15
    v_xor_b32 v12, v27, v12
    s_mul_i32 s37, s39, 10240
    s_add_u32 s37, s37, 81920
    v_add_u32 v12, s37, v12
    v_add_u32 v14, 40960, v12
    v_lshl_add_u32 v2, v3, 3, v2
    v_add_u32 v15, 1024, v4
    s_lshl_b32 s38, s30, 11
    s_lshl_b32 s37, s31, 9
    s_add_u32 s38, s38, s37
    s_lshl_b32 s37, s39, 3
    s_add_u32 s38, s38, s37
    s_lshl_b32 s4, s30, 2
    s_add_u32 s4, s4, s31
    s_lshl_b32 s4, s4, 7
    s_lshr_b32 s64, s28, 1
    s_lshl_b32 s64, s64, 2
    s_and_b32 s67, s29, 3
    s_add_u32 s64, s64, s67
    s_and_b32 s67, s28, 1
    s_lshl_b32 s67, s67, 3
    s_lshr_b32 s37, s29, 2
    s_add_u32 s67, s67, s37
    s_lshl_b32 s6, s64, 2
    s_add_u32 s6, s6, s3
    s_lshl_b32 s60, s6, 9
    s_lshl_b32 s6, s64, 4
    s_add_u32 s6, s6, s67
    s_lshl_b32 s6, s6, 7
    s_add_u32 s6, s6, 32768
    s_mul_i32 s67, s67, 7
    s_mul_i32 s65, s67, 40960
    s_lshl_b32 s66, s3, 10
    v_add_u32 v139, s66, v4
    s_lshr_b32 s16, s28, 1
    s_lshl_b32 s16, s16, 3
    s_and_b32 s18, s29, 7
    s_add_u32 s16, s16, s18
    s_and_b32 s17, s28, 1
    s_lshl_b32 s17, s17, 2
    s_lshr_b32 s37, s29, 3
    s_add_u32 s17, s17, s37
    s_and_b32 s18, s18, 3
    s_mul_i32 s8, s17, 54
    s_mul_i32 s37, s3, 14
    s_add_u32 s8, s8, s37
    s_mul_i32 s8, s8, 5120
    s_mul_i32 s12, s16, 221184
    s_mul_i32 s37, s3, 28672
    s_add_u32 s12, s12, s37
    s_cmp_eq_u32 s3, 3
    s_cselect_b32 s9, 67108864, s8
    s_cselect_b32 s13, 67108864, s12
    s_lshr_b32 s18, s16, 1
    s_lshl_b32 s18, s18, 2
    s_add_u32 s18, s18, s3
    s_lshl_b32 s18, s18, 9
    s_add_u32 s18, s18, 32768
    s_waitcnt vmcnt(1)
    v_cmp_gt_u32 vcc, 1, v28
    s_mov_b32 s7, 0
    s_nop 3
    s_cbranch_vccz km_wu_ok
km_wu:
    s_sleep 8
    buffer_load_dword v28, v137, s[48:51], s34 offen sc1
    s_add_u32 s7, s7, 1
    s_waitcnt vmcnt(0)
    v_cmp_gt_u32 vcc, 1, v28
    s_cmp_lt_u32 s7, 0x40000
    s_nop 3
    s_cbranch_vccz km_wu_ok
    s_cbranch_scc1 km_wu
km_wu_ok:
    s_cmp_eq_u32 s61, 0
    s_cbranch_scc1 km_r0
    s_add_u32 m0, s66, 0
    s_add_u32 s7, s65, 0
    buffer_load_dwordx4 v139, s[68:71], s7 offen lds
    s_add_u32 m0, s66, 8192
    s_add_u32 s7, s65, 40960
    buffer_load_dwordx4 v139, s[68:71], s7 offen lds
    s_add_u32 m0, s66, 16384
    s_add_u32 s7, s65, 81920
    buffer_load_dwordx4 v139, s[68:71], s7 offen lds
    s_add_u32 m0, s66, 4096
    s_add_u32 s7, s65, 4096
    buffer_load_dwordx4 v139, s[68:71], s7 offen lds
    s_add_u32 m0, s66, 12288
    s_add_u32 s7, s65, 45056
    buffer_load_dwordx4 v139, s[68:71], s7 offen lds
    s_add_u32 m0, s66, 20480
    s_add_u32 s7, s65, 86016
    buffer_load_dwordx4 v139, s[68:71], s7 offen lds
    s_add_u32 m0, s66, 24576
    s_add_u32 s7, s65, 8192
    buffer_load_dwordx4 v139, s[68:71], s7 offen lds
    s_add_u32 m0, s66, 32768
    s_add_u32 s7, s65, 49152
    buffer_load_dwordx4 v139, s[68:71], s7 offen lds
    s_add_u32 m0, s66, 40960
    s_add_u32 s7, s65, 90112
    buffer_load_dwordx4 v139, s[68:71], s7 offen lds
    s_add_u32 m0, s66, 28672
    s_add_u32 s7, s65, 12288
    buffer_load_dwordx4 v139, s[68:71], s7 offen lds
    s_add_u32 m0, s66, 36864
    s_add_u32 s7, s65, 53248
    buffer_load_dwordx4 v139, s[68:71], s7 offen lds
    s_add_u32 m0, s66, 45056
    s_add_u32 s7, s65, 94208
    buffer_load_dwordx4 v139, s[68:71], s7 offen lds
    s_add_u32 m0, s66, 49152
    s_add_u32 s7, s65, 16384
    buffer_load_dwordx4 v139, s[68:71], s7 offen lds
    s_add_u32 m0, s66, 57344
    s_add_u32 s7, s65, 57344
    buffer_load_dwordx4 v139, s[68:71], s7 offen lds
    s_add_u32 m0, s66, 65536
    s_add_u32 s7, s65, 98304
    buffer_load_dwordx4 v139, s[68:71], s7 offen lds
    s_add_u32 m0, s66, 53248
    s_add_u32 s7, s65, 20480
    buffer_load_dwordx4 v139, s[68:71], s7 offen lds
    s_add_u32 m0, s66, 61440
    s_add_u32 s7, s65, 61440
    buffer_load_dwordx4 v139, s[68:71], s7 offen lds
    s_add_u32 m0, s66, 69632
    s_add_u32 s7, s65, 102400
    buffer_load_dwordx4 v139, s[68:71], s7 offen lds
km_r0:
    s_waitcnt vmcnt(0)
    v_cmp_gt_u32 vcc, 1, v26
    s_mov_b32 s7, 0
    s_nop 3
    s_cbranch_vccz km_wk_ok
km_wk:
    s_sleep 2
    s_cmp_eq_u32 s61, 0
    s_cbranch_scc1 km_wk_f
    s_sleep 16
km_wk_f:
    buffer_load_dword v26, v136, s[48:51], s5 offen sc1
    s_add_u32 s7, s7, 1
    s_waitcnt vmcnt(0)
    v_cmp_gt_u32 vcc, 1, v26
    s_cmp_lt_u32 s7, 0x40000
    s_nop 3
    s_cbranch_vccz km_wk_ok
    s_cbranch_scc1 km_wk
km_wk_ok:
    buffer_load_dwordx4 v[204:207], v5, s[40:43], s32 offen offset:0
    buffer_load_dwordx4 v[208:211], v5, s[40:43], s32 offen offset:336
    buffer_load_dwordx4 v[212:215], v7, s[40:43], s32 offen offset:1344
    buffer_load_dwordx4 v[216:219], v6, s[40:43], s32 offen offset:1680
    buffer_load_dwordx4 v[220:223], v6, s[40:43], s32 offen offset:2016
    buffer_load_dwordx4 v[224:227], v8, s[40:43], s32 offen offset:3024
    s_add_u32 s32, s32, 3360
    buffer_load_dwordx4 v[228:231], v5, s[40:43], s32 offen offset:0
    buffer_load_dwordx4 v[232:235], v5, s[40:43], s32 offen offset:336
    buffer_load_dwordx4 v[236:239], v7, s[40:43], s32 offen offset:1344
    buffer_load_dwordx4 v[240:243], v6, s[40:43], s32 offen offset:1680
    buffer_load_dwordx4 v[244:247], v6, s[40:43], s32 offen offset:2016
    buffer_load_dwordx4 v[248:251], v8, s[40:43], s32 offen offset:3024
    s_add_u32 s32, s32, 3360
    s_waitcnt vmcnt(11)
    v_cvt_pk_bf16_f32 v204, v204, v205
    s_waitcnt vmcnt(8)
    v_cvt_pk_bf16_f32 v216, v216, v217
    v_cvt_pk_bf16_f32 v205, v206, v207
    v_cvt_pk_bf16_f32 v217, v218, v219
    v_cvt_pk_bf16_f32 v206, v208, v209
    s_waitcnt vmcnt(7)
    v_cvt_pk_bf16_f32 v218, v220, v221
    v_cvt_pk_bf16_f32 v207, v210, v211
    v_cvt_pk_bf16_f32 v219, v222, v223
    v_cvt_pk_bf16_f32 v208, v212, v213
    s_waitcnt vmcnt(6)
    v_cvt_pk_bf16_f32 v220, v224, v225
    v_cvt_pk_bf16_f32 v209, v214, v215
    v_cvt_pk_bf16_f32 v221, v226, v227
    v_mfma_f32_32x32x16_bf16 v[140:155], v[204:207], a[200:203], 0
    s_waitcnt vmcnt(5)
    v_cvt_pk_bf16_f32 v228, v228, v229
    s_waitcnt vmcnt(2)
    v_cvt_pk_bf16_f32 v240, v240, v241
    v_cvt_pk_bf16_f32 v229, v230, v231
    v_cvt_pk_bf16_f32 v241, v242, v243
    v_cvt_pk_bf16_f32 v230, v232, v233
    s_waitcnt vmcnt(1)
    v_cvt_pk_bf16_f32 v242, v244, v245
    v_mfma_f32_32x32x16_bf16 v[156:171], v[216:219], a[206:209], 0
    v_cvt_pk_bf16_f32 v231, v234, v235
    v_cvt_pk_bf16_f32 v243, v246, v247
    v_cvt_pk_bf16_f32 v232, v236, v237
    s_waitcnt vmcnt(0)
    v_cvt_pk_bf16_f32 v244, v248, v249
    v_cvt_pk_bf16_f32 v233, v238, v239
    v_cvt_pk_bf16_f32 v245, v250, v251
    v_mfma_f32_32x32x8_bf16 v[140:155], v[208:209], a[204:205], v[140:155]
    buffer_load_dwordx4 v[204:207], v5, s[40:43], s32 offen offset:0
    s_nop 0
    v_mfma_f32_32x32x8_bf16 v[156:171], v[220:221], a[210:211], v[156:171]
    buffer_load_dwordx4 v[208:211], v5, s[40:43], s32 offen offset:336
    v_mfma_f32_32x32x16_bf16 v[172:187], v[228:231], a[212:215], 0
    buffer_load_dwordx4 v[212:215], v7, s[40:43], s32 offen offset:1344
    v_mfma_f32_32x32x16_bf16 v[188:203], v[240:243], a[218:221], 0
    buffer_load_dwordx4 v[216:219], v6, s[40:43], s32 offen offset:1680
    s_nop 3
    v_add_f32 v152, 0x358637bd, v152
    s_nop 1
    v_add_f32 v168, 0x358637bd, v168
    v_rcp_f32 v152, v152
    v_mfma_f32_32x32x8_bf16 v[172:187], v[232:233], a[216:217], v[172:187]
    buffer_load_dwordx4 v[220:223], v6, s[40:43], s32 offen offset:2016
    v_rcp_f32 v168, v168
    v_mul_f32 v140, v140, v152
    v_mul_f32 v141, v141, v152
    v_mul_f32 v142, v142, v152
    v_mfma_f32_32x32x8_bf16 v[188:203], v[244:245], a[222:223], v[188:203]
    buffer_load_dwordx4 v[224:227], v8, s[40:43], s32 offen offset:3024
    s_add_u32 s32, s32, 3360
    v_mul_f32 v143, v143, v152
    v_mul_f32 v148, v148, v152
    v_mul_f32 v149, v149, v152
    v_mul_f32 v150, v150, v152
    v_mul_f32 v151, v151, v152
    v_cvt_pk_bf16_f32 v16, v140, v141
    v_cvt_pk_bf16_f32 v17, v142, v143
    v_mul_f32 v144, v144, v152
    v_mul_f32 v145, v145, v152
    v_mul_f32 v146, v146, v152
    v_mul_f32 v147, v147, v152
    v_cvt_pk_bf16_f32 v18, v144, v145
    v_cvt_pk_bf16_f32 v19, v146, v147
    v_mul_f32 v156, v156, v168
    v_mul_f32 v157, v157, v168
    v_mul_f32 v158, v158, v168
    v_mul_f32 v159, v159, v168
    v_fmac_f32 v148, v164, v168
    v_fmac_f32 v149, v165, v168
    v_fmac_f32 v150, v166, v168
    v_fmac_f32 v151, v167, v168
    v_cvt_pk_bf16_f32 v22, v156, v157
    v_cvt_pk_bf16_f32 v23, v158, v159
    v_mul_f32 v160, v160, v168
    v_mul_f32 v161, v161, v168
    v_mul_f32 v162, v162, v168
    v_mul_f32 v163, v163, v168
    v_cvt_pk_bf16_f32 v24, v160, v161
    v_cvt_pk_bf16_f32 v25, v162, v163
    v_cvt_pk_bf16_f32 v20, v148, v149
    v_cvt_pk_bf16_f32 v21, v150, v151
    v_mfma_f32_32x32x16_bf16 v[56:71], a[0:3], v[16:19], 0
    buffer_load_dwordx4 v[228:231], v5, s[40:43], s32 offen offset:0
    s_waitcnt vmcnt(6)
    v_cvt_pk_bf16_f32 v204, v204, v205
    s_waitcnt vmcnt(3)
    v_cvt_pk_bf16_f32 v216, v216, v217
    v_cvt_pk_bf16_f32 v205, v206, v207
    v_cvt_pk_bf16_f32 v217, v218, v219
    v_cvt_pk_bf16_f32 v206, v208, v209
    v_mfma_f32_32x32x16_bf16 v[72:87], a[4:7], v[16:19], 0
    buffer_load_dwordx4 v[232:235], v5, s[40:43], s32 offen offset:336
    s_waitcnt vmcnt(3)
    v_cvt_pk_bf16_f32 v218, v220, v221
    v_cvt_pk_bf16_f32 v207, v210, v211
    v_cvt_pk_bf16_f32 v219, v222, v223
    v_cvt_pk_bf16_f32 v208, v212, v213
    s_waitcnt vmcnt(2)
    v_cvt_pk_bf16_f32 v220, v224, v225
    v_mfma_f32_32x32x16_bf16 v[88:103], a[8:11], v[16:19], 0
    buffer_load_dwordx4 v[236:239], v7, s[40:43], s32 offen offset:1344
    v_cvt_pk_bf16_f32 v209, v214, v215
    v_cvt_pk_bf16_f32 v221, v226, v227
    v_add_f32 v184, 0x358637bd, v184
    v_add_f32 v200, 0x358637bd, v200
    v_mfma_f32_32x32x16_bf16 v[104:119], a[12:15], v[16:19], 0
    buffer_load_dwordx4 v[240:243], v6, s[40:43], s32 offen offset:1680
    v_rcp_f32 v184, v184
    v_rcp_f32 v200, v200
    v_mul_f32 v172, v172, v184
    v_mfma_f32_32x32x16_bf16 v[120:135], a[16:19], v[16:19], 0
    buffer_load_dwordx4 v[244:247], v6, s[40:43], s32 offen offset:2016
    v_mul_f32 v173, v173, v184
    v_mul_f32 v174, v174, v184
    v_mul_f32 v175, v175, v184
    v_mul_f32 v180, v180, v184
    v_mul_f32 v181, v181, v184
    v_mfma_f32_32x32x16_bf16 v[140:155], v[204:207], a[224:227], 0
    buffer_load_dwordx4 v[248:251], v8, s[40:43], s32 offen offset:3024
    s_add_u32 s32, s32, 3360
    v_mul_f32 v182, v182, v184
    v_mul_f32 v183, v183, v184
    v_cvt_pk_bf16_f32 v26, v172, v173
    v_cvt_pk_bf16_f32 v27, v174, v175
    v_mfma_f32_32x32x16_bf16 v[156:171], v[216:219], a[230:233], 0
    v_mul_f32 v176, v176, v184
    v_mul_f32 v177, v177, v184
    v_mul_f32 v178, v178, v184
    v_mul_f32 v179, v179, v184
    v_cvt_pk_bf16_f32 v28, v176, v177
    v_cvt_pk_bf16_f32 v29, v178, v179
    s_cmp_eq_u32 s61, 0
    s_cbranch_scc0 km_r1
    s_add_u32 m0, s66, 0
    s_add_u32 s7, s65, 0
    buffer_load_dwordx4 v139, s[68:71], s7 offen lds
    s_add_u32 m0, s66, 4096
    s_add_u32 s7, s65, 4096
    buffer_load_dwordx4 v139, s[68:71], s7 offen lds
    s_add_u32 m0, s66, 24576
    s_add_u32 s7, s65, 8192
    buffer_load_dwordx4 v139, s[68:71], s7 offen lds
    s_add_u32 m0, s66, 28672
    s_add_u32 s7, s65, 12288
    buffer_load_dwordx4 v139, s[68:71], s7 offen lds
    s_add_u32 m0, s66, 49152
    s_add_u32 s7, s65, 16384
    buffer_load_dwordx4 v139, s[68:71], s7 offen lds
    s_add_u32 m0, s66, 53248
    s_add_u32 s7, s65, 20480
    buffer_load_dwordx4 v139, s[68:71], s7 offen lds
km_r1:
    v_mfma_f32_32x32x16_bf16 v[56:71], a[20:23], v[20:23], v[56:71]
    v_mul_f32 v188, v188, v200
    v_mul_f32 v189, v189, v200
    v_mul_f32 v190, v190, v200
    v_mul_f32 v191, v191, v200
    v_fmac_f32 v180, v196, v200
    v_fmac_f32 v181, v197, v200
    v_mfma_f32_32x32x16_bf16 v[72:87], a[24:27], v[20:23], v[72:87]
    v_fmac_f32 v182, v198, v200
    v_fmac_f32 v183, v199, v200
    v_cvt_pk_bf16_f32 v32, v188, v189
    v_cvt_pk_bf16_f32 v33, v190, v191
    v_mul_f32 v192, v192, v200
    v_mul_f32 v193, v193, v200
    v_mfma_f32_32x32x16_bf16 v[88:103], a[28:31], v[20:23], v[88:103]
    v_mul_f32 v194, v194, v200
    v_mul_f32 v195, v195, v200
    v_cvt_pk_bf16_f32 v34, v192, v193
    v_cvt_pk_bf16_f32 v35, v194, v195
    v_cvt_pk_bf16_f32 v30, v180, v181
    v_cvt_pk_bf16_f32 v31, v182, v183
    v_mfma_f32_32x32x16_bf16 v[104:119], a[32:35], v[20:23], v[104:119]
    v_mfma_f32_32x32x16_bf16 v[120:135], a[36:39], v[20:23], v[120:135]
    v_mfma_f32_32x32x8_bf16 v[140:155], v[208:209], a[228:229], v[140:155]
    v_mfma_f32_32x32x8_bf16 v[156:171], v[220:221], a[234:235], v[156:171]
    v_mfma_f32_32x32x16_bf16 v[56:71], a[40:43], v[24:27], v[56:71]
    v_mfma_f32_32x32x16_bf16 v[72:87], a[44:47], v[24:27], v[72:87]
    s_waitcnt vmcnt(5)
    v_cvt_pk_bf16_f32 v228, v228, v229
    s_waitcnt vmcnt(2)
    v_cvt_pk_bf16_f32 v240, v240, v241
    v_cvt_pk_bf16_f32 v229, v230, v231
    v_cvt_pk_bf16_f32 v241, v242, v243
    v_cvt_pk_bf16_f32 v230, v232, v233
    s_waitcnt vmcnt(1)
    v_cvt_pk_bf16_f32 v242, v244, v245
    v_mfma_f32_32x32x16_bf16 v[88:103], a[48:51], v[24:27], v[88:103]
    v_cvt_pk_bf16_f32 v231, v234, v235
    v_cvt_pk_bf16_f32 v243, v246, v247
    v_cvt_pk_bf16_f32 v232, v236, v237
    s_waitcnt vmcnt(0)
    v_cvt_pk_bf16_f32 v244, v248, v249
    v_cvt_pk_bf16_f32 v233, v238, v239
    v_cvt_pk_bf16_f32 v245, v250, v251
    v_mfma_f32_32x32x16_bf16 v[104:119], a[52:55], v[24:27], v[104:119]
    v_add_f32 v152, 0x358637bd, v152
    v_add_f32 v168, 0x358637bd, v168
    v_rcp_f32 v152, v152
    v_rcp_f32 v168, v168
    v_mfma_f32_32x32x16_bf16 v[120:135], a[56:59], v[24:27], v[120:135]
    v_mul_f32 v140, v140, v152
    v_mul_f32 v141, v141, v152
    v_mul_f32 v142, v142, v152
    v_mul_f32 v143, v143, v152
    v_mul_f32 v148, v148, v152
    v_mul_f32 v149, v149, v152
    s_cmp_eq_u32 s61, 0
    s_cbranch_scc0 km_r2
    s_add_u32 m0, s66, 8192
    s_add_u32 s7, s65, 40960
    buffer_load_dwordx4 v139, s[68:71], s7 offen lds
    s_add_u32 m0, s66, 12288
    s_add_u32 s7, s65, 45056
    buffer_load_dwordx4 v139, s[68:71], s7 offen lds
    s_add_u32 m0, s66, 32768
    s_add_u32 s7, s65, 49152
    buffer_load_dwordx4 v139, s[68:71], s7 offen lds
    s_add_u32 m0, s66, 36864
    s_add_u32 s7, s65, 53248
    buffer_load_dwordx4 v139, s[68:71], s7 offen lds
    s_add_u32 m0, s66, 57344
    s_add_u32 s7, s65, 57344
    buffer_load_dwordx4 v139, s[68:71], s7 offen lds
    s_add_u32 m0, s66, 61440
    s_add_u32 s7, s65, 61440
    buffer_load_dwordx4 v139, s[68:71], s7 offen lds
km_r2:
    v_mfma_f32_32x32x16_bf16 v[172:187], v[228:231], a[236:239], 0
    v_mul_f32 v150, v150, v152
    v_mul_f32 v151, v151, v152
    v_cvt_pk_bf16_f32 v36, v140, v141
    v_cvt_pk_bf16_f32 v37, v142, v143
    v_mul_f32 v144, v144, v152
    v_mul_f32 v145, v145, v152
    v_mfma_f32_32x32x16_bf16 v[188:203], v[240:243], a[242:245], 0
    v_mul_f32 v146, v146, v152
    v_mul_f32 v147, v147, v152
    v_cvt_pk_bf16_f32 v38, v144, v145
    v_cvt_pk_bf16_f32 v39, v146, v147
    v_mul_f32 v156, v156, v168
    v_mul_f32 v157, v157, v168
    v_mfma_f32_32x32x16_bf16 v[56:71], a[60:63], v[28:31], v[56:71]
    v_mul_f32 v158, v158, v168
    v_mul_f32 v159, v159, v168
    v_fmac_f32 v148, v164, v168
    v_fmac_f32 v149, v165, v168
    v_fmac_f32 v150, v166, v168
    v_fmac_f32 v151, v167, v168
    v_mfma_f32_32x32x16_bf16 v[72:87], a[64:67], v[28:31], v[72:87]
    v_cvt_pk_bf16_f32 v42, v156, v157
    v_cvt_pk_bf16_f32 v43, v158, v159
    v_mul_f32 v160, v160, v168
    v_mul_f32 v161, v161, v168
    v_mul_f32 v162, v162, v168
    v_mul_f32 v163, v163, v168
    v_mfma_f32_32x32x16_bf16 v[88:103], a[68:71], v[28:31], v[88:103]
    v_cvt_pk_bf16_f32 v44, v160, v161
    v_cvt_pk_bf16_f32 v45, v162, v163
    v_cvt_pk_bf16_f32 v40, v148, v149
    v_cvt_pk_bf16_f32 v41, v150, v151
    v_mfma_f32_32x32x16_bf16 v[104:119], a[72:75], v[28:31], v[104:119]
    v_mfma_f32_32x32x16_bf16 v[120:135], a[76:79], v[28:31], v[120:135]
    v_mfma_f32_32x32x8_bf16 v[172:187], v[232:233], a[240:241], v[172:187]
    buffer_load_dwordx2 v[230:231], v10, s[52:55], s35 offen offset:0
    v_mfma_f32_32x32x8_bf16 v[188:203], v[244:245], a[246:247], v[188:203]
    buffer_load_dwordx2 v[234:235], v10, s[52:55], s35 offen offset:32
    v_mfma_f32_32x32x16_bf16 v[56:71], a[80:83], v[32:35], v[56:71]
    buffer_load_dwordx2 v[238:239], v10, s[52:55], s35 offen offset:64
    v_mfma_f32_32x32x16_bf16 v[72:87], a[84:87], v[32:35], v[72:87]
    buffer_load_dwordx2 v[242:243], v10, s[52:55], s35 offen offset:96
    s_nop 4
    v_add_f32 v184, 0x358637bd, v184
    s_nop 0
    v_add_f32 v200, 0x358637bd, v200
    v_rcp_f32 v184, v184
    v_mfma_f32_32x32x16_bf16 v[88:103], a[88:91], v[32:35], v[88:103]
    buffer_load_dwordx2 v[246:247], v10, s[52:55], s35 offen offset:128
    v_rcp_f32 v200, v200
    v_mul_f32 v172, v172, v184
    v_mul_f32 v173, v173, v184
    v_mul_f32 v174, v174, v184
    v_mfma_f32_32x32x16_bf16 v[104:119], a[92:95], v[32:35], v[104:119]
    buffer_load_dword v137, v138, s[48:51], s33 offen sc1
    v_mul_f32 v175, v175, v184
    v_mul_f32 v180, v180, v184
    v_mul_f32 v181, v181, v184
    v_mul_f32 v182, v182, v184
    v_mul_f32 v183, v183, v184
    v_mfma_f32_32x32x16_bf16 v[120:135], a[96:99], v[32:35], v[120:135]
    v_cvt_pk_bf16_f32 v46, v172, v173
    v_cvt_pk_bf16_f32 v47, v174, v175
    v_mul_f32 v176, v176, v184
    v_mul_f32 v177, v177, v184
    v_mul_f32 v178, v178, v184
    v_mul_f32 v179, v179, v184
    s_cmp_eq_u32 s61, 0
    s_cbranch_scc0 km_r3
    s_add_u32 m0, s66, 16384
    s_add_u32 s7, s65, 81920
    buffer_load_dwordx4 v139, s[68:71], s7 offen lds
    s_add_u32 m0, s66, 20480
    s_add_u32 s7, s65, 86016
    buffer_load_dwordx4 v139, s[68:71], s7 offen lds
    s_add_u32 m0, s66, 40960
    s_add_u32 s7, s65, 90112
    buffer_load_dwordx4 v139, s[68:71], s7 offen lds
    s_add_u32 m0, s66, 45056
    s_add_u32 s7, s65, 94208
    buffer_load_dwordx4 v139, s[68:71], s7 offen lds
    s_add_u32 m0, s66, 65536
    s_add_u32 s7, s65, 98304
    buffer_load_dwordx4 v139, s[68:71], s7 offen lds
    s_add_u32 m0, s66, 69632
    s_add_u32 s7, s65, 102400
    buffer_load_dwordx4 v139, s[68:71], s7 offen lds
km_r3:
    v_mfma_f32_32x32x16_bf16 v[56:71], a[100:103], v[36:39], v[56:71]
    v_cvt_pk_bf16_f32 v48, v176, v177
    v_cvt_pk_bf16_f32 v49, v178, v179
    v_mul_f32 v188, v188, v200
    v_mul_f32 v189, v189, v200
    v_mul_f32 v190, v190, v200
    v_mul_f32 v191, v191, v200
    v_mfma_f32_32x32x16_bf16 v[72:87], a[104:107], v[36:39], v[72:87]
    v_fmac_f32 v180, v196, v200
    v_fmac_f32 v181, v197, v200
    v_fmac_f32 v182, v198, v200
    v_fmac_f32 v183, v199, v200
    v_cvt_pk_bf16_f32 v52, v188, v189
    v_cvt_pk_bf16_f32 v53, v190, v191
    v_mfma_f32_32x32x16_bf16 v[88:103], a[108:111], v[36:39], v[88:103]
    v_mul_f32 v192, v192, v200
    v_mul_f32 v193, v193, v200
    v_mul_f32 v194, v194, v200
    v_mul_f32 v195, v195, v200
    v_cvt_pk_bf16_f32 v54, v192, v193
    v_cvt_pk_bf16_f32 v55, v194, v195
    v_mfma_f32_32x32x16_bf16 v[104:119], a[112:115], v[36:39], v[104:119]
    v_cvt_pk_bf16_f32 v50, v180, v181
    v_cvt_pk_bf16_f32 v51, v182, v183
    v_mfma_f32_32x32x16_bf16 v[120:135], a[116:119], v[36:39], v[120:135]
    v_mfma_f32_32x32x16_bf16 v[56:71], a[120:123], v[40:43], v[56:71]
    v_mfma_f32_32x32x16_bf16 v[72:87], a[124:127], v[40:43], v[72:87]
    v_mfma_f32_32x32x16_bf16 v[88:103], a[128:131], v[40:43], v[88:103]
    v_mfma_f32_32x32x16_bf16 v[104:119], a[132:135], v[40:43], v[104:119]
    v_mfma_f32_32x32x16_bf16 v[120:135], a[136:139], v[40:43], v[120:135]
    s_waitcnt vmcnt(0)
    v_cmp_gt_u32 vcc, 1, v137
    s_mov_b32 s7, 0
    s_nop 3
    s_cbranch_vccz km_wd_ok
km_wd:
    s_sleep 8
    buffer_load_dword v137, v138, s[48:51], s33 offen sc1
    s_add_u32 s7, s7, 1
    s_waitcnt vmcnt(0)
    v_cmp_gt_u32 vcc, 1, v137
    s_cmp_lt_u32 s7, 0x40000
    s_nop 3
    s_cbranch_vccz km_wd_ok
    s_cbranch_scc1 km_wd
km_wd_ok:
    v_mfma_f32_32x32x16_bf16 v[56:71], a[140:143], v[44:47], v[56:71]
    s_add_u32 s63, s8, 0
    buffer_load_dwordx4 v[140:143], v4, s[44:47], s63 offen
    v_mfma_f32_32x32x16_bf16 v[56:71], a[160:163], v[48:51], v[56:71]
    buffer_load_dwordx4 v[144:147], v15, s[44:47], s63 offen offset:0
    v_mfma_f32_32x32x16_bf16 v[56:71], a[180:183], v[52:55], v[56:71]
    buffer_load_dwordx4 v[148:151], v15, s[44:47], s63 offen offset:1024
    v_mfma_f32_32x32x16_bf16 v[72:87], a[144:147], v[44:47], v[72:87]
    buffer_load_dwordx4 v[152:155], v15, s[44:47], s63 offen offset:2048
    v_mfma_f32_32x32x16_bf16 v[72:87], a[164:167], v[48:51], v[72:87]
    buffer_load_dwordx4 v[156:159], v15, s[44:47], s63 offen offset:3072
    v_mfma_f32_32x32x16_bf16 v[72:87], a[184:187], v[52:55], v[72:87]
    s_add_u32 s63, s8, 5120
    buffer_load_dwordx4 v[160:163], v4, s[44:47], s63 offen
    s_nop 3
    ds_write_b128 v11, v[56:59] offset:0
    ds_write_b128 v9, v[60:63] offset:1024
    ds_write_b128 v11, v[64:67] offset:2048
    ds_write_b128 v9, v[68:71] offset:3072
    v_mfma_f32_32x32x16_bf16 v[88:103], a[148:151], v[44:47], v[88:103]
    buffer_load_dwordx4 v[164:167], v15, s[44:47], s63 offen offset:0
    v_lshlrev_b32 v228, 16, v230
    v_and_b32 v229, 0xffff0000, v230
    v_lshlrev_b32 v230, 16, v231
    v_and_b32 v231, 0xffff0000, v231
    v_lshlrev_b32 v232, 16, v234
    v_mfma_f32_32x32x16_bf16 v[88:103], a[168:171], v[48:51], v[88:103]
    buffer_load_dwordx4 v[168:171], v15, s[44:47], s63 offen offset:1024
    v_and_b32 v233, 0xffff0000, v234
    v_lshlrev_b32 v234, 16, v235
    v_and_b32 v235, 0xffff0000, v235
    v_lshlrev_b32 v236, 16, v238
    v_and_b32 v237, 0xffff0000, v238
    v_mfma_f32_32x32x16_bf16 v[88:103], a[188:191], v[52:55], v[88:103]
    v_lshlrev_b32 v238, 16, v239
    v_and_b32 v239, 0xffff0000, v239
    v_lshlrev_b32 v240, 16, v242
    v_and_b32 v241, 0xffff0000, v242
    v_lshlrev_b32 v242, 16, v243
    v_and_b32 v243, 0xffff0000, v243
    v_mfma_f32_32x32x16_bf16 v[104:119], a[152:155], v[44:47], v[104:119]
    v_lshlrev_b32 v244, 16, v246
    v_and_b32 v245, 0xffff0000, v246
    v_lshlrev_b32 v246, 16, v247
    v_and_b32 v247, 0xffff0000, v247
    ds_write_b128 v11, v[72:75] offset:4096
    ds_write_b128 v9, v[76:79] offset:5120
    v_mfma_f32_32x32x16_bf16 v[104:119], a[172:175], v[48:51], v[104:119]
    ds_write_b128 v11, v[80:83] offset:6144
    ds_write_b128 v9, v[84:87] offset:7168
    v_mfma_f32_32x32x16_bf16 v[104:119], a[192:195], v[52:55], v[104:119]
    ds_write_b128 v11, v[88:91] offset:8192
    ds_write_b128 v9, v[92:95] offset:9216
    ds_write_b128 v11, v[96:99] offset:10240
    ds_write_b128 v9, v[100:103] offset:11264
    v_mfma_f32_32x32x16_bf16 v[120:135], a[156:159], v[44:47], v[120:135]
    v_mfma_f32_32x32x16_bf16 v[120:135], a[176:179], v[48:51], v[120:135]
    v_mfma_f32_32x32x16_bf16 v[120:135], a[196:199], v[52:55], v[120:135]
    s_nop 4
    ds_write_b128 v11, v[104:107] offset:12288
    ds_write_b128 v9, v[108:111] offset:13312
    ds_write_b128 v11, v[112:115] offset:14336
    ds_write_b128 v9, v[116:119] offset:15360
    v_mov_b32 v100, 0
    v_mov_b32 v101, 0
    v_mov_b32 v102, 0
    v_mov_b32 v103, 0
    ds_write_b128 v11, v[120:123] offset:16384
    ds_write_b128 v9, v[124:127] offset:17408
    ds_write_b128 v11, v[128:131] offset:18432
    ds_write_b128 v9, v[132:135] offset:19456
    s_waitcnt lgkmcnt(0)
    s_barrier
    ds_read_b128 v[16:19], v12 offset:0
    ds_read_b128 v[20:23], v12 offset:20480
    ds_read_b128 v[24:27], v14 offset:0
    ds_read_b128 v[28:31], v14 offset:20480
    ds_read_b128 v[32:35], v12 offset:2048
    ds_read_b128 v[36:39], v12 offset:22528
    ds_read_b128 v[40:43], v14 offset:2048
    ds_read_b128 v[44:47], v14 offset:22528
    ds_read_b128 v[48:51], v12 offset:4096
    ds_read_b128 v[52:55], v12 offset:24576
    ds_read_b128 v[56:59], v14 offset:4096
    ds_read_b128 v[60:63], v14 offset:24576
    ds_read_b128 v[64:67], v12 offset:6144
    ds_read_b128 v[68:71], v12 offset:26624
    ds_read_b128 v[72:75], v14 offset:6144
    ds_read_b128 v[76:79], v14 offset:26624
    ds_read_b128 v[80:83], v12 offset:8192
    ds_read_b128 v[84:87], v12 offset:28672
    ds_read_b128 v[88:91], v14 offset:8192
    ds_read_b128 v[92:95], v14 offset:28672
    s_waitcnt lgkmcnt(15)
    v_pk_add_f32 v[16:17], v[16:17], v[228:229]
    v_pk_add_f32 v[18:19], v[18:19], v[230:231]
    v_pk_add_f32 v[20:21], v[20:21], v[24:25]
    v_pk_add_f32 v[22:23], v[22:23], v[26:27]
    v_pk_add_f32 v[16:17], v[16:17], v[28:29]
    v_pk_add_f32 v[18:19], v[18:19], v[30:31]
    v_pk_add_f32 v[16:17], v[16:17], v[20:21]
    v_pk_add_f32 v[18:19], v[18:19], v[22:23]
    v_cvt_pk_bf16_f32 v20, v16, v17
    v_cvt_pk_bf16_f32 v21, v18, v19
    v_pk_add_f32 v[100:101], v[100:101], v[16:17]
    v_pk_fma_f32 v[102:103], v[16:17], v[16:17], v[102:103]
    buffer_store_dwordx2 v[20:21], v2, s[56:59], s36 offen offset:0 sc1
    v_pk_add_f32 v[100:101], v[100:101], v[18:19]
    v_pk_fma_f32 v[102:103], v[18:19], v[18:19], v[102:103]
    v_pk_add_f32 v[32:33], v[32:33], v[232:233]
    v_pk_add_f32 v[34:35], v[34:35], v[234:235]
    s_waitcnt lgkmcnt(13)
    v_pk_add_f32 v[36:37], v[36:37], v[40:41]
    v_pk_add_f32 v[38:39], v[38:39], v[42:43]
    s_waitcnt lgkmcnt(12)
    v_pk_add_f32 v[32:33], v[32:33], v[44:45]
    v_pk_add_f32 v[34:35], v[34:35], v[46:47]
    v_pk_add_f32 v[32:33], v[32:33], v[36:37]
    v_pk_add_f32 v[34:35], v[34:35], v[38:39]
    v_cvt_pk_bf16_f32 v36, v32, v33
    v_cvt_pk_bf16_f32 v37, v34, v35
    v_pk_add_f32 v[100:101], v[100:101], v[32:33]
    v_pk_fma_f32 v[102:103], v[32:33], v[32:33], v[102:103]
    buffer_store_dwordx2 v[36:37], v2, s[56:59], s36 offen offset:1024 sc1
    v_pk_add_f32 v[100:101], v[100:101], v[34:35]
    v_pk_fma_f32 v[102:103], v[34:35], v[34:35], v[102:103]
    s_waitcnt lgkmcnt(11)
    v_pk_add_f32 v[48:49], v[48:49], v[236:237]
    v_pk_add_f32 v[50:51], v[50:51], v[238:239]
    s_waitcnt lgkmcnt(9)
    v_pk_add_f32 v[52:53], v[52:53], v[56:57]
    v_pk_add_f32 v[54:55], v[54:55], v[58:59]
    s_waitcnt lgkmcnt(8)
    v_pk_add_f32 v[48:49], v[48:49], v[60:61]
    v_pk_add_f32 v[50:51], v[50:51], v[62:63]
    v_pk_add_f32 v[48:49], v[48:49], v[52:53]
    v_pk_add_f32 v[50:51], v[50:51], v[54:55]
    v_cvt_pk_bf16_f32 v52, v48, v49
    v_cvt_pk_bf16_f32 v53, v50, v51
    v_pk_add_f32 v[100:101], v[100:101], v[48:49]
    v_pk_fma_f32 v[102:103], v[48:49], v[48:49], v[102:103]
    buffer_store_dwordx2 v[52:53], v2, s[56:59], s36 offen offset:2048 sc1
    v_pk_add_f32 v[100:101], v[100:101], v[50:51]
    v_pk_fma_f32 v[102:103], v[50:51], v[50:51], v[102:103]
    s_waitcnt lgkmcnt(7)
    v_pk_add_f32 v[64:65], v[64:65], v[240:241]
    v_pk_add_f32 v[66:67], v[66:67], v[242:243]
    s_waitcnt lgkmcnt(5)
    v_pk_add_f32 v[68:69], v[68:69], v[72:73]
    v_pk_add_f32 v[70:71], v[70:71], v[74:75]
    s_waitcnt lgkmcnt(4)
    v_pk_add_f32 v[64:65], v[64:65], v[76:77]
    v_pk_add_f32 v[66:67], v[66:67], v[78:79]
    v_pk_add_f32 v[64:65], v[64:65], v[68:69]
    v_pk_add_f32 v[66:67], v[66:67], v[70:71]
    v_cvt_pk_bf16_f32 v68, v64, v65
    v_cvt_pk_bf16_f32 v69, v66, v67
    v_pk_add_f32 v[100:101], v[100:101], v[64:65]
    v_pk_fma_f32 v[102:103], v[64:65], v[64:65], v[102:103]
    buffer_store_dwordx2 v[68:69], v2, s[56:59], s36 offen offset:3072 sc1
    v_pk_add_f32 v[100:101], v[100:101], v[66:67]
    v_pk_fma_f32 v[102:103], v[66:67], v[66:67], v[102:103]
    s_add_u32 s36, s36, 4096
    s_waitcnt lgkmcnt(3)
    v_pk_add_f32 v[80:81], v[80:81], v[244:245]
    v_pk_add_f32 v[82:83], v[82:83], v[246:247]
    s_waitcnt lgkmcnt(1)
    v_pk_add_f32 v[84:85], v[84:85], v[88:89]
    v_pk_add_f32 v[86:87], v[86:87], v[90:91]
    s_waitcnt lgkmcnt(0)
    v_pk_add_f32 v[80:81], v[80:81], v[92:93]
    v_pk_add_f32 v[82:83], v[82:83], v[94:95]
    v_pk_add_f32 v[80:81], v[80:81], v[84:85]
    v_pk_add_f32 v[82:83], v[82:83], v[86:87]
    v_cvt_pk_bf16_f32 v84, v80, v81
    v_cvt_pk_bf16_f32 v85, v82, v83
    v_pk_add_f32 v[100:101], v[100:101], v[80:81]
    v_pk_fma_f32 v[102:103], v[80:81], v[80:81], v[102:103]
    buffer_store_dwordx2 v[84:85], v2, s[56:59], s36 offen offset:0 sc1
    v_pk_add_f32 v[100:101], v[100:101], v[82:83]
    v_pk_fma_f32 v[102:103], v[82:83], v[82:83], v[102:103]
    v_add_f32 v100, v100, v101
    v_add_f32 v101, v102, v103
    s_nop 0
    v_add_f32_dpp v100, v100, v100 quad_perm:[1,0,3,2] row_mask:0xf bank_mask:0xf
    v_add_f32_dpp v101, v101, v101 quad_perm:[1,0,3,2] row_mask:0xf bank_mask:0xf
    s_nop 0
    v_add_f32_dpp v100, v100, v100 quad_perm:[2,3,0,1] row_mask:0xf bank_mask:0xf
    v_add_f32_dpp v101, v101, v101 quad_perm:[2,3,0,1] row_mask:0xf bank_mask:0xf
    s_mov_b32 exec_lo, 0x11111111
    s_mov_b32 exec_hi, 0x11111111
    buffer_store_dwordx2 v[100:101], v13, s[72:75], s38 offen sc1
    s_mov_b64 exec, -1
    buffer_load_dwordx4 v[172:175], v15, s[44:47], s63 offen offset:2048
    buffer_load_dwordx4 v[176:179], v15, s[44:47], s63 offen offset:3072
    s_add_u32 s63, s8, 20480
    buffer_load_dwordx4 v[180:183], v4, s[44:47], s63 offen
    buffer_load_dwordx4 v[184:187], v15, s[44:47], s63 offen offset:0
    buffer_load_dwordx4 v[188:191], v15, s[44:47], s63 offen offset:1024
    buffer_load_dwordx4 v[192:195], v15, s[44:47], s63 offen offset:2048
    buffer_load_dwordx4 v[196:199], v15, s[44:47], s63 offen offset:3072
    s_add_u32 s63, s8, 25600
    buffer_load_dwordx4 v[200:203], v4, s[44:47], s63 offen
    buffer_load_dwordx4 v[204:207], v15, s[44:47], s63 offen offset:0
    buffer_load_dwordx4 v[208:211], v15, s[44:47], s63 offen offset:1024
    s_lshl_b32 s34, s64, 2
    s_add_u32 s34, s34, s3
    v_mov_b32 v2, v4
    v_add_u32 v4, 0x10000, v2
    v_and_b32 v5, 31, v1
    v_lshlrev_b32 v5, 4, v5
    v_lshrrev_b32 v6, 5, v1
    v_lshl_add_u32 v5, v6, 10, v5
    v_and_b32 v7, 3, v1
    v_lshlrev_b32 v7, 7, v7
    v_mov_b32 v24, 0
    v_mov_b32 v3, v139
    s_lshl_b32 s36, s34, 11
    s_mul_i32 s37, s34, 40960
    s_mul_i32 s35, s34, 108
    s_add_u32 s35, s35, s67
    s_lshl_b32 s35, s35, 10
    s_cmp_ge_u32 s67, 105
    s_cselect_b32 s33, 67108864, s35
    s_add_u32 s38, s67, s3
    s_lshl_b32 s38, s38, 10
    s_add_u32 s39, s38, 4096
    s_add_u32 s40, s26, 4423680
    s_addc_u32 s41, s27, 0
    s_mov_b32 s42, 110592
    s_mov_b32 s43, 0x20000
    s_add_u32 s52, s26, 12994560
    s_addc_u32 s53, s27, 0
    s_mov_b32 s54, 7077888
    s_mov_b32 s55, 0x20000
    s_waitcnt vmcnt(10)
    s_barrier
    s_cmp_eq_u32 s3, 0
    s_cbranch_scc0 km_pa
    v_mov_b32 v25, 1
    s_mov_b64 exec, 1
    buffer_store_dword v25, v24, s[48:51], s4 offen sc1
    s_mov_b64 exec, -1
km_pa:
    buffer_load_dwordx4 v[212:215], v15, s[44:47], s63 offen offset:2048
    buffer_load_dwordx4 v[216:219], v15, s[44:47], s63 offen offset:3072
    s_add_u32 s63, s8, 35840
    buffer_load_dwordx4 v[220:223], v2, s[44:47], s63 offen
    buffer_load_dwordx4 v[224:227], v15, s[44:47], s63 offen offset:0
    buffer_load_dwordx4 a[200:203], v15, s[44:47], s63 offen offset:1024
    buffer_load_dwordx4 a[204:207], v15, s[44:47], s63 offen offset:2048
    buffer_load_dwordx4 a[208:211], v15, s[44:47], s63 offen offset:3072
    s_add_u32 s63, s8, 40960
    buffer_load_dwordx4 a[212:215], v2, s[44:47], s63 offen
    buffer_load_dwordx4 a[216:219], v15, s[44:47], s63 offen offset:0
    buffer_load_dwordx4 a[220:223], v15, s[44:47], s63 offen offset:1024
    buffer_load_dwordx4 a[224:227], v15, s[44:47], s63 offen offset:2048
    buffer_load_dwordx4 a[228:231], v15, s[44:47], s63 offen offset:3072
    s_add_u32 s63, s8, 56320
    buffer_load_dwordx4 a[232:235], v2, s[44:47], s63 offen
    buffer_load_dwordx4 a[236:239], v15, s[44:47], s63 offen offset:0
    buffer_load_dwordx4 a[240:243], v15, s[44:47], s63 offen offset:1024
    buffer_load_dwordx4 a[244:247], v15, s[44:47], s63 offen offset:2048
    s_add_u32 m0, s66, 73728
    s_add_u32 s7, s65, 24576
    buffer_load_dwordx4 v3, s[68:71], s7 offen lds
    s_add_u32 m0, s66, 81920
    s_add_u32 s7, s65, 65536
    buffer_load_dwordx4 v3, s[68:71], s7 offen lds
    s_add_u32 m0, s66, 90112
    s_add_u32 s7, s65, 106496
    buffer_load_dwordx4 v3, s[68:71], s7 offen lds
    buffer_load_dword v26, v7, s[48:51], s60 offen sc1
    s_waitcnt vmcnt(0)
    v_cmp_gt_u32 vcc, 1, v26
    s_mov_b32 s7, 0
    s_nop 3
    s_cbranch_vccz km_wa_ok
km_wa:
    s_sleep 1
    buffer_load_dword v26, v7, s[48:51], s60 offen sc1
    s_add_u32 s7, s7, 1
    s_waitcnt vmcnt(0)
    v_cmp_gt_u32 vcc, 1, v26
    s_cmp_lt_u32 s7, 0x40000
    s_nop 3
    s_cbranch_vccz km_wa_ok
    s_cbranch_scc1 km_wa
km_wa_ok:
    buffer_load_dwordx4 v[112:115], v5, s[72:75], s36 offen offset:0
    buffer_load_dwordx4 v[116:119], v5, s[72:75], s36 offen offset:512
    buffer_load_dwordx4 a[0:3], v2, s[56:59], s37 offen offset:0
    buffer_load_dwordx4 a[4:7], v2, s[56:59], s37 offen offset:1024
    buffer_load_dwordx4 a[8:11], v2, s[56:59], s37 offen offset:2048
    buffer_load_dwordx4 a[12:15], v2, s[56:59], s37 offen offset:3072
    s_add_u32 s37, s37, 4096
    buffer_load_dwordx4 a[16:19], v2, s[56:59], s37 offen offset:0
    buffer_load_dwordx4 a[20:23], v2, s[56:59], s37 offen offset:1024
    buffer_load_dwordx4 a[24:27], v2, s[56:59], s37 offen offset:2048
    buffer_load_dwordx4 a[28:31], v2, s[56:59], s37 offen offset:3072
    s_add_u32 s37, s37, 4096
    buffer_load_dwordx4 a[32:35], v2, s[56:59], s37 offen offset:0
    buffer_load_dwordx4 a[36:39], v2, s[56:59], s37 offen offset:1024
    buffer_load_dwordx4 a[40:43], v2, s[56:59], s37 offen offset:2048
    buffer_load_dwordx4 a[44:47], v2, s[56:59], s37 offen offset:3072
    s_barrier
    ds_read_b128 a[160:163], v2 offset:0
    ds_read_b128 a[164:167], v2 offset:8192
    ds_read_b128 a[168:171], v2 offset:16384
    ds_read_b128 a[172:175], v2 offset:1024
    ds_read_b128 a[176:179], v2 offset:9216
    ds_read_b128 a[180:183], v2 offset:17408
    ds_read_b128 a[184:187], v2 offset:2048
    s_waitcnt vmcnt(11) lgkmcnt(6)
    v_mfma_f32_32x32x16_bf16 v[32:47], a[160:163], a[0:3], 0
    ds_read_b128 a[188:191], v2 offset:10240
    s_add_u32 s37, s37, 4096
    buffer_load_dwordx4 a[48:51], v2, s[56:59], s37 offen offset:0
    s_waitcnt lgkmcnt(5)
    v_mfma_f32_32x32x16_bf16 v[48:63], a[164:167], a[0:3], 0
    ds_read_b128 a[160:163], v2 offset:18432
    v_mfma_f32_32x32x16_bf16 v[64:79], a[168:171], a[0:3], 0
    ds_read_b128 a[164:167], v2 offset:3072
    v_add_f32 v112, v112, v114
    v_add_f32 v113, v113, v115
    v_add_f32 v116, v116, v118
    v_add_f32 v117, v117, v119
    s_waitcnt lgkmcnt(5)
    s_waitcnt vmcnt(11)
    v_mfma_f32_32x32x16_bf16 v[32:47], a[172:175], a[4:7], v[32:47]
    ds_read_b128 a[168:171], v2 offset:11264
    buffer_load_dwordx4 a[52:55], v2, s[56:59], s37 offen offset:1024
    v_add_f32 v8, v112, v116
    v_add_f32 v9, v113, v117
    v_mov_b32 v10, v8
    v_mov_b32 v11, v9
    v_mfma_f32_32x32x16_bf16 v[48:63], a[176:179], a[4:7], v[48:63]
    ds_read_b128 a[172:175], v2 offset:19456
    v_permlane32_swap_b32 v8, v10
    v_permlane32_swap_b32 v9, v11
    v_add_f32 v8, v8, v10
    v_add_f32 v9, v9, v11
    s_waitcnt lgkmcnt(5)
    v_mfma_f32_32x32x16_bf16 v[64:79], a[180:183], a[4:7], v[64:79]
    ds_read_b128 a[176:179], v2 offset:4096
    s_add_u32 m0, s66, 77824
    s_add_u32 s7, s65, 28672
    buffer_load_dwordx4 v3, s[68:71], s7 offen lds
    v_mul_f32 v8, 0x3acccccd, v8
    v_mul_f32 v9, 0x3acccccd, v9
    s_waitcnt vmcnt(12)
    v_mfma_f32_32x32x16_bf16 v[32:47], a[184:187], a[8:11], v[32:47]
    ds_read_b128 a[180:183], v2 offset:12288
    v_fma_f32 v9, -v8, v8, v9
    v_max_f32 v9, 0, v9
    v_cvt_pk_bf16_f32 v10, v8, v8
    v_and_b32 v10, 0xffff0000, v10
    s_waitcnt lgkmcnt(5)
    v_mfma_f32_32x32x16_bf16 v[48:63], a[188:191], a[8:11], v[48:63]
    ds_read_b128 a[184:187], v2 offset:20480
    buffer_load_dwordx4 a[56:59], v2, s[56:59], s37 offen offset:2048
    v_cvt_pk_bf16_f32 v11, v9, v9
    v_and_b32 v11, 0xffff0000, v11
    v_add_f32 v11, 0x3727c5ac, v11
    v_cvt_pk_bf16_f32 v11, v11, v11
    v_mfma_f32_32x32x16_bf16 v[64:79], a[160:163], a[8:11], v[64:79]
    ds_read_b128 a[188:191], v2 offset:5120
    v_and_b32 v11, 0xffff0000, v11
    v_sqrt_f32 v11, v11
    s_nop 0
    v_cvt_pk_bf16_f32 v11, v11, v11
    v_and_b32 v11, 0xffff0000, v11
    s_waitcnt lgkmcnt(5)
    s_waitcnt vmcnt(12)
    v_mfma_f32_32x32x16_bf16 v[32:47], a[164:167], a[12:15], v[32:47]
    ds_read_b128 a[160:163], v2 offset:13312
    buffer_load_dwordx4 a[60:63], v2, s[56:59], s37 offen offset:3072
    v_rcp_f32 v6, v11
    v_xor_b32 v10, 0x80000000, v10
    v_lshrrev_b32 v17, 16, v10
    v_mfma_f32_32x32x16_bf16 v[48:63], a[168:171], a[12:15], v[48:63]
    ds_read_b128 a[164:167], v2 offset:21504
    v_or_b32 v16, v10, v17
    v_mov_b32 v18, 0
    v_mov_b32 v19, 0
    v_mul_f32 v20, 0xc0135761, v6
    s_waitcnt lgkmcnt(5)
    v_mfma_f32_32x32x16_bf16 v[64:79], a[172:175], a[12:15], v[64:79]
    ds_read_b128 a[168:171], v2 offset:6144
    v_mul_f32 v21, v6, v6
    v_mul_f32 v21, v21, v20
    v_mul_f32 v21, 0x3d372713, v21
    v_mul_f32 v22, v11, v11
    s_waitcnt vmcnt(12)
    v_mfma_f32_32x32x16_bf16 v[32:47], a[176:179], a[16:19], v[32:47]
    ds_read_b128 a[172:175], v2 offset:14336
    s_add_u32 m0, s66, 86016
    s_add_u32 s7, s65, 69632
    buffer_load_dwordx4 v3, s[68:71], s7 offen lds
    s_waitcnt lgkmcnt(5)
    v_mfma_f32_32x32x16_bf16 v[48:63], a[180:183], a[16:19], v[48:63]
    ds_read_b128 a[176:179], v2 offset:22528
    v_mfma_f32_32x32x16_bf16 v[64:79], a[184:187], a[16:19], v[64:79]
    ds_read_b128 a[180:183], v2 offset:7168
    s_add_u32 s37, s37, 4096
    buffer_load_dwordx4 a[64:67], v2, s[56:59], s37 offen offset:0
    s_waitcnt lgkmcnt(5)
    s_waitcnt vmcnt(13)
    v_mfma_f32_32x32x16_bf16 v[32:47], a[188:191], a[20:23], v[32:47]
    ds_read_b128 a[184:187], v2 offset:15360
    v_mfma_f32_32x32x16_bf16 v[48:63], a[160:163], a[20:23], v[48:63]
    ds_read_b128 a[188:191], v2 offset:23552
    buffer_load_dwordx4 a[68:71], v2, s[56:59], s37 offen offset:1024
    s_waitcnt lgkmcnt(5)
    s_barrier
    v_mfma_f32_32x32x16_bf16 v[64:79], a[164:167], a[20:23], v[64:79]
    ds_read_b128 a[160:163], v2 offset:24576
    s_waitcnt vmcnt(13)
    v_mfma_f32_32x32x16_bf16 v[32:47], a[168:171], a[24:27], v[32:47]
    ds_read_b128 a[164:167], v2 offset:32768
    s_add_u32 m0, s66, 94208
    s_add_u32 s7, s65, 110592
    buffer_load_dwordx4 v3, s[68:71], s7 offen lds
    s_waitcnt lgkmcnt(5)
    v_mfma_f32_32x32x16_bf16 v[48:63], a[172:175], a[24:27], v[48:63]
    ds_read_b128 a[168:171], v2 offset:40960
    v_mfma_f32_32x32x16_bf16 v[64:79], a[176:179], a[24:27], v[64:79]
    ds_read_b128 a[172:175], v2 offset:25600
    s_waitcnt lgkmcnt(5)
    s_waitcnt vmcnt(13)
    v_mfma_f32_32x32x16_bf16 v[32:47], a[180:183], a[28:31], v[32:47]
    ds_read_b128 a[176:179], v2 offset:33792
    buffer_load_dwordx4 a[72:75], v2, s[56:59], s37 offen offset:2048
    v_mfma_f32_32x32x16_bf16 v[48:63], a[184:187], a[28:31], v[48:63]
    ds_read_b128 a[180:183], v2 offset:41984
    s_waitcnt lgkmcnt(5)
    v_mfma_f32_32x32x16_bf16 v[64:79], a[188:191], a[28:31], v[64:79]
    ds_read_b128 a[184:187], v2 offset:26624
    buffer_load_dwordx4 a[76:79], v2, s[56:59], s37 offen offset:3072
    s_waitcnt vmcnt(14)
    v_mfma_f32_32x32x16_bf16 v[32:47], a[160:163], a[32:35], v[32:47]
    ds_read_b128 a[188:191], v2 offset:34816
    s_waitcnt lgkmcnt(5)
    v_mfma_f32_32x32x16_bf16 v[48:63], a[164:167], a[32:35], v[48:63]
    ds_read_b128 a[160:163], v2 offset:43008
    s_add_u32 m0, s66, 98304
    s_add_u32 s7, s65, 32768
    buffer_load_dwordx4 v3, s[68:71], s7 offen lds
    v_mfma_f32_32x32x16_bf16 v[64:79], a[168:171], a[32:35], v[64:79]
    ds_read_b128 a[164:167], v2 offset:27648
    s_waitcnt lgkmcnt(5)
    s_waitcnt vmcnt(14)
    v_mfma_f32_32x32x16_bf16 v[32:47], a[172:175], a[36:39], v[32:47]
    ds_read_b128 a[168:171], v2 offset:35840
    s_add_u32 s37, s37, 4096
    buffer_load_dwordx4 a[80:83], v2, s[56:59], s37 offen offset:0
    v_mfma_f32_32x32x16_bf16 v[48:63], a[176:179], a[36:39], v[48:63]
    ds_read_b128 a[172:175], v2 offset:44032
    s_waitcnt lgkmcnt(5)
    v_mfma_f32_32x32x16_bf16 v[64:79], a[180:183], a[36:39], v[64:79]
    ds_read_b128 a[176:179], v2 offset:28672
    s_waitcnt vmcnt(14)
    v_mfma_f32_32x32x16_bf16 v[32:47], a[184:187], a[40:43], v[32:47]
    ds_read_b128 a[180:183], v2 offset:36864
    buffer_load_dwordx4 a[84:87], v2, s[56:59], s37 offen offset:1024
    s_waitcnt lgkmcnt(5)
    v_mfma_f32_32x32x16_bf16 v[48:63], a[188:191], a[40:43], v[48:63]
    ds_read_b128 a[184:187], v2 offset:45056
    v_mfma_f32_32x32x16_bf16 v[64:79], a[160:163], a[40:43], v[64:79]
    ds_read_b128 a[188:191], v2 offset:29696
    s_add_u32 m0, s66, 106496
    s_add_u32 s7, s65, 73728
    buffer_load_dwordx4 v3, s[68:71], s7 offen lds
    s_waitcnt lgkmcnt(5)
    s_waitcnt vmcnt(15)
    v_mfma_f32_32x32x16_bf16 v[32:47], a[164:167], a[44:47], v[32:47]
    ds_read_b128 a[160:163], v2 offset:37888
    v_mfma_f32_32x32x16_bf16 v[48:63], a[168:171], a[44:47], v[48:63]
    ds_read_b128 a[164:167], v2 offset:46080
    buffer_load_dwordx4 a[88:91], v2, s[56:59], s37 offen offset:2048
    s_waitcnt lgkmcnt(5)
    v_mfma_f32_32x32x16_bf16 v[64:79], a[172:175], a[44:47], v[64:79]
    ds_read_b128 a[168:171], v2 offset:30720
    s_waitcnt vmcnt(15)
    v_mfma_f32_32x32x16_bf16 v[32:47], a[176:179], a[48:51], v[32:47]
    ds_read_b128 a[172:175], v2 offset:38912
    buffer_load_dwordx4 a[92:95], v2, s[56:59], s37 offen offset:3072
    s_waitcnt lgkmcnt(5)
    v_mfma_f32_32x32x16_bf16 v[48:63], a[180:183], a[48:51], v[48:63]
    ds_read_b128 a[176:179], v2 offset:47104
    v_mfma_f32_32x32x16_bf16 v[64:79], a[184:187], a[48:51], v[64:79]
    ds_read_b128 a[180:183], v2 offset:31744
    s_waitcnt lgkmcnt(5)
    s_waitcnt vmcnt(15)
    v_mfma_f32_32x32x16_bf16 v[32:47], a[188:191], a[52:55], v[32:47]
    ds_read_b128 a[184:187], v2 offset:39936
    s_add_u32 m0, s66, 114688
    s_add_u32 s7, s65, 114688
    buffer_load_dwordx4 v3, s[68:71], s7 offen lds
    v_mfma_f32_32x32x16_bf16 v[48:63], a[160:163], a[52:55], v[48:63]
    ds_read_b128 a[188:191], v2 offset:48128
    s_waitcnt lgkmcnt(5)
    s_barrier
    v_mfma_f32_32x32x16_bf16 v[64:79], a[164:167], a[52:55], v[64:79]
    ds_read_b128 a[160:163], v2 offset:49152
    s_add_u32 s37, s37, 4096
    buffer_load_dwordx4 a[96:99], v2, s[56:59], s37 offen offset:0
    s_waitcnt vmcnt(15)
    v_mfma_f32_32x32x16_bf16 v[32:47], a[168:171], a[56:59], v[32:47]
    ds_read_b128 a[164:167], v2 offset:57344
    s_waitcnt lgkmcnt(5)
    v_mfma_f32_32x32x16_bf16 v[48:63], a[172:175], a[56:59], v[48:63]
    ds_read_b128 a[168:171], v4 offset:0
    buffer_load_dwordx4 a[100:103], v2, s[56:59], s37 offen offset:1024
    v_mfma_f32_32x32x16_bf16 v[64:79], a[176:179], a[56:59], v[64:79]
    ds_read_b128 a[172:175], v2 offset:50176
    s_waitcnt lgkmcnt(5)
    s_waitcnt vmcnt(15)
    v_mfma_f32_32x32x16_bf16 v[32:47], a[180:183], a[60:63], v[32:47]
    ds_read_b128 a[176:179], v2 offset:58368
    s_add_u32 m0, s66, 102400
    s_add_u32 s7, s65, 36864
    buffer_load_dwordx4 v3, s[68:71], s7 offen lds
    v_mfma_f32_32x32x16_bf16 v[48:63], a[184:187], a[60:63], v[48:63]
    ds_read_b128 a[180:183], v4 offset:1024
    s_waitcnt lgkmcnt(5)
    v_mfma_f32_32x32x16_bf16 v[64:79], a[188:191], a[60:63], v[64:79]
    ds_read_b128 a[184:187], v2 offset:51200
    s_waitcnt vmcnt(14)
    v_mfma_f32_32x32x16_bf16 v[32:47], a[160:163], a[64:67], v[32:47]
    ds_read_b128 a[188:191], v2 offset:59392
    buffer_load_dwordx4 a[104:107], v2, s[56:59], s37 offen offset:2048
    s_waitcnt lgkmcnt(5)
    v_mfma_f32_32x32x16_bf16 v[48:63], a[164:167], a[64:67], v[48:63]
    ds_read_b128 a[160:163], v4 offset:2048
    v_mfma_f32_32x32x16_bf16 v[64:79], a[168:171], a[64:67], v[64:79]
    ds_read_b128 a[164:167], v2 offset:52224
    buffer_load_dwordx4 a[108:111], v2, s[56:59], s37 offen offset:3072
    s_waitcnt lgkmcnt(5)
    s_waitcnt vmcnt(15)
    v_mfma_f32_32x32x16_bf16 v[32:47], a[172:175], a[68:71], v[32:47]
    ds_read_b128 a[168:171], v2 offset:60416
    v_mfma_f32_32x32x16_bf16 v[48:63], a[176:179], a[68:71], v[48:63]
    ds_read_b128 a[172:175], v4 offset:3072
    s_add_u32 m0, s66, 110592
    s_add_u32 s7, s65, 77824
    buffer_load_dwordx4 v3, s[68:71], s7 offen lds
    s_waitcnt lgkmcnt(5)
    v_mfma_f32_32x32x16_bf16 v[64:79], a[180:183], a[68:71], v[64:79]
    ds_read_b128 a[176:179], v2 offset:53248
    s_waitcnt vmcnt(14)
    v_mfma_f32_32x32x16_bf16 v[32:47], a[184:187], a[72:75], v[32:47]
    ds_read_b128 a[180:183], v2 offset:61440
    s_add_u32 s37, s37, 4096
    buffer_load_dwordx4 a[112:115], v2, s[56:59], s37 offen offset:0
    s_waitcnt lgkmcnt(5)
    v_mfma_f32_32x32x16_bf16 v[48:63], a[188:191], a[72:75], v[48:63]
    ds_read_b128 a[184:187], v4 offset:4096
    v_mfma_f32_32x32x16_bf16 v[64:79], a[160:163], a[72:75], v[64:79]
    ds_read_b128 a[188:191], v2 offset:54272
    s_waitcnt lgkmcnt(5)
    s_waitcnt vmcnt(14)
    v_mfma_f32_32x32x16_bf16 v[32:47], a[164:167], a[76:79], v[32:47]
    ds_read_b128 a[160:163], v2 offset:62464
    buffer_load_dwordx4 a[116:119], v2, s[56:59], s37 offen offset:1024
    v_mfma_f32_32x32x16_bf16 v[48:63], a[168:171], a[76:79], v[48:63]
    ds_read_b128 a[164:167], v4 offset:5120
    s_waitcnt lgkmcnt(5)
    v_mfma_f32_32x32x16_bf16 v[64:79], a[172:175], a[76:79], v[64:79]
    ds_read_b128 a[168:171], v2 offset:55296
    s_add_u32 m0, s66, 118784
    s_add_u32 s7, s65, 118784
    buffer_load_dwordx4 v3, s[68:71], s7 offen lds
    s_waitcnt vmcnt(14)
    v_mfma_f32_32x32x16_bf16 v[32:47], a[176:179], a[80:83], v[32:47]
    ds_read_b128 a[172:175], v2 offset:63488
    s_waitcnt lgkmcnt(5)
    v_mfma_f32_32x32x16_bf16 v[48:63], a[180:183], a[80:83], v[48:63]
    ds_read_b128 a[176:179], v4 offset:6144
    buffer_load_dwordx4 a[120:123], v2, s[56:59], s37 offen offset:2048
    v_mfma_f32_32x32x16_bf16 v[64:79], a[184:187], a[80:83], v[64:79]
    ds_read_b128 a[180:183], v2 offset:56320
    s_waitcnt lgkmcnt(5)
    s_waitcnt vmcnt(14)
    v_mfma_f32_32x32x16_bf16 v[32:47], a[188:191], a[84:87], v[32:47]
    ds_read_b128 a[184:187], v2 offset:64512
    buffer_load_dwordx4 a[124:127], v2, s[56:59], s37 offen offset:3072
    v_mfma_f32_32x32x16_bf16 v[48:63], a[160:163], a[84:87], v[48:63]
    ds_read_b128 a[188:191], v4 offset:7168
    s_waitcnt lgkmcnt(5)
    s_barrier
    v_mfma_f32_32x32x16_bf16 v[64:79], a[164:167], a[84:87], v[64:79]
    ds_read_b128 a[160:163], v4 offset:8192
    s_waitcnt vmcnt(13)
    v_mfma_f32_32x32x16_bf16 v[32:47], a[168:171], a[88:91], v[32:47]
    ds_read_b128 a[164:167], v4 offset:16384
    s_add_u32 m0, s66, 122880
    s_nop 0
    buffer_load_dwordx4 v2, s[40:43], s38 offen lds
    s_waitcnt lgkmcnt(5)
    v_mfma_f32_32x32x16_bf16 v[48:63], a[172:175], a[88:91], v[48:63]
    ds_read_b128 a[168:171], v4 offset:24576
    v_mfma_f32_32x32x16_bf16 v[64:79], a[176:179], a[88:91], v[64:79]
    ds_read_b128 a[172:175], v4 offset:9216
    s_add_u32 s37, s37, 4096
    buffer_load_dwordx4 a[128:131], v2, s[56:59], s37 offen offset:0
    s_waitcnt lgkmcnt(5)
    s_waitcnt vmcnt(14)
    v_mfma_f32_32x32x16_bf16 v[32:47], a[180:183], a[92:95], v[32:47]
    ds_read_b128 a[176:179], v4 offset:17408
    v_mfma_f32_32x32x16_bf16 v[48:63], a[184:187], a[92:95], v[48:63]
    ds_read_b128 a[180:183], v4 offset:25600
    buffer_load_dwordx4 a[132:135], v2, s[56:59], s37 offen offset:1024
    s_waitcnt lgkmcnt(5)
    v_mfma_f32_32x32x16_bf16 v[64:79], a[188:191], a[92:95], v[64:79]
    ds_read_b128 a[184:187], v4 offset:10240
    s_waitcnt vmcnt(13)
    v_mfma_f32_32x32x16_bf16 v[32:47], a[160:163], a[96:99], v[32:47]
    ds_read_b128 a[188:191], v4 offset:18432
    s_add_u32 m0, s66, 126976
    s_nop 0
    buffer_load_dwordx4 v2, s[40:43], s39 offen lds
    s_waitcnt lgkmcnt(5)
    v_mfma_f32_32x32x16_bf16 v[48:63], a[164:167], a[96:99], v[48:63]
    ds_read_b128 a[160:163], v4 offset:26624
    v_mfma_f32_32x32x16_bf16 v[64:79], a[168:171], a[96:99], v[64:79]
    ds_read_b128 a[164:167], v4 offset:11264
    s_waitcnt lgkmcnt(5)
    s_waitcnt vmcnt(13)
    v_mfma_f32_32x32x16_bf16 v[32:47], a[172:175], a[100:103], v[32:47]
    ds_read_b128 a[168:171], v4 offset:19456
    buffer_load_dwordx4 a[136:139], v2, s[56:59], s37 offen offset:2048
    v_mfma_f32_32x32x16_bf16 v[48:63], a[176:179], a[100:103], v[48:63]
    ds_read_b128 a[172:175], v4 offset:27648
    s_waitcnt lgkmcnt(5)
    v_mfma_f32_32x32x16_bf16 v[64:79], a[180:183], a[100:103], v[64:79]
    ds_read_b128 a[176:179], v4 offset:12288
    buffer_load_dwordx4 a[140:143], v2, s[56:59], s37 offen offset:3072
    s_waitcnt vmcnt(13)
    v_mfma_f32_32x32x16_bf16 v[32:47], a[184:187], a[104:107], v[32:47]
    ds_read_b128 a[180:183], v4 offset:20480
    s_waitcnt lgkmcnt(5)
    v_mfma_f32_32x32x16_bf16 v[48:63], a[188:191], a[104:107], v[48:63]
    ds_read_b128 a[184:187], v4 offset:28672
    s_add_u32 s37, s37, 4096
    buffer_load_dwordx4 a[144:147], v2, s[56:59], s37 offen offset:0
    v_mfma_f32_32x32x16_bf16 v[64:79], a[160:163], a[104:107], v[64:79]
    ds_read_b128 a[188:191], v4 offset:13312
    s_waitcnt lgkmcnt(5)
    s_waitcnt vmcnt(13)
    v_mfma_f32_32x32x16_bf16 v[32:47], a[164:167], a[108:111], v[32:47]
    ds_read_b128 a[160:163], v4 offset:21504
    buffer_load_dwordx4 a[148:151], v2, s[56:59], s37 offen offset:1024
    v_mfma_f32_32x32x16_bf16 v[48:63], a[168:171], a[108:111], v[48:63]
    ds_read_b128 a[164:167], v4 offset:29696
    s_waitcnt lgkmcnt(5)
    v_mfma_f32_32x32x16_bf16 v[64:79], a[172:175], a[108:111], v[64:79]
    ds_read_b128 a[168:171], v4 offset:14336
    s_waitcnt vmcnt(12)
    v_mfma_f32_32x32x16_bf16 v[32:47], a[176:179], a[112:115], v[32:47]
    ds_read_b128 a[172:175], v4 offset:22528
    buffer_load_dwordx4 a[152:155], v2, s[56:59], s37 offen offset:2048
    s_waitcnt lgkmcnt(5)
    v_mfma_f32_32x32x16_bf16 v[48:63], a[180:183], a[112:115], v[48:63]
    ds_read_b128 a[176:179], v4 offset:30720
    v_mfma_f32_32x32x16_bf16 v[64:79], a[184:187], a[112:115], v[64:79]
    ds_read_b128 a[180:183], v4 offset:15360
    buffer_load_dwordx4 a[156:159], v2, s[56:59], s37 offen offset:3072
    s_waitcnt lgkmcnt(5)
    s_waitcnt vmcnt(13)
    v_mfma_f32_32x32x16_bf16 v[32:47], a[188:191], a[116:119], v[32:47]
    ds_read_b128 a[184:187], v4 offset:23552
    v_mfma_f32_32x32x16_bf16 v[48:63], a[160:163], a[116:119], v[48:63]
    ds_read_b128 a[188:191], v4 offset:31744
    s_add_u32 m0, s66, 0
    s_add_u32 s7, s65, 122880
    buffer_load_dwordx4 v3, s[68:71], s7 offen lds
    s_waitcnt lgkmcnt(5)
    s_waitcnt vmcnt(7)
    s_barrier
    v_mfma_f32_32x32x16_bf16 v[64:79], a[164:167], a[116:119], v[64:79]
    ds_read_b128 a[160:163], v4 offset:32768
    v_mfma_f32_32x32x16_bf16 v[32:47], a[168:171], a[120:123], v[32:47]
    ds_read_b128 a[164:167], v4 offset:40960
    s_add_u32 m0, s66, 4096
    s_add_u32 s7, s65, 126976
    buffer_load_dwordx4 v3, s[68:71], s7 offen lds
    s_waitcnt lgkmcnt(5)
    v_mfma_f32_32x32x16_bf16 v[48:63], a[172:175], a[120:123], v[48:63]
    ds_read_b128 a[168:171], v4 offset:49152
    v_mfma_f32_32x32x16_bf16 v[64:79], a[176:179], a[120:123], v[64:79]
    ds_read_b128 a[172:175], v4 offset:33792
    s_waitcnt lgkmcnt(5)
    v_mfma_f32_32x32x16_bf16 v[32:47], a[180:183], a[124:127], v[32:47]
    ds_read_b128 a[176:179], v4 offset:41984
    s_add_u32 m0, s66, 8192
    s_add_u32 s7, s65, 131072
    buffer_load_dwordx4 v3, s[68:71], s7 offen lds
    v_mfma_f32_32x32x16_bf16 v[48:63], a[184:187], a[124:127], v[48:63]
    ds_read_b128 a[180:183], v4 offset:50176
    s_waitcnt lgkmcnt(5)
    v_mfma_f32_32x32x16_bf16 v[64:79], a[188:191], a[124:127], v[64:79]
    ds_read_b128 a[184:187], v4 offset:34816
    s_add_u32 m0, s66, 12288
    s_add_u32 s7, s65, 135168
    buffer_load_dwordx4 v3, s[68:71], s7 offen lds
    v_mfma_f32_32x32x16_bf16 v[32:47], a[160:163], a[128:131], v[32:47]
    ds_read_b128 a[188:191], v4 offset:43008
    s_waitcnt lgkmcnt(5)
    v_mfma_f32_32x32x16_bf16 v[48:63], a[164:167], a[128:131], v[48:63]
    ds_read_b128 a[160:163], v4 offset:51200
    s_add_u32 m0, s66, 16384
    s_add_u32 s7, s65, 139264
    buffer_load_dwordx4 v3, s[68:71], s7 offen lds
    v_mfma_f32_32x32x16_bf16 v[64:79], a[168:171], a[128:131], v[64:79]
    ds_read_b128 a[164:167], v4 offset:35840
    s_waitcnt lgkmcnt(5)
    v_mfma_f32_32x32x16_bf16 v[32:47], a[172:175], a[132:135], v[32:47]
    ds_read_b128 a[168:171], v4 offset:44032
    s_add_u32 m0, s66, 24576
    s_add_u32 s7, s65, 143360
    buffer_load_dwordx4 v3, s[68:71], s7 offen lds
    v_mfma_f32_32x32x16_bf16 v[48:63], a[176:179], a[132:135], v[48:63]
    ds_read_b128 a[172:175], v4 offset:52224
    s_waitcnt lgkmcnt(5)
    v_mfma_f32_32x32x16_bf16 v[64:79], a[180:183], a[132:135], v[64:79]
    ds_read_b128 a[176:179], v4 offset:36864
    s_waitcnt vmcnt(11)
    v_mfma_f32_32x32x16_bf16 v[32:47], a[184:187], a[136:139], v[32:47]
    ds_read_b128 a[180:183], v4 offset:45056
    s_add_u32 m0, s66, 28672
    s_add_u32 s7, s65, 147456
    buffer_load_dwordx4 v3, s[68:71], s7 offen lds
    s_waitcnt lgkmcnt(5)
    v_mfma_f32_32x32x16_bf16 v[48:63], a[188:191], a[136:139], v[48:63]
    ds_read_b128 a[184:187], v4 offset:53248
    v_mfma_f32_32x32x16_bf16 v[64:79], a[160:163], a[136:139], v[64:79]
    ds_read_b128 a[188:191], v4 offset:37888
    s_add_u32 m0, s66, 32768
    s_add_u32 s7, s65, 151552
    buffer_load_dwordx4 v3, s[68:71], s7 offen lds
    s_waitcnt lgkmcnt(5)
    s_waitcnt vmcnt(12)
    v_mfma_f32_32x32x16_bf16 v[32:47], a[164:167], a[140:143], v[32:47]
    ds_read_b128 a[160:163], v4 offset:46080
    v_mfma_f32_32x32x16_bf16 v[48:63], a[168:171], a[140:143], v[48:63]
    ds_read_b128 a[164:167], v4 offset:54272
    s_add_u32 m0, s66, 36864
    s_add_u32 s7, s65, 155648
    buffer_load_dwordx4 v3, s[68:71], s7 offen lds
    s_waitcnt lgkmcnt(5)
    v_mfma_f32_32x32x16_bf16 v[64:79], a[172:175], a[140:143], v[64:79]
    ds_read_b128 a[168:171], v4 offset:38912
    s_waitcnt vmcnt(12)
    v_mfma_f32_32x32x16_bf16 v[32:47], a[176:179], a[144:147], v[32:47]
    ds_read_b128 a[172:175], v4 offset:47104
    s_add_u32 m0, s66, 40960
    s_add_u32 s7, s65, 159744
    buffer_load_dwordx4 v3, s[68:71], s7 offen lds
    s_waitcnt lgkmcnt(5)
    v_mfma_f32_32x32x16_bf16 v[48:63], a[180:183], a[144:147], v[48:63]
    ds_read_b128 a[176:179], v4 offset:55296
    v_mfma_f32_32x32x16_bf16 v[64:79], a[184:187], a[144:147], v[64:79]
    ds_read_b128 a[180:183], v4 offset:39936
    s_waitcnt lgkmcnt(5)
    s_waitcnt vmcnt(12)
    v_mfma_f32_32x32x16_bf16 v[32:47], a[188:191], a[148:151], v[32:47]
    ds_read_b128 a[184:187], v4 offset:57344
    s_add_u32 m0, s66, 49152
    s_add_u32 s7, s65, 163840
    buffer_load_dwordx4 v3, s[68:71], s7 offen lds
    v_mfma_f32_32x32x16_bf16 v[48:63], a[160:163], a[148:151], v[48:63]
    ds_read_b128 a[188:191], v4 offset:48128
    s_waitcnt lgkmcnt(5)
    v_mfma_f32_32x32x16_bf16 v[64:79], a[164:167], a[148:151], v[64:79]
    ds_read_b128 a[160:163], v4 offset:58368
    s_add_u32 m0, s66, 53248
    s_add_u32 s7, s65, 167936
    buffer_load_dwordx4 v3, s[68:71], s7 offen lds
    s_waitcnt vmcnt(13)
    v_mfma_f32_32x32x16_bf16 v[32:47], a[168:171], a[152:155], v[32:47]
    ds_read_b128 a[164:167], v4 offset:56320
    s_waitcnt lgkmcnt(5)
    v_mfma_f32_32x32x16_bf16 v[48:63], a[172:175], a[152:155], v[48:63]
    ds_read_b128 a[168:171], v4 offset:59392
    s_add_u32 m0, s66, 57344
    s_add_u32 s7, s65, 172032
    buffer_load_dwordx4 v3, s[68:71], s7 offen lds
    s_waitcnt vmcnt(8)
    s_barrier
    v_mfma_f32_32x32x16_bf16 v[64:79], a[176:179], a[152:155], v[64:79]
    ds_read_b128 a[172:175], v2 offset:0
    s_waitcnt lgkmcnt(5)
    v_mfma_f32_32x32x16_bf16 v[32:47], a[180:183], a[156:159], v[32:47]
    ds_read_b128 a[176:179], v2 offset:1024
    s_add_u32 m0, s66, 61440
    s_add_u32 s7, s65, 176128
    buffer_load_dwordx4 v3, s[68:71], s7 offen lds
    v_mfma_f32_32x32x16_bf16 v[32:47], a[184:187], v[16:19], v[32:47]
    ds_read_b128 a[180:183], v2 offset:2048
    s_waitcnt lgkmcnt(5)
    v_mfma_f32_32x32x16_bf16 v[48:63], a[188:191], a[156:159], v[48:63]
    ds_read_b128 a[184:187], v2 offset:3072
    v_mfma_f32_32x32x16_bf16 v[48:63], a[160:163], v[16:19], v[48:63]
    ds_read_b128 a[188:191], v2 offset:4096
    s_add_u32 m0, s66, 65536
    s_add_u32 s7, s65, 180224
    buffer_load_dwordx4 v3, s[68:71], s7 offen lds
    s_waitcnt lgkmcnt(5)
    v_mfma_f32_32x32x16_bf16 v[64:79], a[164:167], a[156:159], v[64:79]
    ds_read_b128 a[160:163], v2 offset:5120
    v_mfma_f32_32x32x16_bf16 v[64:79], a[168:171], v[16:19], v[64:79]
    ds_read_b128 a[164:167], v2 offset:6144
    buffer_load_dwordx4 v[228:231], v15, s[44:47], s63 offen offset:3072
    v_mul_f32 v116, v32, v32
    v_mul_f32 v117, v33, v33
    v_mul_f32 v118, v34, v34
    s_waitcnt lgkmcnt(5)
    v_mfma_f32_32x32x16_bf16 v[80:95], a[172:175], a[0:3], 0
    ds_read_b128 a[168:171], v2 offset:7168
    v_mul_f32 v119, v35, v35
    v_fma_f32 v116, v116, v21, v20
    v_fma_f32 v117, v117, v21, v20
    v_fma_f32 v118, v118, v21, v20
    v_fma_f32 v119, v119, v21, v20
    v_mfma_f32_32x32x16_bf16 v[80:95], a[176:179], a[4:7], v[80:95]
    ds_read_b128 a[172:175], v2 offset:8192
    s_add_u32 s63, s9, 61440
    buffer_load_dwordx4 v[232:235], v2, s[44:47], s63 offen
    v_mul_f32 v116, v116, v32
    v_mul_f32 v117, v117, v33
    s_waitcnt lgkmcnt(5)
    v_mfma_f32_32x32x16_bf16 v[80:95], a[180:183], a[8:11], v[80:95]
    ds_read_b128 a[176:179], v2 offset:9216
    v_mul_f32 v118, v118, v34
    v_mul_f32 v119, v119, v35
    v_exp_f32 v116, v116
    v_mfma_f32_32x32x16_bf16 v[80:95], a[184:187], a[12:15], v[80:95]
    ds_read_b128 a[180:183], v2 offset:10240
    buffer_load_dwordx4 v[236:239], v15, s[44:47], s63 offen offset:0
    v_exp_f32 v117, v117
    s_waitcnt lgkmcnt(5)
    v_mfma_f32_32x32x16_bf16 v[80:95], a[188:191], a[16:19], v[80:95]
    ds_read_b128 a[184:187], v2 offset:11264
    v_exp_f32 v118, v118
    v_exp_f32 v119, v119
    v_mul_f32 v32, v32, v36
    v_mfma_f32_32x32x16_bf16 v[80:95], a[160:163], a[20:23], v[80:95]
    ds_read_b128 a[188:191], v2 offset:12288
    v_mul_f32 v33, v33, v37
    v_mul_f32 v34, v34, v38
    v_mul_f32 v35, v35, v39
    v_fma_f32 v116, v116, v22, v22
    s_waitcnt lgkmcnt(5)
    v_mfma_f32_32x32x16_bf16 v[80:95], a[164:167], a[24:27], v[80:95]
    ds_read_b128 a[160:163], v2 offset:13312
    buffer_load_dwordx4 v[240:243], v15, s[44:47], s63 offen offset:1024
    v_fma_f32 v117, v117, v22, v22
    v_fma_f32 v118, v118, v22, v22
    v_fma_f32 v119, v119, v22, v22
    v_mfma_f32_32x32x16_bf16 v[80:95], a[168:171], a[28:31], v[80:95]
    ds_read_b128 a[164:167], v2 offset:14336
    v_rcp_f32 v116, v116
    v_rcp_f32 v117, v117
    s_waitcnt lgkmcnt(5)
    v_mfma_f32_32x32x16_bf16 v[80:95], a[172:175], a[32:35], v[80:95]
    ds_read_b128 a[168:171], v2 offset:15360
    buffer_load_dwordx4 v[244:247], v15, s[44:47], s63 offen offset:2048
    v_rcp_f32 v118, v118
    v_rcp_f32 v119, v119
    v_mfma_f32_32x32x16_bf16 v[80:95], a[176:179], a[36:39], v[80:95]
    ds_read_b128 a[172:175], v2 offset:16384
    v_mul_f32 v32, v32, v116
    v_mul_f32 v33, v33, v117
    v_mul_f32 v34, v34, v118
    v_mul_f32 v35, v35, v119
    s_waitcnt lgkmcnt(5)
    v_mfma_f32_32x32x16_bf16 v[80:95], a[180:183], a[40:43], v[80:95]
    ds_read_b128 a[176:179], v2 offset:17408
    buffer_load_dwordx4 v[248:251], v15, s[44:47], s63 offen offset:3072
    v_mul_f32 v120, v40, v40
    v_mul_f32 v121, v41, v41
    v_mul_f32 v122, v42, v42
    v_mul_f32 v123, v43, v43
    v_mfma_f32_32x32x16_bf16 v[80:95], a[184:187], a[44:47], v[80:95]
    ds_read_b128 a[180:183], v2 offset:18432
    v_fma_f32 v120, v120, v21, v20
    v_fma_f32 v121, v121, v21, v20
    v_fma_f32 v122, v122, v21, v20
    v_fma_f32 v123, v123, v21, v20
    s_waitcnt lgkmcnt(5)
    v_mfma_f32_32x32x16_bf16 v[80:95], a[188:191], a[48:51], v[80:95]
    ds_read_b128 a[184:187], v2 offset:19456
    s_add_u32 m0, s66, 73728
    s_add_u32 s7, s65, 184320
    buffer_load_dwordx4 v3, s[68:71], s7 offen lds
    v_mul_f32 v120, v120, v40
    v_mul_f32 v121, v121, v41
    s_waitcnt vmcnt(12)
    s_barrier
    v_mfma_f32_32x32x16_bf16 v[80:95], a[160:163], a[52:55], v[80:95]
    ds_read_b128 a[188:191], v2 offset:24576
    v_mul_f32 v122, v122, v42
    v_mul_f32 v123, v123, v43
    v_exp_f32 v120, v120
    s_waitcnt lgkmcnt(5)
    v_mfma_f32_32x32x16_bf16 v[80:95], a[164:167], a[56:59], v[80:95]
    ds_read_b128 a[160:163], v2 offset:25600
    v_exp_f32 v121, v121
    v_exp_f32 v122, v122
    v_mfma_f32_32x32x16_bf16 v[80:95], a[168:171], a[60:63], v[80:95]
    ds_read_b128 a[164:167], v2 offset:26624
    s_add_u32 m0, s66, 77824
    s_add_u32 s7, s65, 188416
    buffer_load_dwordx4 v3, s[68:71], s7 offen lds
    s_waitcnt lgkmcnt(5)
    v_mfma_f32_32x32x16_bf16 v[80:95], a[172:175], a[64:67], v[80:95]
    ds_read_b128 a[168:171], v2 offset:27648
    v_exp_f32 v123, v123
    v_mul_f32 v40, v40, v44
    v_mul_f32 v41, v41, v45
    v_mul_f32 v42, v42, v46
    v_mfma_f32_32x32x16_bf16 v[80:95], a[176:179], a[68:71], v[80:95]
    ds_read_b128 a[172:175], v2 offset:28672
    s_add_u32 m0, s66, 81920
    s_add_u32 s7, s65, 192512
    buffer_load_dwordx4 v3, s[68:71], s7 offen lds
    v_mul_f32 v43, v43, v47
    s_waitcnt lgkmcnt(5)
    v_mfma_f32_32x32x16_bf16 v[80:95], a[180:183], a[72:75], v[80:95]
    ds_read_b128 a[176:179], v2 offset:29696
    v_fma_f32 v120, v120, v22, v22
    v_fma_f32 v121, v121, v22, v22
    v_fma_f32 v122, v122, v22, v22
    v_fma_f32 v123, v123, v22, v22
    v_mfma_f32_32x32x16_bf16 v[80:95], a[184:187], a[76:79], v[80:95]
    ds_read_b128 a[180:183], v2 offset:30720
    s_add_u32 m0, s66, 86016
    s_add_u32 s7, s65, 196608
    buffer_load_dwordx4 v3, s[68:71], s7 offen lds
    s_waitcnt lgkmcnt(5)
    v_mfma_f32_32x32x16_bf16 v[80:95], a[188:191], a[80:83], v[80:95]
    ds_read_b128 a[184:187], v2 offset:31744
    v_rcp_f32 v120, v120
    v_rcp_f32 v121, v121
    v_mfma_f32_32x32x16_bf16 v[80:95], a[160:163], a[84:87], v[80:95]
    ds_read_b128 a[188:191], v2 offset:32768
    s_add_u32 m0, s66, 90112
    s_add_u32 s7, s65, 200704
    buffer_load_dwordx4 v3, s[68:71], s7 offen lds
    s_waitcnt lgkmcnt(5)
    v_mfma_f32_32x32x16_bf16 v[80:95], a[164:167], a[88:91], v[80:95]
    ds_read_b128 a[160:163], v2 offset:33792
    v_rcp_f32 v122, v122
    v_rcp_f32 v123, v123
    v_cvt_pk_bf16_f32 v112, v32, v33
    v_mfma_f32_32x32x16_bf16 v[80:95], a[168:171], a[92:95], v[80:95]
    ds_read_b128 a[164:167], v2 offset:34816
    v_cvt_pk_bf16_f32 v113, v34, v35
    v_mul_f32 v40, v40, v120
    v_mul_f32 v41, v41, v121
    v_mul_f32 v42, v42, v122
    s_waitcnt lgkmcnt(5)
    v_mfma_f32_32x32x16_bf16 v[80:95], a[172:175], a[96:99], v[80:95]
    ds_read_b128 a[168:171], v2 offset:35840
    s_add_u32 s63, s8, 10240
    buffer_load_dwordx4 v[252:255], v2, s[44:47], s63 offen
    v_mul_f32 v43, v43, v123
    v_cvt_pk_bf16_f32 v114, v40, v41
    v_cvt_pk_bf16_f32 v115, v42, v43
    v_mfma_f32_32x32x16_bf16 v[80:95], a[176:179], a[100:103], v[80:95]
    ds_read_b128 a[172:175], v2 offset:36864
    buffer_store_dwordx4 v[112:115], v2, s[52:55], s35 offen offset:0 sc1
    v_mul_f32 v128, v48, v48
    v_mul_f32 v129, v49, v49
    v_mul_f32 v130, v50, v50
    s_waitcnt lgkmcnt(5)
    v_mfma_f32_32x32x16_bf16 v[80:95], a[180:183], a[104:107], v[80:95]
    ds_read_b128 a[176:179], v2 offset:37888
    buffer_load_dwordx4 a[192:195], v15, s[44:47], s63 offen offset:0
    v_mul_f32 v131, v51, v51
    v_fma_f32 v128, v128, v21, v20
    v_fma_f32 v129, v129, v21, v20
    v_fma_f32 v130, v130, v21, v20
    v_mfma_f32_32x32x16_bf16 v[80:95], a[184:187], a[108:111], v[80:95]
    ds_read_b128 a[180:183], v2 offset:38912
    v_fma_f32 v131, v131, v21, v20
    v_mul_f32 v128, v128, v48
    v_mul_f32 v129, v129, v49
    v_mul_f32 v130, v130, v50
    s_waitcnt lgkmcnt(5)
    v_mfma_f32_32x32x16_bf16 v[80:95], a[188:191], a[112:115], v[80:95]
    ds_read_b128 a[184:187], v2 offset:39936
    buffer_load_dwordx4 a[196:199], v15, s[44:47], s63 offen offset:1024
    v_mul_f32 v131, v131, v51
    v_exp_f32 v128, v128
    v_mfma_f32_32x32x16_bf16 v[80:95], a[160:163], a[116:119], v[80:95]
    ds_read_b128 a[188:191], v2 offset:40960
    v_exp_f32 v129, v129
    v_exp_f32 v130, v130
    s_waitcnt lgkmcnt(5)
    v_mfma_f32_32x32x16_bf16 v[80:95], a[164:167], a[120:123], v[80:95]
    ds_read_b128 a[160:163], v2 offset:41984
    buffer_load_dwordx4 a[248:251], v15, s[44:47], s63 offen offset:2048
    v_exp_f32 v131, v131
    v_mul_f32 v48, v48, v52
    v_mul_f32 v49, v49, v53
    v_mfma_f32_32x32x16_bf16 v[80:95], a[168:171], a[124:127], v[80:95]
    ds_read_b128 a[164:167], v2 offset:43008
    v_mul_f32 v50, v50, v54
    v_mul_f32 v51, v51, v55
    v_fma_f32 v128, v128, v22, v22
    v_fma_f32 v129, v129, v22, v22
    s_waitcnt lgkmcnt(5)
    v_mfma_f32_32x32x16_bf16 v[80:95], a[172:175], a[128:131], v[80:95]
    ds_read_b128 a[168:171], v2 offset:44032
    v_fma_f32 v130, v130, v22, v22
    v_fma_f32 v131, v131, v22, v22
    v_rcp_f32 v128, v128
    v_mfma_f32_32x32x16_bf16 v[80:95], a[176:179], a[132:135], v[80:95]
    ds_read_b128 a[172:175], v4 offset:60416
    buffer_load_dwordx4 a[252:255], v15, s[44:47], s63 offen offset:3072
    v_rcp_f32 v129, v129
    s_waitcnt lgkmcnt(5)
    s_waitcnt vmcnt(17)
    s_barrier
    v_mfma_f32_32x32x16_bf16 v[80:95], a[180:183], a[136:139], v[80:95]
    ds_read_b128 a[176:179], v2 offset:49152
    v_rcp_f32 v130, v130
    v_rcp_f32 v131, v131
    v_mul_f32 v48, v48, v128
    v_mfma_f32_32x32x16_bf16 v[80:95], a[184:187], a[140:143], v[80:95]
    ds_read_b128 a[180:183], v2 offset:50176
    s_add_u32 m0, s66, 131072
    s_add_u32 s63, s8, 46080
    buffer_load_dwordx4 v2, s[44:47], s63 offen lds
    v_mul_f32 v49, v49, v129
    s_waitcnt lgkmcnt(5)
    v_mfma_f32_32x32x16_bf16 v[80:95], a[188:191], a[144:147], v[80:95]
    ds_read_b128 a[184:187], v2 offset:51200
    v_mul_f32 v50, v50, v130
    v_mul_f32 v51, v51, v131
    v_mul_f32 v132, v56, v56
    v_mul_f32 v133, v57, v57
    v_mul_f32 v134, v58, v58
    v_mfma_f32_32x32x16_bf16 v[80:95], a[160:163], a[148:151], v[80:95]
    ds_read_b128 a[188:191], v2 offset:52224
    s_add_u32 m0, s66, 135168
    s_add_u32 s63, s8, 47104
    buffer_load_dwordx4 v2, s[44:47], s63 offen lds
    v_mul_f32 v135, v59, v59
    s_waitcnt lgkmcnt(5)
    v_mfma_f32_32x32x16_bf16 v[80:95], a[164:167], a[152:155], v[80:95]
    ds_read_b128 a[160:163], v2 offset:53248
    v_fma_f32 v132, v132, v21, v20
    v_fma_f32 v133, v133, v21, v20
    v_fma_f32 v134, v134, v21, v20
    v_fma_f32 v135, v135, v21, v20
    v_mul_f32 v132, v132, v56
    v_mfma_f32_32x32x16_bf16 v[80:95], a[168:171], a[156:159], v[80:95]
    ds_read_b128 a[164:167], v2 offset:54272
    s_add_u32 m0, s66, 139264
    s_add_u32 s63, s8, 48128
    buffer_load_dwordx4 v2, s[44:47], s63 offen lds
    v_mul_f32 v133, v133, v57
    s_waitcnt lgkmcnt(5)
    v_mfma_f32_32x32x16_bf16 v[80:95], a[172:175], v[16:19], v[80:95]
    ds_read_b128 a[168:171], v2 offset:55296
    v_mul_f32 v134, v134, v58
    v_mul_f32 v135, v135, v59
    v_exp_f32 v132, v132
    v_mfma_f32_32x32x16_bf16 v[96:111], a[176:179], a[0:3], 0
    ds_read_b128 a[172:175], v2 offset:56320
    v_exp_f32 v133, v133
    v_exp_f32 v134, v134
    s_waitcnt lgkmcnt(5)
    v_mfma_f32_32x32x16_bf16 v[96:111], a[180:183], a[4:7], v[96:111]
    ds_read_b128 a[176:179], v2 offset:57344
    s_add_u32 m0, s66, 143360
    s_add_u32 s63, s8, 49152
    buffer_load_dwordx4 v2, s[44:47], s63 offen lds
    v_exp_f32 v135, v135
    v_mfma_f32_32x32x16_bf16 v[96:111], a[184:187], a[8:11], v[96:111]
    ds_read_b128 a[180:183], v2 offset:58368
    v_mul_f32 v56, v56, v60
    v_mul_f32 v57, v57, v61
    v_mul_f32 v58, v58, v62
    v_mul_f32 v59, v59, v63
    s_waitcnt lgkmcnt(5)
    v_mfma_f32_32x32x16_bf16 v[96:111], a[188:191], a[12:15], v[96:111]
    ds_read_b128 a[184:187], v2 offset:59392
    s_add_u32 m0, s66, 147456
    s_add_u32 s63, s8, 50176
    buffer_load_dwordx4 v2, s[44:47], s63 offen lds
    v_fma_f32 v132, v132, v22, v22
    v_fma_f32 v133, v133, v22, v22
    v_mfma_f32_32x32x16_bf16 v[96:111], a[160:163], a[16:19], v[96:111]
    ds_read_b128 a[188:191], v2 offset:60416
    v_fma_f32 v134, v134, v22, v22
    v_fma_f32 v135, v135, v22, v22
    v_rcp_f32 v132, v132
    s_waitcnt lgkmcnt(5)
    v_mfma_f32_32x32x16_bf16 v[96:111], a[164:167], a[20:23], v[96:111]
    ds_read_b128 a[160:163], v2 offset:61440
    s_add_u32 m0, s66, 151552
    s_add_u32 s63, s8, 15360
    buffer_load_dwordx4 v2, s[44:47], s63 offen lds
    v_rcp_f32 v133, v133
    v_mfma_f32_32x32x16_bf16 v[96:111], a[168:171], a[24:27], v[96:111]
    ds_read_b128 a[164:167], v2 offset:62464
    v_rcp_f32 v134, v134
    v_rcp_f32 v135, v135
    s_waitcnt lgkmcnt(5)
    v_mfma_f32_32x32x16_bf16 v[96:111], a[172:175], a[28:31], v[96:111]
    ds_read_b128 a[168:171], v2 offset:63488
    s_add_u32 m0, s66, 98304
    s_add_u32 s7, s65, 204800
    buffer_load_dwordx4 v3, s[68:71], s7 offen lds
    v_cvt_pk_bf16_f32 v124, v48, v49
    v_cvt_pk_bf16_f32 v125, v50, v51
    v_mfma_f32_32x32x16_bf16 v[96:111], a[176:179], a[32:35], v[96:111]
    ds_read_b128 a[172:175], v2 offset:64512
    v_mul_f32 v56, v56, v132
    v_mul_f32 v57, v57, v133
    v_mul_f32 v58, v58, v134
    v_mul_f32 v59, v59, v135
    s_waitcnt lgkmcnt(5)
    v_mfma_f32_32x32x16_bf16 v[96:111], a[180:183], a[36:39], v[96:111]
    ds_read_b128 a[176:179], v4 offset:0
    v_cvt_pk_bf16_f32 v126, v56, v57
    v_cvt_pk_bf16_f32 v127, v58, v59
    buffer_store_dwordx4 v[124:127], v2, s[52:55], s35 offen offset:1024 sc1
    v_mul_f32 v116, v64, v64
    v_mul_f32 v117, v65, v65
    v_mfma_f32_32x32x16_bf16 v[96:111], a[184:187], a[40:43], v[96:111]
    ds_read_b128 a[180:183], v4 offset:1024
    s_add_u32 m0, s66, 102400
    s_add_u32 s7, s65, 208896
    buffer_load_dwordx4 v3, s[68:71], s7 offen lds
    v_mul_f32 v118, v66, v66
    s_waitcnt lgkmcnt(5)
    v_mfma_f32_32x32x16_bf16 v[96:111], a[188:191], a[44:47], v[96:111]
    ds_read_b128 a[184:187], v4 offset:2048
    v_mul_f32 v119, v67, v67
    v_fma_f32 v116, v116, v21, v20
    v_fma_f32 v117, v117, v21, v20
    v_fma_f32 v118, v118, v21, v20
    v_fma_f32 v119, v119, v21, v20
    v_mfma_f32_32x32x16_bf16 v[96:111], a[160:163], a[48:51], v[96:111]
    ds_read_b128 a[188:191], v4 offset:3072
    s_add_u32 m0, s66, 106496
    s_add_u32 s7, s65, 212992
    buffer_load_dwordx4 v3, s[68:71], s7 offen lds
    v_mul_f32 v116, v116, v64
    s_waitcnt lgkmcnt(5)
    s_waitcnt vmcnt(16)
    s_barrier
    v_mfma_f32_32x32x16_bf16 v[96:111], a[164:167], a[52:55], v[96:111]
    ds_read_b128 a[160:163], v4 offset:8192
    v_mul_f32 v117, v117, v65
    v_mul_f32 v118, v118, v66
    v_mul_f32 v119, v119, v67
    v_exp_f32 v116, v116
    v_mfma_f32_32x32x16_bf16 v[96:111], a[168:171], a[56:59], v[96:111]
    ds_read_b128 a[164:167], v4 offset:9216
    s_add_u32 m0, s66, 110592
    s_add_u32 s7, s65, 217088
    buffer_load_dwordx4 v3, s[68:71], s7 offen lds
    s_waitcnt lgkmcnt(5)
    v_mfma_f32_32x32x16_bf16 v[96:111], a[172:175], a[60:63], v[96:111]
    ds_read_b128 a[168:171], v4 offset:10240
    v_exp_f32 v117, v117
    v_exp_f32 v118, v118
    v_mfma_f32_32x32x16_bf16 v[96:111], a[176:179], a[64:67], v[96:111]
    ds_read_b128 a[172:175], v4 offset:11264
    s_add_u32 m0, s66, 114688
    s_add_u32 s7, s65, 221184
    buffer_load_dwordx4 v3, s[68:71], s7 offen lds
    s_waitcnt lgkmcnt(5)
    v_mfma_f32_32x32x16_bf16 v[96:111], a[180:183], a[68:71], v[96:111]
    ds_read_b128 a[176:179], v4 offset:12288
    v_exp_f32 v119, v119
    v_mul_f32 v64, v64, v68
    v_mul_f32 v65, v65, v69
    v_mul_f32 v66, v66, v70
    v_mfma_f32_32x32x16_bf16 v[96:111], a[184:187], a[72:75], v[96:111]
    ds_read_b128 a[180:183], v4 offset:13312
    v_mul_f32 v67, v67, v71
    v_fma_f32 v116, v116, v22, v22
    v_fma_f32 v117, v117, v22, v22
    v_fma_f32 v118, v118, v22, v22
    s_waitcnt lgkmcnt(5)
    v_mfma_f32_32x32x16_bf16 v[96:111], a[188:191], a[76:79], v[96:111]
    ds_read_b128 a[184:187], v4 offset:14336
    s_add_u32 m0, s66, 155648
    s_add_u32 s63, s8, 16384
    buffer_load_dwordx4 v2, s[44:47], s63 offen lds
    v_fma_f32 v119, v119, v22, v22
    v_mfma_f32_32x32x16_bf16 v[96:111], a[160:163], a[80:83], v[96:111]
    ds_read_b128 a[188:191], v4 offset:15360
    v_rcp_f32 v116, v116
    v_rcp_f32 v117, v117
    s_waitcnt lgkmcnt(5)
    v_mfma_f32_32x32x16_bf16 v[96:111], a[164:167], a[84:87], v[96:111]
    ds_read_b128 a[160:163], v4 offset:16384
    s_add_u32 m0, s66, 159744
    s_add_u32 s63, s8, 17408
    buffer_load_dwordx4 v2, s[44:47], s63 offen lds
    v_rcp_f32 v118, v118
    v_mfma_f32_32x32x16_bf16 v[96:111], a[168:171], a[88:91], v[96:111]
    ds_read_b128 a[164:167], v4 offset:17408
    v_rcp_f32 v119, v119
    v_mul_f32 v64, v64, v116
    v_mul_f32 v65, v65, v117
    s_waitcnt lgkmcnt(5)
    v_mfma_f32_32x32x16_bf16 v[96:111], a[172:175], a[92:95], v[96:111]
    ds_read_b128 a[168:171], v4 offset:18432
    s_add_u32 m0, s66, 0
    s_add_u32 s7, s65, 225280
    buffer_load_dwordx4 v3, s[68:71], s7 offen lds
    v_mul_f32 v66, v66, v118
    v_mul_f32 v67, v67, v119
    v_mfma_f32_32x32x16_bf16 v[96:111], a[176:179], a[96:99], v[96:111]
    ds_read_b128 a[172:175], v4 offset:19456
    v_mul_f32 v120, v72, v72
    v_mul_f32 v121, v73, v73
    v_mul_f32 v122, v74, v74
    v_mul_f32 v123, v75, v75
    s_waitcnt lgkmcnt(5)
    v_mfma_f32_32x32x16_bf16 v[96:111], a[180:183], a[100:103], v[96:111]
    ds_read_b128 a[176:179], v4 offset:20480
    s_add_u32 m0, s66, 4096
    s_add_u32 s7, s65, 229376
    buffer_load_dwordx4 v3, s[68:71], s7 offen lds
    v_fma_f32 v120, v120, v21, v20
    v_fma_f32 v121, v121, v21, v20
    v_mfma_f32_32x32x16_bf16 v[96:111], a[184:187], a[104:107], v[96:111]
    ds_read_b128 a[180:183], v4 offset:21504
    v_fma_f32 v122, v122, v21, v20
    v_fma_f32 v123, v123, v21, v20
    v_mul_f32 v120, v120, v72
    v_mul_f32 v121, v121, v73
    s_waitcnt lgkmcnt(5)
    v_mfma_f32_32x32x16_bf16 v[96:111], a[188:191], a[108:111], v[96:111]
    ds_read_b128 a[184:187], v4 offset:22528
    v_mul_f32 v122, v122, v74
    v_mul_f32 v123, v123, v75
    v_exp_f32 v120, v120
    v_mfma_f32_32x32x16_bf16 v[96:111], a[160:163], a[112:115], v[96:111]
    ds_read_b128 a[188:191], v4 offset:23552
    s_add_u32 m0, s66, 8192
    s_add_u32 s7, s65, 233472
    buffer_load_dwordx4 v3, s[68:71], s7 offen lds
    s_waitcnt lgkmcnt(5)
    v_mfma_f32_32x32x16_bf16 v[96:111], a[164:167], a[116:119], v[96:111]
    ds_read_b128 a[160:163], v4 offset:24576
    v_exp_f32 v121, v121
    v_exp_f32 v122, v122
    v_mfma_f32_32x32x16_bf16 v[96:111], a[168:171], a[120:123], v[96:111]
    ds_read_b128 a[164:167], v4 offset:25600
    s_add_u32 m0, s66, 12288
    s_add_u32 s7, s65, 237568
    buffer_load_dwordx4 v3, s[68:71], s7 offen lds
    s_waitcnt lgkmcnt(5)
    v_mfma_f32_32x32x16_bf16 v[96:111], a[172:175], a[124:127], v[96:111]
    ds_read_b128 a[168:171], v4 offset:26624
    v_exp_f32 v123, v123
    v_mul_f32 v72, v72, v76
    v_mul_f32 v73, v73, v77
    v_mul_f32 v74, v74, v78
    v_mfma_f32_32x32x16_bf16 v[96:111], a[176:179], a[128:131], v[96:111]
    ds_read_b128 a[172:175], v4 offset:27648
    s_add_u32 m0, s66, 16384
    s_add_u32 s7, s65, 241664
    buffer_load_dwordx4 v3, s[68:71], s7 offen lds
    v_mul_f32 v75, v75, v79
    s_waitcnt lgkmcnt(5)
    v_mfma_f32_32x32x16_bf16 v[96:111], a[180:183], a[132:135], v[96:111]
    ds_read_b128 a[176:179], v4 offset:61440
    v_fma_f32 v120, v120, v22, v22
    v_fma_f32 v121, v121, v22, v22
    v_fma_f32 v122, v122, v22, v22
    v_fma_f32 v123, v123, v22, v22
    s_waitcnt vmcnt(7)
    s_barrier
    v_mfma_f32_32x32x16_bf16 v[96:111], a[184:187], a[136:139], v[96:111]
    ds_read_b128 a[180:183], v4 offset:32768
    s_add_u32 m0, s66, 24576
    s_add_u32 s7, s65, 245760
    buffer_load_dwordx4 v3, s[68:71], s7 offen lds
    s_waitcnt lgkmcnt(5)
    v_mfma_f32_32x32x16_bf16 v[96:111], a[188:191], a[140:143], v[96:111]
    ds_read_b128 a[184:187], v4 offset:33792
    v_rcp_f32 v120, v120
    v_rcp_f32 v121, v121
    v_mfma_f32_32x32x16_bf16 v[96:111], a[160:163], a[144:147], v[96:111]
    ds_read_b128 a[188:191], v4 offset:34816
    v_rcp_f32 v122, v122
    v_rcp_f32 v123, v123
    s_waitcnt lgkmcnt(5)
    v_mfma_f32_32x32x16_bf16 v[96:111], a[164:167], a[148:151], v[96:111]
    ds_read_b128 a[160:163], v4 offset:35840
    s_add_u32 m0, s66, 28672
    s_add_u32 s7, s65, 249856
    buffer_load_dwordx4 v3, s[68:71], s7 offen lds
    v_cvt_pk_bf16_f32 v112, v64, v65
    v_cvt_pk_bf16_f32 v113, v66, v67
    v_mfma_f32_32x32x16_bf16 v[96:111], a[168:171], a[152:155], v[96:111]
    ds_read_b128 a[164:167], v4 offset:36864
    v_mul_f32 v72, v72, v120
    v_mul_f32 v73, v73, v121
    v_mul_f32 v74, v74, v122
    v_mul_f32 v75, v75, v123
    s_waitcnt lgkmcnt(5)
    v_mfma_f32_32x32x16_bf16 v[96:111], a[172:175], a[156:159], v[96:111]
    ds_read_b128 a[168:171], v4 offset:37888
    s_add_u32 m0, s66, 32768
    s_add_u32 s7, s65, 253952
    buffer_load_dwordx4 v3, s[68:71], s7 offen lds
    v_cvt_pk_bf16_f32 v114, v72, v73
    v_cvt_pk_bf16_f32 v115, v74, v75
    v_mfma_f32_32x32x16_bf16 v[96:111], a[176:179], v[16:19], v[96:111]
    ds_read_b128 a[172:175], v4 offset:38912
    buffer_store_dwordx4 v[112:115], v2, s[52:55], s35 offen offset:2048 sc1
    v_mul_f32 v128, v80, v80
    v_mul_f32 v129, v81, v81
    v_mul_f32 v130, v82, v82
    s_waitcnt lgkmcnt(5)
    v_mfma_f32_32x32x16_bf16 v[32:47], a[180:183], a[0:3], 0
    ds_read_b128 a[176:179], v4 offset:39936
    s_add_u32 m0, s66, 36864
    s_add_u32 s7, s65, 258048
    buffer_load_dwordx4 v3, s[68:71], s7 offen lds
    v_mul_f32 v131, v83, v83
    v_fma_f32 v128, v128, v21, v20
    v_mfma_f32_32x32x16_bf16 v[32:47], a[184:187], a[4:7], v[32:47]
    ds_read_b128 a[180:183], v4 offset:40960
    v_fma_f32 v129, v129, v21, v20
    v_fma_f32 v130, v130, v21, v20
    v_fma_f32 v131, v131, v21, v20
    v_mul_f32 v128, v128, v80
    s_waitcnt lgkmcnt(5)
    v_mfma_f32_32x32x16_bf16 v[32:47], a[188:191], a[8:11], v[32:47]
    ds_read_b128 a[184:187], v4 offset:41984
    s_add_u32 m0, s66, 40960
    s_add_u32 s7, s65, 262144
    buffer_load_dwordx4 v3, s[68:71], s7 offen lds
    v_mul_f32 v129, v129, v81
    v_mul_f32 v130, v130, v82
    v_mfma_f32_32x32x16_bf16 v[32:47], a[160:163], a[12:15], v[32:47]
    ds_read_b128 a[188:191], v4 offset:43008
    v_mul_f32 v131, v131, v83
    v_exp_f32 v128, v128
    s_waitcnt lgkmcnt(5)
    v_mfma_f32_32x32x16_bf16 v[32:47], a[164:167], a[16:19], v[32:47]
    ds_read_b128 a[160:163], v4 offset:44032
    v_exp_f32 v129, v129
    v_exp_f32 v130, v130
    v_mfma_f32_32x32x16_bf16 v[32:47], a[168:171], a[20:23], v[32:47]
    ds_read_b128 a[164:167], v4 offset:45056
    s_add_u32 m0, s66, 49152
    s_add_u32 s7, s65, 266240
    buffer_load_dwordx4 v3, s[68:71], s7 offen lds
    s_waitcnt lgkmcnt(5)
    v_mfma_f32_32x32x16_bf16 v[32:47], a[172:175], a[24:27], v[32:47]
    ds_read_b128 a[168:171], v4 offset:46080
    v_exp_f32 v131, v131
    v_mul_f32 v80, v80, v84
    v_mul_f32 v81, v81, v85
    v_mul_f32 v82, v82, v86
    v_mfma_f32_32x32x16_bf16 v[32:47], a[176:179], a[28:31], v[32:47]
    ds_read_b128 a[172:175], v4 offset:47104
    s_add_u32 m0, s66, 53248
    s_add_u32 s7, s65, 270336
    buffer_load_dwordx4 v3, s[68:71], s7 offen lds
    v_mul_f32 v83, v83, v87
    s_waitcnt lgkmcnt(5)
    v_mfma_f32_32x32x16_bf16 v[32:47], a[180:183], a[32:35], v[32:47]
    ds_read_b128 a[176:179], v4 offset:48128
    v_fma_f32 v128, v128, v22, v22
    v_fma_f32 v129, v129, v22, v22
    v_fma_f32 v130, v130, v22, v22
    v_fma_f32 v131, v131, v22, v22
    v_mfma_f32_32x32x16_bf16 v[32:47], a[184:187], a[36:39], v[32:47]
    ds_read_b128 a[180:183], v4 offset:49152
    s_add_u32 m0, s66, 57344
    s_add_u32 s7, s65, 274432
    buffer_load_dwordx4 v3, s[68:71], s7 offen lds
    s_waitcnt lgkmcnt(5)
    v_mfma_f32_32x32x16_bf16 v[32:47], a[188:191], a[40:43], v[32:47]
    ds_read_b128 a[184:187], v4 offset:50176
    v_rcp_f32 v128, v128
    v_rcp_f32 v129, v129
    v_mfma_f32_32x32x16_bf16 v[32:47], a[160:163], a[44:47], v[32:47]
    ds_read_b128 a[188:191], v4 offset:51200
    s_add_u32 m0, s66, 61440
    s_add_u32 s7, s65, 278528
    buffer_load_dwordx4 v3, s[68:71], s7 offen lds
    s_waitcnt lgkmcnt(5)
    v_mfma_f32_32x32x16_bf16 v[32:47], a[164:167], a[48:51], v[32:47]
    ds_read_b128 a[160:163], v4 offset:52224
    v_rcp_f32 v130, v130
    v_rcp_f32 v131, v131
    v_mul_f32 v80, v80, v128
    s_waitcnt vmcnt(10)
    s_barrier
    v_mfma_f32_32x32x16_bf16 v[32:47], a[168:171], a[52:55], v[32:47]
    ds_read_b128 a[164:167], v2 offset:0
    v_mul_f32 v81, v81, v129
    v_mul_f32 v82, v82, v130
    v_mul_f32 v83, v83, v131
    v_mul_f32 v132, v88, v88
    s_waitcnt lgkmcnt(5)
    v_mfma_f32_32x32x16_bf16 v[32:47], a[172:175], a[56:59], v[32:47]
    ds_read_b128 a[168:171], v2 offset:1024
    s_add_u32 m0, s66, 65536
    s_add_u32 s7, s65, 282624
    buffer_load_dwordx4 v3, s[68:71], s7 offen lds
    v_mul_f32 v133, v89, v89
    v_mul_f32 v134, v90, v90
    v_mfma_f32_32x32x16_bf16 v[32:47], a[176:179], a[60:63], v[32:47]
    ds_read_b128 a[172:175], v2 offset:2048
    v_mul_f32 v135, v91, v91
    v_fma_f32 v132, v132, v21, v20
    v_fma_f32 v133, v133, v21, v20
    v_fma_f32 v134, v134, v21, v20
    s_waitcnt lgkmcnt(5)
    v_mfma_f32_32x32x16_bf16 v[32:47], a[180:183], a[64:67], v[32:47]
    ds_read_b128 a[176:179], v2 offset:3072
    s_add_u32 m0, s66, 73728
    s_add_u32 s63, s8, 18432
    buffer_load_dwordx4 v2, s[44:47], s63 offen lds
    v_fma_f32 v135, v135, v21, v20
    v_mul_f32 v132, v132, v88
    v_mfma_f32_32x32x16_bf16 v[32:47], a[184:187], a[68:71], v[32:47]
    ds_read_b128 a[180:183], v2 offset:4096
    v_mul_f32 v133, v133, v89
    v_mul_f32 v134, v134, v90
    v_mul_f32 v135, v135, v91
    s_waitcnt lgkmcnt(5)
    v_mfma_f32_32x32x16_bf16 v[32:47], a[188:191], a[72:75], v[32:47]
    ds_read_b128 a[184:187], v2 offset:5120
    s_add_u32 m0, s66, 77824
    s_add_u32 s63, s8, 19456
    buffer_load_dwordx4 v2, s[44:47], s63 offen lds
    v_exp_f32 v132, v132
    v_mfma_f32_32x32x16_bf16 v[32:47], a[160:163], a[76:79], v[32:47]
    ds_read_b128 a[188:191], v2 offset:6144
    v_exp_f32 v133, v133
    v_exp_f32 v134, v134
    s_waitcnt lgkmcnt(5)
    v_mfma_f32_32x32x16_bf16 v[32:47], a[164:167], a[80:83], v[32:47]
    ds_read_b128 a[160:163], v2 offset:7168
    s_add_u32 m0, s66, 81920
    s_add_u32 s63, s8, 30720
    buffer_load_dwordx4 v2, s[44:47], s63 offen lds
    v_exp_f32 v135, v135
    v_mfma_f32_32x32x16_bf16 v[32:47], a[168:171], a[84:87], v[32:47]
    ds_read_b128 a[164:167], v2 offset:8192
    v_mul_f32 v88, v88, v92
    v_mul_f32 v89, v89, v93
    v_mul_f32 v90, v90, v94
    v_mul_f32 v91, v91, v95
    s_waitcnt lgkmcnt(5)
    v_mfma_f32_32x32x16_bf16 v[32:47], a[172:175], a[88:91], v[32:47]
    ds_read_b128 a[168:171], v2 offset:9216
    v_fma_f32 v132, v132, v22, v22
    v_fma_f32 v133, v133, v22, v22
    v_fma_f32 v134, v134, v22, v22
    v_fma_f32 v135, v135, v22, v22
    v_mfma_f32_32x32x16_bf16 v[32:47], a[176:179], a[92:95], v[32:47]
    ds_read_b128 a[172:175], v2 offset:10240
    s_add_u32 m0, s66, 86016
    s_add_u32 s63, s8, 31744
    buffer_load_dwordx4 v2, s[44:47], s63 offen lds
    s_waitcnt lgkmcnt(5)
    v_mfma_f32_32x32x16_bf16 v[32:47], a[180:183], a[96:99], v[32:47]
    ds_read_b128 a[176:179], v2 offset:11264
    v_rcp_f32 v132, v132
    v_rcp_f32 v133, v133
    v_mfma_f32_32x32x16_bf16 v[32:47], a[184:187], a[100:103], v[32:47]
    ds_read_b128 a[180:183], v2 offset:12288
    s_add_u32 m0, s66, 90112
    s_add_u32 s63, s8, 32768
    buffer_load_dwordx4 v2, s[44:47], s63 offen lds
    s_waitcnt lgkmcnt(5)
    v_mfma_f32_32x32x16_bf16 v[32:47], a[188:191], a[104:107], v[32:47]
    ds_read_b128 a[184:187], v2 offset:13312
    v_rcp_f32 v134, v134
    v_rcp_f32 v135, v135
    v_cvt_pk_bf16_f32 v124, v80, v81
    v_mfma_f32_32x32x16_bf16 v[32:47], a[160:163], a[108:111], v[32:47]
    ds_read_b128 a[188:191], v2 offset:14336
    s_add_u32 m0, s66, 94208
    s_add_u32 s63, s8, 33792
    buffer_load_dwordx4 v2, s[44:47], s63 offen lds
    v_cvt_pk_bf16_f32 v125, v82, v83
    s_waitcnt lgkmcnt(5)
    v_mfma_f32_32x32x16_bf16 v[32:47], a[164:167], a[112:115], v[32:47]
    ds_read_b128 a[160:163], v2 offset:15360
    v_mul_f32 v88, v88, v132
    v_mul_f32 v89, v89, v133
    v_mul_f32 v90, v90, v134
    v_mul_f32 v91, v91, v135
    v_cvt_pk_bf16_f32 v126, v88, v89
    v_mfma_f32_32x32x16_bf16 v[32:47], a[168:171], a[116:119], v[32:47]
    ds_read_b128 a[164:167], v2 offset:16384
    v_cvt_pk_bf16_f32 v127, v90, v91
    s_add_u32 s33, s33, 3072
    buffer_store_dwordx4 v[124:127], v2, s[52:55], s33 offen offset:0 sc1
    v_mul_f32 v116, v96, v96
    s_waitcnt lgkmcnt(5)
    v_mfma_f32_32x32x16_bf16 v[32:47], a[172:175], a[120:123], v[32:47]
    ds_read_b128 a[168:171], v2 offset:17408
    v_mul_f32 v117, v97, v97
    v_mul_f32 v118, v98, v98
    v_mul_f32 v119, v99, v99
    v_fma_f32 v116, v116, v21, v20
    v_fma_f32 v117, v117, v21, v20
    v_mfma_f32_32x32x16_bf16 v[32:47], a[176:179], a[124:127], v[32:47]
    ds_read_b128 a[172:175], v2 offset:18432
    v_fma_f32 v118, v118, v21, v20
    v_fma_f32 v119, v119, v21, v20
    v_mul_f32 v116, v116, v96
    v_mul_f32 v117, v117, v97
    s_waitcnt lgkmcnt(5)
    v_mfma_f32_32x32x16_bf16 v[32:47], a[180:183], a[128:131], v[32:47]
    ds_read_b128 a[176:179], v2 offset:19456
    v_mul_f32 v118, v118, v98
    v_mul_f32 v119, v119, v99
    v_exp_f32 v116, v116
    v_mfma_f32_32x32x16_bf16 v[32:47], a[184:187], a[132:135], v[32:47]
    ds_read_b128 a[180:183], v4 offset:62464
    v_exp_f32 v117, v117
    v_exp_f32 v118, v118
    s_waitcnt lgkmcnt(5)
    s_waitcnt vmcnt(12)
    s_barrier
    v_mfma_f32_32x32x16_bf16 v[32:47], a[188:191], a[136:139], v[32:47]
    ds_read_b128 a[184:187], v2 offset:24576
    s_add_u32 m0, s66, 98304
    s_add_u32 s63, s8, 34816
    buffer_load_dwordx4 v2, s[44:47], s63 offen lds
    v_exp_f32 v119, v119
    v_mfma_f32_32x32x16_bf16 v[32:47], a[160:163], a[140:143], v[32:47]
    ds_read_b128 a[188:191], v2 offset:25600
    v_mul_f32 v96, v96, v100
    v_mul_f32 v97, v97, v101
    v_mul_f32 v98, v98, v102
    v_mul_f32 v99, v99, v103
    s_waitcnt lgkmcnt(5)
    v_mfma_f32_32x32x16_bf16 v[32:47], a[164:167], a[144:147], v[32:47]
    ds_read_b128 a[160:163], v2 offset:26624
    s_add_u32 m0, s66, 102400
    s_add_u32 s63, s8, 51200
    buffer_load_dwordx4 v2, s[44:47], s63 offen lds
    v_fma_f32 v116, v116, v22, v22
    v_fma_f32 v117, v117, v22, v22
    v_mfma_f32_32x32x16_bf16 v[32:47], a[168:171], a[148:151], v[32:47]
    ds_read_b128 a[164:167], v2 offset:27648
    v_fma_f32 v118, v118, v22, v22
    v_fma_f32 v119, v119, v22, v22
    v_rcp_f32 v116, v116
    s_waitcnt lgkmcnt(5)
    v_mfma_f32_32x32x16_bf16 v[32:47], a[172:175], a[152:155], v[32:47]
    ds_read_b128 a[168:171], v2 offset:28672
    s_add_u32 m0, s66, 106496
    s_add_u32 s63, s8, 52224
    buffer_load_dwordx4 v2, s[44:47], s63 offen lds
    v_rcp_f32 v117, v117
    v_mfma_f32_32x32x16_bf16 v[32:47], a[176:179], a[156:159], v[32:47]
    ds_read_b128 a[172:175], v2 offset:29696
    v_rcp_f32 v118, v118
    v_rcp_f32 v119, v119
    s_waitcnt lgkmcnt(5)
    v_mfma_f32_32x32x16_bf16 v[32:47], a[180:183], v[16:19], v[32:47]
    ds_read_b128 a[176:179], v2 offset:30720
    s_add_u32 m0, s66, 110592
    s_add_u32 s63, s8, 53248
    buffer_load_dwordx4 v2, s[44:47], s63 offen lds
    v_mul_f32 v96, v96, v116
    v_mul_f32 v97, v97, v117
    v_mfma_f32_32x32x16_bf16 v[48:63], a[184:187], a[0:3], 0
    ds_read_b128 a[180:183], v2 offset:31744
    v_mul_f32 v98, v98, v118
    v_mul_f32 v99, v99, v119
    v_mul_f32 v120, v104, v104
    v_mul_f32 v121, v105, v105
    s_waitcnt lgkmcnt(5)
    v_mfma_f32_32x32x16_bf16 v[48:63], a[188:191], a[4:7], v[48:63]
    ds_read_b128 a[184:187], v2 offset:32768
    s_add_u32 m0, s66, 114688
    s_add_u32 s63, s8, 54272
    buffer_load_dwordx4 v2, s[44:47], s63 offen lds
    v_mul_f32 v122, v106, v106
    v_mul_f32 v123, v107, v107
    v_mfma_f32_32x32x16_bf16 v[48:63], a[160:163], a[8:11], v[48:63]
    ds_read_b128 a[188:191], v2 offset:33792
    v_fma_f32 v120, v120, v21, v20
    v_fma_f32 v121, v121, v21, v20
    v_fma_f32 v122, v122, v21, v20
    v_fma_f32 v123, v123, v21, v20
    s_waitcnt lgkmcnt(5)
    v_mfma_f32_32x32x16_bf16 v[48:63], a[164:167], a[12:15], v[48:63]
    ds_read_b128 a[160:163], v2 offset:34816
    v_mul_f32 v120, v120, v104
    v_mul_f32 v121, v121, v105
    v_mul_f32 v122, v122, v106
    v_mul_f32 v123, v123, v107
    v_mfma_f32_32x32x16_bf16 v[48:63], a[168:171], a[16:19], v[48:63]
    ds_read_b128 a[164:167], v2 offset:35840
    s_add_u32 m0, s66, 118784
    s_add_u32 s63, s8, 55296
    buffer_load_dwordx4 v2, s[44:47], s63 offen lds
    s_waitcnt lgkmcnt(5)
    v_mfma_f32_32x32x16_bf16 v[48:63], a[172:175], a[20:23], v[48:63]
    ds_read_b128 a[168:171], v2 offset:36864
    v_exp_f32 v120, v120
    v_exp_f32 v121, v121
    v_mfma_f32_32x32x16_bf16 v[48:63], a[176:179], a[24:27], v[48:63]
    ds_read_b128 a[172:175], v2 offset:37888
    v_exp_f32 v122, v122
    v_exp_f32 v123, v123
    s_waitcnt lgkmcnt(5)
    v_mfma_f32_32x32x16_bf16 v[48:63], a[180:183], a[28:31], v[48:63]
    ds_read_b128 a[176:179], v2 offset:38912
    v_mul_f32 v104, v104, v108
    v_mul_f32 v105, v105, v109
    v_mul_f32 v106, v106, v110
    v_mul_f32 v107, v107, v111
    v_fma_f32 v120, v120, v22, v22
    v_mfma_f32_32x32x16_bf16 v[48:63], a[184:187], a[32:35], v[48:63]
    ds_read_b128 a[180:183], v2 offset:39936
    v_fma_f32 v121, v121, v22, v22
    v_fma_f32 v122, v122, v22, v22
    v_fma_f32 v123, v123, v22, v22
    s_waitcnt lgkmcnt(5)
    v_mfma_f32_32x32x16_bf16 v[48:63], a[188:191], a[36:39], v[48:63]
    ds_read_b128 a[184:187], v2 offset:40960
    v_rcp_f32 v120, v120
    v_rcp_f32 v121, v121
    v_mfma_f32_32x32x16_bf16 v[48:63], a[160:163], a[40:43], v[48:63]
    ds_read_b128 a[188:191], v2 offset:41984
    v_rcp_f32 v122, v122
    v_rcp_f32 v123, v123
    s_waitcnt lgkmcnt(5)
    v_mfma_f32_32x32x16_bf16 v[48:63], a[164:167], a[44:47], v[48:63]
    ds_read_b128 a[160:163], v2 offset:43008
    v_cvt_pk_bf16_f32 v112, v96, v97
    v_cvt_pk_bf16_f32 v113, v98, v99
    v_mul_f32 v104, v104, v120
    v_mul_f32 v105, v105, v121
    v_mul_f32 v106, v106, v122
    v_mfma_f32_32x32x16_bf16 v[48:63], a[168:171], a[48:51], v[48:63]
    ds_read_b128 a[164:167], v2 offset:44032
    v_mul_f32 v107, v107, v123
    v_cvt_pk_bf16_f32 v114, v104, v105
    v_cvt_pk_bf16_f32 v115, v106, v107
    buffer_store_dwordx4 v[112:115], v2, s[52:55], s33 offen offset:1024 sc1
    s_waitcnt lgkmcnt(5)
    s_waitcnt vmcnt(14)
    s_waitcnt vmcnt(0)
    s_barrier
    s_cmp_eq_u32 s3, 0
    s_cbranch_scc0 km_pe
    v_mov_b32 v25, 1
    s_mov_b64 exec, 1
    buffer_store_dword v25, v24, s[48:51], s6 offen sc1
    s_mov_b64 exec, -1
km_pe:
    v_mfma_f32_32x32x16_bf16 v[48:63], a[172:175], a[52:55], v[48:63]
    ds_read_b128 a[168:171], v2 offset:49152
    s_add_u32 m0, s66, 0
    s_add_u32 s63, s9, 66560
    buffer_load_dwordx4 v2, s[44:47], s63 offen lds
    v_mul_f32 v128, v32, v32
    v_mul_f32 v129, v33, v33
    v_mfma_f32_32x32x16_bf16 v[48:63], a[176:179], a[56:59], v[48:63]
    ds_read_b128 a[172:175], v2 offset:50176
    v_mul_f32 v130, v34, v34
    v_mul_f32 v131, v35, v35
    v_fma_f32 v128, v128, v21, v20
    v_fma_f32 v129, v129, v21, v20
    s_waitcnt lgkmcnt(5)
    v_mfma_f32_32x32x16_bf16 v[48:63], a[180:183], a[60:63], v[48:63]
    ds_read_b128 a[176:179], v2 offset:51200
    s_add_u32 m0, s66, 4096
    s_add_u32 s63, s9, 67584
    buffer_load_dwordx4 v2, s[44:47], s63 offen lds
    v_fma_f32 v130, v130, v21, v20
    v_fma_f32 v131, v131, v21, v20
    v_mfma_f32_32x32x16_bf16 v[48:63], a[184:187], a[64:67], v[48:63]
    ds_read_b128 a[180:183], v2 offset:52224
    v_mul_f32 v128, v128, v32
    v_mul_f32 v129, v129, v33
    v_mul_f32 v130, v130, v34
    v_mul_f32 v131, v131, v35
    s_waitcnt lgkmcnt(5)
    v_mfma_f32_32x32x16_bf16 v[48:63], a[188:191], a[68:71], v[48:63]
    ds_read_b128 a[184:187], v2 offset:53248
    s_add_u32 m0, s66, 8192
    s_add_u32 s63, s9, 68608
    buffer_load_dwordx4 v2, s[44:47], s63 offen lds
    v_exp_f32 v128, v128
    v_mfma_f32_32x32x16_bf16 v[48:63], a[160:163], a[72:75], v[48:63]
    ds_read_b128 a[188:191], v2 offset:54272
    v_exp_f32 v129, v129
    v_exp_f32 v130, v130
    s_waitcnt lgkmcnt(5)
    v_mfma_f32_32x32x16_bf16 v[48:63], a[164:167], a[76:79], v[48:63]
    ds_read_b128 a[160:163], v2 offset:55296
    s_add_u32 m0, s66, 12288
    s_add_u32 s63, s9, 69632
    buffer_load_dwordx4 v2, s[44:47], s63 offen lds
    v_exp_f32 v131, v131
    v_mfma_f32_32x32x16_bf16 v[48:63], a[168:171], a[80:83], v[48:63]
    ds_read_b128 a[164:167], v2 offset:56320
    v_mul_f32 v32, v32, v36
    v_mul_f32 v33, v33, v37
    v_mul_f32 v34, v34, v38
    v_mul_f32 v35, v35, v39
    s_waitcnt lgkmcnt(5)
    v_mfma_f32_32x32x16_bf16 v[48:63], a[172:175], a[84:87], v[48:63]
    ds_read_b128 a[168:171], v2 offset:57344
    s_add_u32 m0, s66, 16384
    s_add_u32 s63, s9, 70656
    buffer_load_dwordx4 v2, s[44:47], s63 offen lds
    v_fma_f32 v128, v128, v22, v22
    v_fma_f32 v129, v129, v22, v22
    v_mfma_f32_32x32x16_bf16 v[48:63], a[176:179], a[88:91], v[48:63]
    ds_read_b128 a[172:175], v2 offset:58368
    v_fma_f32 v130, v130, v22, v22
    v_fma_f32 v131, v131, v22, v22
    v_rcp_f32 v128, v128
    s_waitcnt lgkmcnt(5)
    v_mfma_f32_32x32x16_bf16 v[48:63], a[180:183], a[92:95], v[48:63]
    ds_read_b128 a[176:179], v2 offset:59392
    v_rcp_f32 v129, v129
    v_rcp_f32 v130, v130
    v_mfma_f32_32x32x16_bf16 v[48:63], a[184:187], a[96:99], v[48:63]
    ds_read_b128 a[180:183], v2 offset:60416
    v_rcp_f32 v131, v131
    v_mul_f32 v32, v32, v128
    v_mul_f32 v33, v33, v129
    s_waitcnt lgkmcnt(5)
    v_mfma_f32_32x32x16_bf16 v[48:63], a[188:191], a[100:103], v[48:63]
    ds_read_b128 a[184:187], v2 offset:61440
    v_mul_f32 v34, v34, v130
    v_mul_f32 v35, v35, v131
    v_mul_f32 v132, v40, v40
    v_mul_f32 v133, v41, v41
    v_mul_f32 v134, v42, v42
    v_mfma_f32_32x32x16_bf16 v[48:63], a[160:163], a[104:107], v[48:63]
    ds_read_b128 a[188:191], v2 offset:62464
    v_mul_f32 v135, v43, v43
    v_fma_f32 v132, v132, v21, v20
    v_fma_f32 v133, v133, v21, v20
    v_fma_f32 v134, v134, v21, v20
    s_waitcnt lgkmcnt(5)
    v_mfma_f32_32x32x16_bf16 v[48:63], a[164:167], a[108:111], v[48:63]
    ds_read_b128 a[160:163], v2 offset:63488
    v_fma_f32 v135, v135, v21, v20
    v_mul_f32 v132, v132, v40
    v_mul_f32 v133, v133, v41
    v_mul_f32 v134, v134, v42
    v_mul_f32 v135, v135, v43
    v_mfma_f32_32x32x16_bf16 v[48:63], a[168:171], a[112:115], v[48:63]
    ds_read_b128 a[164:167], v2 offset:64512
    v_exp_f32 v132, v132
    v_exp_f32 v133, v133
    s_waitcnt lgkmcnt(5)
    v_mfma_f32_32x32x16_bf16 v[48:63], a[172:175], a[116:119], v[48:63]
    ds_read_b128 a[168:171], v4 offset:0
    v_exp_f32 v134, v134
    v_exp_f32 v135, v135
    v_mul_f32 v40, v40, v44
    v_mfma_f32_32x32x16_bf16 v[48:63], a[176:179], a[120:123], v[48:63]
    ds_read_b128 a[172:175], v4 offset:1024
    v_mul_f32 v41, v41, v45
    v_mul_f32 v42, v42, v46
    v_mul_f32 v43, v43, v47
    v_fma_f32 v132, v132, v22, v22
    s_waitcnt lgkmcnt(5)
    v_mfma_f32_32x32x16_bf16 v[48:63], a[180:183], a[124:127], v[48:63]
    ds_read_b128 a[176:179], v4 offset:2048
    v_fma_f32 v133, v133, v22, v22
    v_fma_f32 v134, v134, v22, v22
    v_fma_f32 v135, v135, v22, v22
    v_rcp_f32 v132, v132
    v_mfma_f32_32x32x16_bf16 v[48:63], a[184:187], a[128:131], v[48:63]
    ds_read_b128 a[180:183], v4 offset:3072
    v_rcp_f32 v133, v133
    v_rcp_f32 v134, v134
    s_waitcnt lgkmcnt(6)
    v_mfma_f32_32x32x16_bf16 v[48:63], a[188:191], a[132:135], v[48:63]
    ds_read_b128 a[184:187], v4 offset:63488
    v_rcp_f32 v135, v135
    v_cvt_pk_bf16_f32 v124, v32, v33
    v_cvt_pk_bf16_f32 v125, v34, v35
    v_mul_f32 v40, v40, v132
    s_waitcnt lgkmcnt(6)
    v_mfma_f32_32x32x16_bf16 v[48:63], a[160:163], a[136:139], v[48:63]
    v_mul_f32 v41, v41, v133
    v_mul_f32 v42, v42, v134
    v_mul_f32 v43, v43, v135
    v_cvt_pk_bf16_f32 v126, v40, v41
    s_waitcnt lgkmcnt(5)
    v_mfma_f32_32x32x16_bf16 v[48:63], a[164:167], a[140:143], v[48:63]
    v_cvt_pk_bf16_f32 v127, v42, v43
    buffer_store_dwordx4 v[124:127], v2, s[52:55], s33 offen offset:2048 sc1
    s_waitcnt lgkmcnt(4)
    v_mfma_f32_32x32x16_bf16 v[48:63], a[168:171], a[144:147], v[48:63]
    s_waitcnt lgkmcnt(3)
    v_mfma_f32_32x32x16_bf16 v[48:63], a[172:175], a[148:151], v[48:63]
    s_waitcnt lgkmcnt(2)
    v_mfma_f32_32x32x16_bf16 v[48:63], a[176:179], a[152:155], v[48:63]
    s_waitcnt lgkmcnt(1)
    v_mfma_f32_32x32x16_bf16 v[48:63], a[180:183], a[156:159], v[48:63]
    s_waitcnt lgkmcnt(0)
    v_mfma_f32_32x32x16_bf16 v[48:63], a[184:187], v[16:19], v[48:63]
    buffer_load_dword v26, v7, s[48:51], s18 offen sc1
    v_and_b32 v14, 15, v1
    v_lshrrev_b32 v3, 4, v1
    v_lshlrev_b32 v4, 4, v14
    v_lshl_add_u32 v4, v3, 9, v4
    v_add_u32 v5, 110592, v4
    s_nop 5
    v_mul_f32 v116, v48, v48
    v_mul_f32 v117, v49, v49
    v_mul_f32 v118, v50, v50
    v_mul_f32 v119, v51, v51
    v_fma_f32 v116, v116, v21, v20
    v_fma_f32 v117, v117, v21, v20
    v_fma_f32 v118, v118, v21, v20
    v_fma_f32 v119, v119, v21, v20
    v_mul_f32 v116, v116, v48
    v_mul_f32 v117, v117, v49
    v_mul_f32 v118, v118, v50
    v_mul_f32 v119, v119, v51
    v_exp_f32 v116, v116
    v_exp_f32 v117, v117
    v_exp_f32 v118, v118
    v_exp_f32 v119, v119
    v_mul_f32 v48, v48, v52
    v_mul_f32 v49, v49, v53
    v_mul_f32 v50, v50, v54
    v_mul_f32 v51, v51, v55
    v_fma_f32 v116, v116, v22, v22
    v_fma_f32 v117, v117, v22, v22
    v_fma_f32 v118, v118, v22, v22
    v_fma_f32 v119, v119, v22, v22
    v_rcp_f32 v116, v116
    v_rcp_f32 v117, v117
    v_rcp_f32 v118, v118
    v_rcp_f32 v119, v119
    v_mul_f32 v48, v48, v116
    v_mul_f32 v49, v49, v117
    v_mul_f32 v50, v50, v118
    v_mul_f32 v51, v51, v119
    v_mul_f32 v120, v56, v56
    v_mul_f32 v121, v57, v57
    v_mul_f32 v122, v58, v58
    v_mul_f32 v123, v59, v59
    v_fma_f32 v120, v120, v21, v20
    v_fma_f32 v121, v121, v21, v20
    v_fma_f32 v122, v122, v21, v20
    v_fma_f32 v123, v123, v21, v20
    v_mul_f32 v120, v120, v56
    v_mul_f32 v121, v121, v57
    v_mul_f32 v122, v122, v58
    v_mul_f32 v123, v123, v59
    v_exp_f32 v120, v120
    v_exp_f32 v121, v121
    v_exp_f32 v122, v122
    v_exp_f32 v123, v123
    v_mul_f32 v56, v56, v60
    v_mul_f32 v57, v57, v61
    v_mul_f32 v58, v58, v62
    v_mul_f32 v59, v59, v63
    v_fma_f32 v120, v120, v22, v22
    v_fma_f32 v121, v121, v22, v22
    v_fma_f32 v122, v122, v22, v22
    v_fma_f32 v123, v123, v22, v22
    v_rcp_f32 v120, v120
    v_rcp_f32 v121, v121
    v_rcp_f32 v122, v122
    v_rcp_f32 v123, v123
    v_cvt_pk_bf16_f32 v112, v48, v49
    v_cvt_pk_bf16_f32 v113, v50, v51
    v_mul_f32 v56, v56, v120
    v_mul_f32 v57, v57, v121
    v_mul_f32 v58, v58, v122
    v_mul_f32 v59, v59, v123
    v_cvt_pk_bf16_f32 v114, v56, v57
    v_cvt_pk_bf16_f32 v115, v58, v59
    buffer_store_dwordx4 v[112:115], v2, s[52:55], s33 offen offset:3072 sc1
    s_waitcnt vmcnt(1)
    v_cmp_gt_u32 vcc, 1, v26
    s_mov_b32 s7, 0
    s_nop 3
    s_cbranch_vccz km_wb_ok
km_wb:
    s_sleep 1
    buffer_load_dword v26, v7, s[48:51], s18 offen sc1
    s_add_u32 s7, s7, 1
    s_waitcnt vmcnt(0)
    v_cmp_gt_u32 vcc, 1, v26
    s_cmp_lt_u32 s7, 0x40000
    s_nop 3
    s_cbranch_vccz km_wb_ok
    s_cbranch_scc1 km_wb
km_wb_ok:
    s_add_u32 s62, s12, 0
    buffer_load_dwordx4 a[100:103], v4, s[52:55], s62 offen
    buffer_load_dwordx4 a[104:107], v4, s[52:55], s62 offen offset:256
    buffer_load_dwordx4 a[108:111], v5, s[52:55], s62 offen
    buffer_load_dwordx4 a[112:115], v5, s[52:55], s62 offen offset:256
    s_add_u32 s62, s12, 2048
    buffer_load_dwordx4 a[116:119], v4, s[52:55], s62 offen
    buffer_load_dwordx4 a[120:123], v4, s[52:55], s62 offen offset:256
    buffer_load_dwordx4 a[124:127], v5, s[52:55], s62 offen
    buffer_load_dwordx4 a[128:131], v5, s[52:55], s62 offen offset:256
    v_lshrrev_b32 v8, 2, v1
    v_and_b32 v9, 3, v1
    s_lshl_b32 s36, s3, 4
    v_add_u32 v8, s36, v8
    v_and_b32 v10, 31, v8
    v_lshlrev_b32 v10, 4, v10
    v_and_b32 v11, 1, v9
    v_lshl_add_u32 v10, v11, 9, v10
    v_lshrrev_b32 v11, 1, v9
    v_lshl_add_u32 v10, v11, 3, v10
    s_lshr_b32 s37, s3, 1
    s_lshl_b32 s38, s16, 1
    s_add_u32 s37, s37, s38
    s_mul_i32 s37, s37, 40
    s_mul_i32 s38, s17, 5
    s_add_u32 s37, s37, s38
    s_lshl_b32 s37, s37, 10
    s_add_u32 s38, s37, 4096
    v_lshrrev_b32 v11, 2, v1
    v_lshlrev_b32 v12, 2, v9
    v_xor_b32 v11, v11, v12
    v_lshlrev_b32 v11, 4, v11
    v_lshl_add_u32 v11, v9, 8, v11
    s_mul_i32 s39, s3, 5120
    v_add_u32 v11, s39, v11
    v_add_u32 v6, 40960, v11
    v_lshlrev_b32 v12, 6, v3
    v_xor_b32 v12, v12, v2
    s_mul_i32 s39, s3, 20480
    v_add_u32 v12, s39, v12
    v_mul_u32_u24 v13, 1280, v8
    v_lshl_add_u32 v13, v9, 3, v13
    s_mul_i32 s39, s16, 81920
    s_mul_i32 s36, s17, 160
    s_add_u32 s39, s39, s36
    s_mov_b32 s40, s22
    s_mov_b32 s41, s23
    s_mov_b32 s42, 2621440
    s_mov_b32 s43, 0x20000
    v_add_u32 v16, s66, v2
    v_add_u32 v17, 0x10000, v16
    v_add_u32 v18, 0x20000, v16
    ds_read_b128 a[0:3], v18 offset:0
    ds_read_b128 a[4:7], v18 offset:4096
    ds_read_b128 a[8:11], v18 offset:8192
    ds_read_b128 a[12:15], v18 offset:12288
    ds_read_b128 a[16:19], v18 offset:16384
    ds_read_b128 a[20:23], v18 offset:20480
    ds_read_b128 a[24:27], v18 offset:24576
    ds_read_b128 a[28:31], v18 offset:28672
    ds_read_b128 a[32:35], v17 offset:8192
    ds_read_b128 a[36:39], v17 offset:12288
    ds_read_b128 a[40:43], v17 offset:16384
    ds_read_b128 a[44:47], v17 offset:20480
    ds_read_b128 a[48:51], v17 offset:24576
    ds_read_b128 a[52:55], v17 offset:28672
    ds_read_b128 a[56:59], v17 offset:32768
    ds_read_b128 a[60:63], v17 offset:36864
    ds_read_b128 a[64:67], v17 offset:40960
    ds_read_b128 a[68:71], v17 offset:45056
    ds_read_b128 a[72:75], v17 offset:49152
    ds_read_b128 a[76:79], v17 offset:53248
    ds_read_b128 a[80:83], v16 offset:0
    ds_read_b128 a[84:87], v16 offset:4096
    ds_read_b128 a[88:91], v16 offset:8192
    ds_read_b128 a[92:95], v16 offset:12288
    ds_read_b128 a[96:99], v16 offset:16384
    s_waitcnt lgkmcnt(0)
    s_waitcnt vmcnt(8)
    s_barrier
    s_cmp_eq_u32 s3, 0
    s_cbranch_scc0 km_pb
    v_mov_b32 v25, 2
    s_mov_b64 exec, 1
    buffer_store_dword v25, v24, s[48:51], s6 offen sc1
    s_mov_b64 exec, -1
km_pb:
    s_add_u32 s62, s12, 8192
    buffer_load_dwordx4 a[132:135], v4, s[52:55], s62 offen
    buffer_load_dwordx4 a[136:139], v4, s[52:55], s62 offen offset:256
    buffer_load_dwordx4 a[140:143], v5, s[52:55], s62 offen
    buffer_load_dwordx4 a[144:147], v5, s[52:55], s62 offen offset:256
    s_add_u32 s62, s12, 10240
    buffer_load_dwordx4 a[148:151], v4, s[52:55], s62 offen
    buffer_load_dwordx4 a[152:155], v4, s[52:55], s62 offen offset:256
    buffer_load_dwordx4 a[156:159], v5, s[52:55], s62 offen
    buffer_load_dwordx4 a[160:163], v5, s[52:55], s62 offen offset:256
    s_waitcnt vmcnt(15)
    v_mfma_f32_16x16x32_bf16 v[32:35], v[140:143], a[100:103], 0
    v_mfma_f32_16x16x32_bf16 v[36:39], v[144:147], a[100:103], 0
    s_add_u32 s62, s12, 14336
    buffer_load_dwordx4 a[164:167], v4, s[52:55], s62 offen
    v_mfma_f32_16x16x32_bf16 v[40:43], v[148:151], a[100:103], 0
    v_mfma_f32_16x16x32_bf16 v[44:47], v[152:155], a[100:103], 0
    buffer_load_dwordx4 a[168:171], v4, s[52:55], s62 offen offset:256
    v_mfma_f32_16x16x32_bf16 v[48:51], v[156:159], a[100:103], 0
    s_waitcnt vmcnt(16)
    v_mfma_f32_16x16x32_bf16 v[52:55], v[140:143], a[104:107], 0
    buffer_load_dwordx4 a[172:175], v5, s[52:55], s62 offen
    v_mfma_f32_16x16x32_bf16 v[56:59], v[144:147], a[104:107], 0
    v_mfma_f32_16x16x32_bf16 v[60:63], v[148:151], a[104:107], 0
    buffer_load_dwordx4 a[176:179], v5, s[52:55], s62 offen offset:256
    v_mfma_f32_16x16x32_bf16 v[64:67], v[152:155], a[104:107], 0
    v_mfma_f32_16x16x32_bf16 v[68:71], v[156:159], a[104:107], 0
    s_waitcnt vmcnt(17)
    v_mfma_f32_16x16x32_bf16 v[72:75], v[140:143], a[108:111], 0
    v_mfma_f32_16x16x32_bf16 v[76:79], v[144:147], a[108:111], 0
    v_mfma_f32_16x16x32_bf16 v[80:83], v[148:151], a[108:111], 0
    v_mfma_f32_16x16x32_bf16 v[84:87], v[152:155], a[108:111], 0
    v_mfma_f32_16x16x32_bf16 v[88:91], v[156:159], a[108:111], 0
    s_waitcnt vmcnt(16)
    v_mfma_f32_16x16x32_bf16 v[92:95], v[140:143], a[112:115], 0
    v_mfma_f32_16x16x32_bf16 v[96:99], v[144:147], a[112:115], 0
    v_mfma_f32_16x16x32_bf16 v[100:103], v[148:151], a[112:115], 0
    v_mfma_f32_16x16x32_bf16 v[104:107], v[152:155], a[112:115], 0
    v_mfma_f32_16x16x32_bf16 v[108:111], v[156:159], a[112:115], 0
    s_waitcnt vmcnt(15)
    v_mfma_f32_16x16x32_bf16 v[32:35], v[160:163], a[116:119], v[32:35]
    v_mfma_f32_16x16x32_bf16 v[36:39], v[164:167], a[116:119], v[36:39]
    s_add_u32 s62, s12, 16384
    buffer_load_dwordx4 a[100:103], v4, s[52:55], s62 offen
    v_mfma_f32_16x16x32_bf16 v[40:43], v[168:171], a[116:119], v[40:43]
    v_mfma_f32_16x16x32_bf16 v[44:47], v[172:175], a[116:119], v[44:47]
    buffer_load_dwordx4 a[104:107], v4, s[52:55], s62 offen offset:256
    v_mfma_f32_16x16x32_bf16 v[48:51], v[176:179], a[116:119], v[48:51]
    s_waitcnt vmcnt(16)
    v_mfma_f32_16x16x32_bf16 v[52:55], v[160:163], a[120:123], v[52:55]
    buffer_load_dwordx4 a[108:111], v5, s[52:55], s62 offen
    v_mfma_f32_16x16x32_bf16 v[56:59], v[164:167], a[120:123], v[56:59]
    v_mfma_f32_16x16x32_bf16 v[60:63], v[168:171], a[120:123], v[60:63]
    buffer_load_dwordx4 a[112:115], v5, s[52:55], s62 offen offset:256
    v_mfma_f32_16x16x32_bf16 v[64:67], v[172:175], a[120:123], v[64:67]
    v_mfma_f32_16x16x32_bf16 v[68:71], v[176:179], a[120:123], v[68:71]
    s_waitcnt vmcnt(17)
    v_mfma_f32_16x16x32_bf16 v[72:75], v[160:163], a[124:127], v[72:75]
    v_mfma_f32_16x16x32_bf16 v[76:79], v[164:167], a[124:127], v[76:79]
    v_mfma_f32_16x16x32_bf16 v[80:83], v[168:171], a[124:127], v[80:83]
    v_mfma_f32_16x16x32_bf16 v[84:87], v[172:175], a[124:127], v[84:87]
    v_mfma_f32_16x16x32_bf16 v[88:91], v[176:179], a[124:127], v[88:91]
    s_waitcnt vmcnt(16)
    v_mfma_f32_16x16x32_bf16 v[92:95], v[160:163], a[128:131], v[92:95]
    v_mfma_f32_16x16x32_bf16 v[96:99], v[164:167], a[128:131], v[96:99]
    v_mfma_f32_16x16x32_bf16 v[100:103], v[168:171], a[128:131], v[100:103]
    v_mfma_f32_16x16x32_bf16 v[104:107], v[172:175], a[128:131], v[104:107]
    v_mfma_f32_16x16x32_bf16 v[108:111], v[176:179], a[128:131], v[108:111]
    buffer_load_dword v26, v7, s[48:51], s18 offen sc1
    s_waitcnt vmcnt(16)
    v_mfma_f32_16x16x32_bf16 v[32:35], v[180:183], a[132:135], v[32:35]
    v_mfma_f32_16x16x32_bf16 v[36:39], v[184:187], a[132:135], v[36:39]
    s_add_u32 s62, s12, 22528
    buffer_load_dwordx4 a[116:119], v4, s[52:55], s62 offen
    v_mfma_f32_16x16x32_bf16 v[40:43], v[188:191], a[132:135], v[40:43]
    v_mfma_f32_16x16x32_bf16 v[44:47], v[192:195], a[132:135], v[44:47]
    buffer_load_dwordx4 a[120:123], v4, s[52:55], s62 offen offset:256
    v_mfma_f32_16x16x32_bf16 v[48:51], v[196:199], a[132:135], v[48:51]
    s_waitcnt vmcnt(17)
    v_mfma_f32_16x16x32_bf16 v[52:55], v[180:183], a[136:139], v[52:55]
    buffer_load_dwordx4 a[124:127], v5, s[52:55], s62 offen
    v_mfma_f32_16x16x32_bf16 v[56:59], v[184:187], a[136:139], v[56:59]
    v_mfma_f32_16x16x32_bf16 v[60:63], v[188:191], a[136:139], v[60:63]
    buffer_load_dwordx4 a[128:131], v5, s[52:55], s62 offen offset:256
    v_mfma_f32_16x16x32_bf16 v[64:67], v[192:195], a[136:139], v[64:67]
    v_mfma_f32_16x16x32_bf16 v[68:71], v[196:199], a[136:139], v[68:71]
    s_waitcnt vmcnt(18)
    v_mfma_f32_16x16x32_bf16 v[72:75], v[180:183], a[140:143], v[72:75]
    v_mfma_f32_16x16x32_bf16 v[76:79], v[184:187], a[140:143], v[76:79]
    v_mfma_f32_16x16x32_bf16 v[80:83], v[188:191], a[140:143], v[80:83]
    v_mfma_f32_16x16x32_bf16 v[84:87], v[192:195], a[140:143], v[84:87]
    v_mfma_f32_16x16x32_bf16 v[88:91], v[196:199], a[140:143], v[88:91]
    s_waitcnt vmcnt(17)
    v_mfma_f32_16x16x32_bf16 v[92:95], v[180:183], a[144:147], v[92:95]
    v_mfma_f32_16x16x32_bf16 v[96:99], v[184:187], a[144:147], v[96:99]
    v_mfma_f32_16x16x32_bf16 v[100:103], v[188:191], a[144:147], v[100:103]
    v_mfma_f32_16x16x32_bf16 v[104:107], v[192:195], a[144:147], v[104:107]
    v_mfma_f32_16x16x32_bf16 v[108:111], v[196:199], a[144:147], v[108:111]
    s_waitcnt vmcnt(16)
    v_mfma_f32_16x16x32_bf16 v[32:35], v[200:203], a[148:151], v[32:35]
    v_mfma_f32_16x16x32_bf16 v[36:39], v[204:207], a[148:151], v[36:39]
    s_add_u32 s62, s13, 24576
    buffer_load_dwordx4 a[132:135], v4, s[52:55], s62 offen
    v_mfma_f32_16x16x32_bf16 v[40:43], v[208:211], a[148:151], v[40:43]
    v_mfma_f32_16x16x32_bf16 v[44:47], v[212:215], a[148:151], v[44:47]
    buffer_load_dwordx4 a[136:139], v4, s[52:55], s62 offen offset:256
    v_mfma_f32_16x16x32_bf16 v[48:51], v[216:219], a[148:151], v[48:51]
    s_waitcnt vmcnt(17)
    v_mfma_f32_16x16x32_bf16 v[52:55], v[200:203], a[152:155], v[52:55]
    buffer_load_dwordx4 a[140:143], v5, s[52:55], s62 offen
    v_mfma_f32_16x16x32_bf16 v[56:59], v[204:207], a[152:155], v[56:59]
    v_mfma_f32_16x16x32_bf16 v[60:63], v[208:211], a[152:155], v[60:63]
    buffer_load_dwordx4 a[144:147], v5, s[52:55], s62 offen offset:256
    v_mfma_f32_16x16x32_bf16 v[64:67], v[212:215], a[152:155], v[64:67]
    v_mfma_f32_16x16x32_bf16 v[68:71], v[216:219], a[152:155], v[68:71]
    s_waitcnt vmcnt(18)
    v_mfma_f32_16x16x32_bf16 v[72:75], v[200:203], a[156:159], v[72:75]
    v_mfma_f32_16x16x32_bf16 v[76:79], v[204:207], a[156:159], v[76:79]
    v_mfma_f32_16x16x32_bf16 v[80:83], v[208:211], a[156:159], v[80:83]
    v_mfma_f32_16x16x32_bf16 v[84:87], v[212:215], a[156:159], v[84:87]
    v_mfma_f32_16x16x32_bf16 v[88:91], v[216:219], a[156:159], v[88:91]
    s_waitcnt vmcnt(17)
    v_mfma_f32_16x16x32_bf16 v[92:95], v[200:203], a[160:163], v[92:95]
    v_mfma_f32_16x16x32_bf16 v[96:99], v[204:207], a[160:163], v[96:99]
    v_mfma_f32_16x16x32_bf16 v[100:103], v[208:211], a[160:163], v[100:103]
    v_mfma_f32_16x16x32_bf16 v[104:107], v[212:215], a[160:163], v[104:107]
    v_mfma_f32_16x16x32_bf16 v[108:111], v[216:219], a[160:163], v[108:111]
    s_waitcnt vmcnt(8)
    v_cmp_gt_u32 vcc, 2, v26
    s_mov_b32 s7, 0
    s_nop 3
    s_cbranch_vccz km_wc_ok
km_wc:
    s_sleep 1
    buffer_load_dword v26, v7, s[48:51], s18 offen sc1
    s_add_u32 s7, s7, 1
    s_waitcnt vmcnt(0)
    v_cmp_gt_u32 vcc, 2, v26
    s_cmp_lt_u32 s7, 0x40000
    s_nop 3
    s_cbranch_vccz km_wc_ok
    s_cbranch_scc1 km_wc
km_wc_ok:
    v_mfma_f32_16x16x32_bf16 v[32:35], v[220:223], a[164:167], v[32:35]
    v_mfma_f32_16x16x32_bf16 v[36:39], v[224:227], a[164:167], v[36:39]
    s_add_u32 s62, s12, 4096
    buffer_load_dwordx4 a[148:151], v4, s[52:55], s62 offen
    v_mfma_f32_16x16x32_bf16 v[40:43], a[200:203], a[164:167], v[40:43]
    v_mfma_f32_16x16x32_bf16 v[44:47], a[204:207], a[164:167], v[44:47]
    buffer_load_dwordx4 a[152:155], v4, s[52:55], s62 offen offset:256
    v_mfma_f32_16x16x32_bf16 v[48:51], a[208:211], a[164:167], v[48:51]
    v_mfma_f32_16x16x32_bf16 v[52:55], v[220:223], a[168:171], v[52:55]
    buffer_load_dwordx4 a[156:159], v5, s[52:55], s62 offen
    v_mfma_f32_16x16x32_bf16 v[56:59], v[224:227], a[168:171], v[56:59]
    v_mfma_f32_16x16x32_bf16 v[60:63], a[200:203], a[168:171], v[60:63]
    buffer_load_dwordx4 a[160:163], v5, s[52:55], s62 offen offset:256
    v_mfma_f32_16x16x32_bf16 v[64:67], a[204:207], a[168:171], v[64:67]
    v_mfma_f32_16x16x32_bf16 v[68:71], a[208:211], a[168:171], v[68:71]
    v_mfma_f32_16x16x32_bf16 v[72:75], v[220:223], a[172:175], v[72:75]
    v_mfma_f32_16x16x32_bf16 v[76:79], v[224:227], a[172:175], v[76:79]
    v_mfma_f32_16x16x32_bf16 v[80:83], a[200:203], a[172:175], v[80:83]
    v_mfma_f32_16x16x32_bf16 v[84:87], a[204:207], a[172:175], v[84:87]
    v_mfma_f32_16x16x32_bf16 v[88:91], a[208:211], a[172:175], v[88:91]
    v_mfma_f32_16x16x32_bf16 v[92:95], v[220:223], a[176:179], v[92:95]
    v_mfma_f32_16x16x32_bf16 v[96:99], v[224:227], a[176:179], v[96:99]
    v_mfma_f32_16x16x32_bf16 v[100:103], a[200:203], a[176:179], v[100:103]
    v_mfma_f32_16x16x32_bf16 v[104:107], a[204:207], a[176:179], v[104:107]
    v_mfma_f32_16x16x32_bf16 v[108:111], a[208:211], a[176:179], v[108:111]
    v_mfma_f32_16x16x32_bf16 v[32:35], a[212:215], a[100:103], v[32:35]
    v_mfma_f32_16x16x32_bf16 v[36:39], a[216:219], a[100:103], v[36:39]
    s_add_u32 s62, s12, 18432
    buffer_load_dwordx4 a[164:167], v4, s[52:55], s62 offen
    v_mfma_f32_16x16x32_bf16 v[40:43], a[220:223], a[100:103], v[40:43]
    v_mfma_f32_16x16x32_bf16 v[44:47], a[224:227], a[100:103], v[44:47]
    buffer_load_dwordx4 a[168:171], v4, s[52:55], s62 offen offset:256
    v_mfma_f32_16x16x32_bf16 v[48:51], a[228:231], a[100:103], v[48:51]
    v_mfma_f32_16x16x32_bf16 v[52:55], a[212:215], a[104:107], v[52:55]
    buffer_load_dwordx4 a[172:175], v5, s[52:55], s62 offen
    v_mfma_f32_16x16x32_bf16 v[56:59], a[216:219], a[104:107], v[56:59]
    v_mfma_f32_16x16x32_bf16 v[60:63], a[220:223], a[104:107], v[60:63]
    buffer_load_dwordx4 a[176:179], v5, s[52:55], s62 offen offset:256
    v_mfma_f32_16x16x32_bf16 v[64:67], a[224:227], a[104:107], v[64:67]
    v_mfma_f32_16x16x32_bf16 v[68:71], a[228:231], a[104:107], v[68:71]
    v_mfma_f32_16x16x32_bf16 v[72:75], a[212:215], a[108:111], v[72:75]
    v_mfma_f32_16x16x32_bf16 v[76:79], a[216:219], a[108:111], v[76:79]
    v_mfma_f32_16x16x32_bf16 v[80:83], a[220:223], a[108:111], v[80:83]
    v_mfma_f32_16x16x32_bf16 v[84:87], a[224:227], a[108:111], v[84:87]
    v_mfma_f32_16x16x32_bf16 v[88:91], a[228:231], a[108:111], v[88:91]
    v_mfma_f32_16x16x32_bf16 v[92:95], a[212:215], a[112:115], v[92:95]
    v_mfma_f32_16x16x32_bf16 v[96:99], a[216:219], a[112:115], v[96:99]
    v_mfma_f32_16x16x32_bf16 v[100:103], a[220:223], a[112:115], v[100:103]
    v_mfma_f32_16x16x32_bf16 v[104:107], a[224:227], a[112:115], v[104:107]
    v_mfma_f32_16x16x32_bf16 v[108:111], a[228:231], a[112:115], v[108:111]
    s_waitcnt vmcnt(15)
    v_mfma_f32_16x16x32_bf16 v[32:35], a[232:235], a[116:119], v[32:35]
    v_mfma_f32_16x16x32_bf16 v[36:39], a[236:239], a[116:119], v[36:39]
    s_add_u32 s62, s12, 6144
    buffer_load_dwordx4 a[100:103], v4, s[52:55], s62 offen
    v_mfma_f32_16x16x32_bf16 v[40:43], a[240:243], a[116:119], v[40:43]
    v_mfma_f32_16x16x32_bf16 v[44:47], a[244:247], a[116:119], v[44:47]
    buffer_load_dwordx4 a[104:107], v4, s[52:55], s62 offen offset:256
    v_mfma_f32_16x16x32_bf16 v[48:51], v[228:231], a[116:119], v[48:51]
    s_waitcnt vmcnt(16)
    v_mfma_f32_16x16x32_bf16 v[52:55], a[232:235], a[120:123], v[52:55]
    buffer_load_dwordx4 a[108:111], v5, s[52:55], s62 offen
    v_mfma_f32_16x16x32_bf16 v[56:59], a[236:239], a[120:123], v[56:59]
    v_mfma_f32_16x16x32_bf16 v[60:63], a[240:243], a[120:123], v[60:63]
    buffer_load_dwordx4 a[112:115], v5, s[52:55], s62 offen offset:256
    v_mfma_f32_16x16x32_bf16 v[64:67], a[244:247], a[120:123], v[64:67]
    v_mfma_f32_16x16x32_bf16 v[68:71], v[228:231], a[120:123], v[68:71]
    s_waitcnt vmcnt(17)
    v_mfma_f32_16x16x32_bf16 v[72:75], a[232:235], a[124:127], v[72:75]
    v_mfma_f32_16x16x32_bf16 v[76:79], a[236:239], a[124:127], v[76:79]
    v_mfma_f32_16x16x32_bf16 v[80:83], a[240:243], a[124:127], v[80:83]
    v_mfma_f32_16x16x32_bf16 v[84:87], a[244:247], a[124:127], v[84:87]
    v_mfma_f32_16x16x32_bf16 v[88:91], v[228:231], a[124:127], v[88:91]
    s_waitcnt vmcnt(16)
    v_mfma_f32_16x16x32_bf16 v[92:95], a[232:235], a[128:131], v[92:95]
    v_mfma_f32_16x16x32_bf16 v[96:99], a[236:239], a[128:131], v[96:99]
    v_mfma_f32_16x16x32_bf16 v[100:103], a[240:243], a[128:131], v[100:103]
    v_mfma_f32_16x16x32_bf16 v[104:107], a[244:247], a[128:131], v[104:107]
    v_mfma_f32_16x16x32_bf16 v[108:111], v[228:231], a[128:131], v[108:111]
    s_waitcnt vmcnt(15)
    v_mfma_f32_16x16x32_bf16 v[32:35], v[232:235], a[132:135], v[32:35]
    v_mfma_f32_16x16x32_bf16 v[36:39], v[236:239], a[132:135], v[36:39]
    s_add_u32 s62, s12, 12288
    buffer_load_dwordx4 a[116:119], v4, s[52:55], s62 offen
    v_mfma_f32_16x16x32_bf16 v[40:43], v[240:243], a[132:135], v[40:43]
    v_mfma_f32_16x16x32_bf16 v[44:47], v[244:247], a[132:135], v[44:47]
    buffer_load_dwordx4 a[120:123], v4, s[52:55], s62 offen offset:256
    v_mfma_f32_16x16x32_bf16 v[48:51], v[248:251], a[132:135], v[48:51]
    s_waitcnt vmcnt(16)
    v_mfma_f32_16x16x32_bf16 v[52:55], v[232:235], a[136:139], v[52:55]
    buffer_load_dwordx4 a[124:127], v5, s[52:55], s62 offen
    v_mfma_f32_16x16x32_bf16 v[56:59], v[236:239], a[136:139], v[56:59]
    v_mfma_f32_16x16x32_bf16 v[60:63], v[240:243], a[136:139], v[60:63]
    buffer_load_dwordx4 a[128:131], v5, s[52:55], s62 offen offset:256
    v_mfma_f32_16x16x32_bf16 v[64:67], v[244:247], a[136:139], v[64:67]
    v_mfma_f32_16x16x32_bf16 v[68:71], v[248:251], a[136:139], v[68:71]
    s_waitcnt vmcnt(17)
    v_mfma_f32_16x16x32_bf16 v[72:75], v[232:235], a[140:143], v[72:75]
    v_mfma_f32_16x16x32_bf16 v[76:79], v[236:239], a[140:143], v[76:79]
    v_mfma_f32_16x16x32_bf16 v[80:83], v[240:243], a[140:143], v[80:83]
    v_mfma_f32_16x16x32_bf16 v[84:87], v[244:247], a[140:143], v[84:87]
    v_mfma_f32_16x16x32_bf16 v[88:91], v[248:251], a[140:143], v[88:91]
    s_waitcnt vmcnt(16)
    v_mfma_f32_16x16x32_bf16 v[92:95], v[232:235], a[144:147], v[92:95]
    v_mfma_f32_16x16x32_bf16 v[96:99], v[236:239], a[144:147], v[96:99]
    v_mfma_f32_16x16x32_bf16 v[100:103], v[240:243], a[144:147], v[100:103]
    v_mfma_f32_16x16x32_bf16 v[104:107], v[244:247], a[144:147], v[104:107]
    v_mfma_f32_16x16x32_bf16 v[108:111], v[248:251], a[144:147], v[108:111]
    s_waitcnt vmcnt(15)
    v_mfma_f32_16x16x32_bf16 v[32:35], v[252:255], a[148:151], v[32:35]
    v_mfma_f32_16x16x32_bf16 v[36:39], a[192:195], a[148:151], v[36:39]
    s_add_u32 s62, s12, 20480
    buffer_load_dwordx4 a[132:135], v4, s[52:55], s62 offen
    v_mfma_f32_16x16x32_bf16 v[40:43], a[196:199], a[148:151], v[40:43]
    v_mfma_f32_16x16x32_bf16 v[44:47], a[248:251], a[148:151], v[44:47]
    buffer_load_dwordx4 a[136:139], v4, s[52:55], s62 offen offset:256
    v_mfma_f32_16x16x32_bf16 v[48:51], a[252:255], a[148:151], v[48:51]
    s_waitcnt vmcnt(16)
    v_mfma_f32_16x16x32_bf16 v[52:55], v[252:255], a[152:155], v[52:55]
    buffer_load_dwordx4 a[140:143], v5, s[52:55], s62 offen
    v_mfma_f32_16x16x32_bf16 v[56:59], a[192:195], a[152:155], v[56:59]
    v_mfma_f32_16x16x32_bf16 v[60:63], a[196:199], a[152:155], v[60:63]
    buffer_load_dwordx4 a[144:147], v5, s[52:55], s62 offen offset:256
    v_mfma_f32_16x16x32_bf16 v[64:67], a[248:251], a[152:155], v[64:67]
    v_mfma_f32_16x16x32_bf16 v[68:71], a[252:255], a[152:155], v[68:71]
    s_waitcnt vmcnt(17)
    v_mfma_f32_16x16x32_bf16 v[72:75], v[252:255], a[156:159], v[72:75]
    v_mfma_f32_16x16x32_bf16 v[76:79], a[192:195], a[156:159], v[76:79]
    v_mfma_f32_16x16x32_bf16 v[80:83], a[196:199], a[156:159], v[80:83]
    v_mfma_f32_16x16x32_bf16 v[84:87], a[248:251], a[156:159], v[84:87]
    v_mfma_f32_16x16x32_bf16 v[88:91], a[252:255], a[156:159], v[88:91]
    s_waitcnt vmcnt(16)
    v_mfma_f32_16x16x32_bf16 v[92:95], v[252:255], a[160:163], v[92:95]
    v_mfma_f32_16x16x32_bf16 v[96:99], a[192:195], a[160:163], v[96:99]
    v_mfma_f32_16x16x32_bf16 v[100:103], a[196:199], a[160:163], v[100:103]
    v_mfma_f32_16x16x32_bf16 v[104:107], a[248:251], a[160:163], v[104:107]
    v_mfma_f32_16x16x32_bf16 v[108:111], a[252:255], a[160:163], v[108:111]
    s_waitcnt vmcnt(15)
    v_mfma_f32_16x16x32_bf16 v[32:35], a[0:3], a[164:167], v[32:35]
    v_mfma_f32_16x16x32_bf16 v[36:39], a[4:7], a[164:167], v[36:39]
    s_add_u32 s62, s13, 26624
    buffer_load_dwordx4 a[148:151], v4, s[52:55], s62 offen
    v_mfma_f32_16x16x32_bf16 v[40:43], a[8:11], a[164:167], v[40:43]
    v_mfma_f32_16x16x32_bf16 v[44:47], a[12:15], a[164:167], v[44:47]
    buffer_load_dwordx4 a[152:155], v4, s[52:55], s62 offen offset:256
    v_mfma_f32_16x16x32_bf16 v[48:51], a[16:19], a[164:167], v[48:51]
    s_waitcnt vmcnt(16)
    v_mfma_f32_16x16x32_bf16 v[52:55], a[0:3], a[168:171], v[52:55]
    buffer_load_dwordx4 a[156:159], v5, s[52:55], s62 offen
    v_mfma_f32_16x16x32_bf16 v[56:59], a[4:7], a[168:171], v[56:59]
    v_mfma_f32_16x16x32_bf16 v[60:63], a[8:11], a[168:171], v[60:63]
    buffer_load_dwordx4 a[160:163], v5, s[52:55], s62 offen offset:256
    v_mfma_f32_16x16x32_bf16 v[64:67], a[12:15], a[168:171], v[64:67]
    v_mfma_f32_16x16x32_bf16 v[68:71], a[16:19], a[168:171], v[68:71]
    buffer_load_dwordx2 v[114:115], v10, s[56:59], s37 offen offset:0
    s_waitcnt vmcnt(18)
    v_mfma_f32_16x16x32_bf16 v[72:75], a[0:3], a[172:175], v[72:75]
    v_mfma_f32_16x16x32_bf16 v[76:79], a[4:7], a[172:175], v[76:79]
    buffer_load_dwordx2 v[118:119], v10, s[56:59], s37 offen offset:1024
    v_mfma_f32_16x16x32_bf16 v[80:83], a[8:11], a[172:175], v[80:83]
    v_mfma_f32_16x16x32_bf16 v[84:87], a[12:15], a[172:175], v[84:87]
    buffer_load_dwordx2 v[122:123], v10, s[56:59], s37 offen offset:2048
    v_mfma_f32_16x16x32_bf16 v[88:91], a[16:19], a[172:175], v[88:91]
    s_waitcnt vmcnt(19)
    v_mfma_f32_16x16x32_bf16 v[92:95], a[0:3], a[176:179], v[92:95]
    buffer_load_dwordx2 v[126:127], v10, s[56:59], s37 offen offset:3072
    v_mfma_f32_16x16x32_bf16 v[96:99], a[4:7], a[176:179], v[96:99]
    v_mfma_f32_16x16x32_bf16 v[100:103], a[8:11], a[176:179], v[100:103]
    buffer_load_dwordx2 v[130:131], v10, s[56:59], s38 offen offset:0
    v_mfma_f32_16x16x32_bf16 v[104:107], a[12:15], a[176:179], v[104:107]
    v_mfma_f32_16x16x32_bf16 v[108:111], a[16:19], a[176:179], v[108:111]
    s_waitcnt vmcnt(20)
    v_mfma_f32_16x16x32_bf16 v[32:35], a[20:23], a[100:103], v[32:35]
    v_mfma_f32_16x16x32_bf16 v[36:39], a[24:27], a[100:103], v[36:39]
    v_mfma_f32_16x16x32_bf16 v[40:43], a[28:31], a[100:103], v[40:43]
    v_mfma_f32_16x16x32_bf16 v[44:47], a[32:35], a[100:103], v[44:47]
    v_mfma_f32_16x16x32_bf16 v[48:51], a[36:39], a[100:103], v[48:51]
    s_waitcnt vmcnt(19)
    v_mfma_f32_16x16x32_bf16 v[52:55], a[20:23], a[104:107], v[52:55]
    v_mfma_f32_16x16x32_bf16 v[56:59], a[24:27], a[104:107], v[56:59]
    v_mfma_f32_16x16x32_bf16 v[60:63], a[28:31], a[104:107], v[60:63]
    v_mfma_f32_16x16x32_bf16 v[64:67], a[32:35], a[104:107], v[64:67]
    v_mfma_f32_16x16x32_bf16 v[68:71], a[36:39], a[104:107], v[68:71]
    s_waitcnt vmcnt(18)
    v_mfma_f32_16x16x32_bf16 v[72:75], a[20:23], a[108:111], v[72:75]
    v_mfma_f32_16x16x32_bf16 v[76:79], a[24:27], a[108:111], v[76:79]
    v_mfma_f32_16x16x32_bf16 v[80:83], a[28:31], a[108:111], v[80:83]
    v_mfma_f32_16x16x32_bf16 v[84:87], a[32:35], a[108:111], v[84:87]
    v_mfma_f32_16x16x32_bf16 v[88:91], a[36:39], a[108:111], v[88:91]
    s_waitcnt vmcnt(17)
    v_mfma_f32_16x16x32_bf16 v[92:95], a[20:23], a[112:115], v[92:95]
    v_mfma_f32_16x16x32_bf16 v[96:99], a[24:27], a[112:115], v[96:99]
    v_mfma_f32_16x16x32_bf16 v[100:103], a[28:31], a[112:115], v[100:103]
    v_mfma_f32_16x16x32_bf16 v[104:107], a[32:35], a[112:115], v[104:107]
    v_mfma_f32_16x16x32_bf16 v[108:111], a[36:39], a[112:115], v[108:111]
    s_waitcnt vmcnt(16)
    v_mfma_f32_16x16x32_bf16 v[32:35], a[40:43], a[116:119], v[32:35]
    v_mfma_f32_16x16x32_bf16 v[36:39], a[44:47], a[116:119], v[36:39]
    v_mfma_f32_16x16x32_bf16 v[40:43], a[48:51], a[116:119], v[40:43]
    v_mfma_f32_16x16x32_bf16 v[44:47], a[52:55], a[116:119], v[44:47]
    v_mfma_f32_16x16x32_bf16 v[48:51], a[56:59], a[116:119], v[48:51]
    s_waitcnt vmcnt(15)
    v_mfma_f32_16x16x32_bf16 v[52:55], a[40:43], a[120:123], v[52:55]
    v_mfma_f32_16x16x32_bf16 v[56:59], a[44:47], a[120:123], v[56:59]
    v_mfma_f32_16x16x32_bf16 v[60:63], a[48:51], a[120:123], v[60:63]
    v_mfma_f32_16x16x32_bf16 v[64:67], a[52:55], a[120:123], v[64:67]
    v_mfma_f32_16x16x32_bf16 v[68:71], a[56:59], a[120:123], v[68:71]
    s_waitcnt vmcnt(14)
    v_mfma_f32_16x16x32_bf16 v[72:75], a[40:43], a[124:127], v[72:75]
    v_mfma_f32_16x16x32_bf16 v[76:79], a[44:47], a[124:127], v[76:79]
    v_mfma_f32_16x16x32_bf16 v[80:83], a[48:51], a[124:127], v[80:83]
    v_mfma_f32_16x16x32_bf16 v[84:87], a[52:55], a[124:127], v[84:87]
    v_mfma_f32_16x16x32_bf16 v[88:91], a[56:59], a[124:127], v[88:91]
    s_waitcnt vmcnt(13)
    v_mfma_f32_16x16x32_bf16 v[92:95], a[40:43], a[128:131], v[92:95]
    v_mfma_f32_16x16x32_bf16 v[96:99], a[44:47], a[128:131], v[96:99]
    v_mfma_f32_16x16x32_bf16 v[100:103], a[48:51], a[128:131], v[100:103]
    v_mfma_f32_16x16x32_bf16 v[104:107], a[52:55], a[128:131], v[104:107]
    v_mfma_f32_16x16x32_bf16 v[108:111], a[56:59], a[128:131], v[108:111]
    s_waitcnt vmcnt(12)
    v_mfma_f32_16x16x32_bf16 v[32:35], a[60:63], a[132:135], v[32:35]
    v_mfma_f32_16x16x32_bf16 v[36:39], a[64:67], a[132:135], v[36:39]
    s_waitcnt vmcnt(4)
    v_lshlrev_b32 v112, 16, v114
    v_and_b32 v113, 0xffff0000, v114
    v_mfma_f32_16x16x32_bf16 v[40:43], a[68:71], a[132:135], v[40:43]
    v_mfma_f32_16x16x32_bf16 v[44:47], a[72:75], a[132:135], v[44:47]
    v_lshlrev_b32 v114, 16, v115
    v_and_b32 v115, 0xffff0000, v115
    v_mfma_f32_16x16x32_bf16 v[48:51], a[76:79], a[132:135], v[48:51]
    v_mfma_f32_16x16x32_bf16 v[52:55], a[60:63], a[136:139], v[52:55]
    s_waitcnt vmcnt(3)
    v_lshlrev_b32 v116, 16, v118
    v_and_b32 v117, 0xffff0000, v118
    v_mfma_f32_16x16x32_bf16 v[56:59], a[64:67], a[136:139], v[56:59]
    v_mfma_f32_16x16x32_bf16 v[60:63], a[68:71], a[136:139], v[60:63]
    v_lshlrev_b32 v118, 16, v119
    v_and_b32 v119, 0xffff0000, v119
    v_mfma_f32_16x16x32_bf16 v[64:67], a[72:75], a[136:139], v[64:67]
    v_mfma_f32_16x16x32_bf16 v[68:71], a[76:79], a[136:139], v[68:71]
    s_waitcnt vmcnt(2)
    v_lshlrev_b32 v120, 16, v122
    v_and_b32 v121, 0xffff0000, v122
    v_mfma_f32_16x16x32_bf16 v[72:75], a[60:63], a[140:143], v[72:75]
    v_mfma_f32_16x16x32_bf16 v[76:79], a[64:67], a[140:143], v[76:79]
    v_lshlrev_b32 v122, 16, v123
    v_and_b32 v123, 0xffff0000, v123
    v_mfma_f32_16x16x32_bf16 v[80:83], a[68:71], a[140:143], v[80:83]
    v_mfma_f32_16x16x32_bf16 v[84:87], a[72:75], a[140:143], v[84:87]
    s_waitcnt vmcnt(1)
    v_lshlrev_b32 v124, 16, v126
    v_and_b32 v125, 0xffff0000, v126
    v_mfma_f32_16x16x32_bf16 v[88:91], a[76:79], a[140:143], v[88:91]
    v_mfma_f32_16x16x32_bf16 v[92:95], a[60:63], a[144:147], v[92:95]
    v_lshlrev_b32 v126, 16, v127
    v_and_b32 v127, 0xffff0000, v127
    v_mfma_f32_16x16x32_bf16 v[96:99], a[64:67], a[144:147], v[96:99]
    v_mfma_f32_16x16x32_bf16 v[100:103], a[68:71], a[144:147], v[100:103]
    s_waitcnt vmcnt(0)
    v_lshlrev_b32 v128, 16, v130
    v_and_b32 v129, 0xffff0000, v130
    v_mfma_f32_16x16x32_bf16 v[104:107], a[72:75], a[144:147], v[104:107]
    v_mfma_f32_16x16x32_bf16 v[108:111], a[76:79], a[144:147], v[108:111]
    v_lshlrev_b32 v130, 16, v131
    v_and_b32 v131, 0xffff0000, v131
    v_mfma_f32_16x16x32_bf16 v[32:35], a[80:83], a[148:151], v[32:35]
    v_mfma_f32_16x16x32_bf16 v[36:39], a[84:87], a[148:151], v[36:39]
    v_mfma_f32_16x16x32_bf16 v[40:43], a[88:91], a[148:151], v[40:43]
    v_mfma_f32_16x16x32_bf16 v[44:47], a[92:95], a[148:151], v[44:47]
    v_mfma_f32_16x16x32_bf16 v[48:51], a[96:99], a[148:151], v[48:51]
    v_mfma_f32_16x16x32_bf16 v[52:55], a[80:83], a[152:155], v[52:55]
    v_mfma_f32_16x16x32_bf16 v[56:59], a[84:87], a[152:155], v[56:59]
    s_nop 1
    ds_write_b128 v12, v[32:35] offset:0
    v_mfma_f32_16x16x32_bf16 v[60:63], a[88:91], a[152:155], v[60:63]
    ds_write_b128 v12, v[36:39] offset:1024
    v_mfma_f32_16x16x32_bf16 v[64:67], a[92:95], a[152:155], v[64:67]
    ds_write_b128 v12, v[40:43] offset:2048
    v_mfma_f32_16x16x32_bf16 v[68:71], a[96:99], a[152:155], v[68:71]
    ds_write_b128 v12, v[44:47] offset:3072
    v_mfma_f32_16x16x32_bf16 v[72:75], a[80:83], a[156:159], v[72:75]
    ds_write_b128 v12, v[48:51] offset:4096
    v_mfma_f32_16x16x32_bf16 v[76:79], a[84:87], a[156:159], v[76:79]
    ds_write_b128 v12, v[52:55] offset:5120
    v_mfma_f32_16x16x32_bf16 v[80:83], a[88:91], a[156:159], v[80:83]
    ds_write_b128 v12, v[56:59] offset:6144
    v_mfma_f32_16x16x32_bf16 v[84:87], a[92:95], a[156:159], v[84:87]
    ds_write_b128 v12, v[60:63] offset:7168
    v_mfma_f32_16x16x32_bf16 v[88:91], a[96:99], a[156:159], v[88:91]
    ds_write_b128 v12, v[64:67] offset:8192
    v_mfma_f32_16x16x32_bf16 v[92:95], a[80:83], a[160:163], v[92:95]
    ds_write_b128 v12, v[68:71] offset:9216
    v_mfma_f32_16x16x32_bf16 v[96:99], a[84:87], a[160:163], v[96:99]
    ds_write_b128 v12, v[72:75] offset:10240
    v_mfma_f32_16x16x32_bf16 v[100:103], a[88:91], a[160:163], v[100:103]
    ds_write_b128 v12, v[76:79] offset:11264
    v_mfma_f32_16x16x32_bf16 v[104:107], a[92:95], a[160:163], v[104:107]
    ds_write_b128 v12, v[80:83] offset:12288
    v_mfma_f32_16x16x32_bf16 v[108:111], a[96:99], a[160:163], v[108:111]
    ds_write_b128 v12, v[84:87] offset:13312
    ds_write_b128 v12, v[88:91] offset:14336
    ds_write_b128 v12, v[92:95] offset:15360
    ds_write_b128 v12, v[96:99] offset:16384
    ds_write_b128 v12, v[100:103] offset:17408
    s_nop 0
    ds_write_b128 v12, v[104:107] offset:18432
    s_nop 0
    ds_write_b128 v12, v[108:111] offset:19456
    s_waitcnt lgkmcnt(0)
    s_barrier
    ds_read_b128 v[32:35], v11 offset:0
    ds_read_b128 v[36:39], v11 offset:20480
    ds_read_b128 v[40:43], v6 offset:0
    ds_read_b128 v[44:47], v6 offset:20480
    ds_read_b128 v[48:51], v11 offset:1024
    ds_read_b128 v[52:55], v11 offset:21504
    ds_read_b128 v[56:59], v6 offset:1024
    ds_read_b128 v[60:63], v6 offset:21504
    ds_read_b128 v[64:67], v11 offset:2048
    ds_read_b128 v[68:71], v11 offset:22528
    ds_read_b128 v[72:75], v6 offset:2048
    ds_read_b128 v[76:79], v6 offset:22528
    ds_read_b128 v[80:83], v11 offset:3072
    ds_read_b128 v[84:87], v11 offset:23552
    ds_read_b128 v[88:91], v6 offset:3072
    ds_read_b128 v[92:95], v6 offset:23552
    ds_read_b128 v[96:99], v11 offset:4096
    ds_read_b128 v[100:103], v11 offset:24576
    ds_read_b128 v[104:107], v6 offset:4096
    ds_read_b128 v[108:111], v6 offset:24576
    s_waitcnt lgkmcnt(15)
    v_pk_add_f32 v[32:33], v[32:33], v[36:37]
    v_pk_add_f32 v[34:35], v[34:35], v[38:39]
    v_pk_add_f32 v[40:41], v[40:41], v[44:45]
    v_pk_add_f32 v[42:43], v[42:43], v[46:47]
    v_pk_add_f32 v[32:33], v[32:33], v[40:41]
    v_pk_add_f32 v[34:35], v[34:35], v[42:43]
    v_cvt_pk_bf16_f32 v36, v32, v33
    v_cvt_pk_bf16_f32 v37, v34, v35
    v_lshlrev_b32 v32, 16, v36
    v_and_b32 v33, 0xffff0000, v36
    v_lshlrev_b32 v34, 16, v37
    v_and_b32 v35, 0xffff0000, v37
    v_pk_add_f32 v[32:33], v[32:33], v[112:113]
    v_pk_add_f32 v[34:35], v[34:35], v[114:115]
    v_cvt_pk_bf16_f32 v36, v32, v33
    v_cvt_pk_bf16_f32 v37, v34, v35
    buffer_store_dwordx2 v[36:37], v13, s[40:43], s39 offen offset:0
    s_waitcnt lgkmcnt(14)
    v_pk_add_f32 v[48:49], v[48:49], v[52:53]
    v_pk_add_f32 v[50:51], v[50:51], v[54:55]
    s_waitcnt lgkmcnt(12)
    v_pk_add_f32 v[56:57], v[56:57], v[60:61]
    v_pk_add_f32 v[58:59], v[58:59], v[62:63]
    v_pk_add_f32 v[48:49], v[48:49], v[56:57]
    v_pk_add_f32 v[50:51], v[50:51], v[58:59]
    v_cvt_pk_bf16_f32 v52, v48, v49
    v_cvt_pk_bf16_f32 v53, v50, v51
    v_lshlrev_b32 v48, 16, v52
    v_and_b32 v49, 0xffff0000, v52
    v_lshlrev_b32 v50, 16, v53
    v_and_b32 v51, 0xffff0000, v53
    v_pk_add_f32 v[48:49], v[48:49], v[116:117]
    v_pk_add_f32 v[50:51], v[50:51], v[118:119]
    v_cvt_pk_bf16_f32 v52, v48, v49
    v_cvt_pk_bf16_f32 v53, v50, v51
    buffer_store_dwordx2 v[52:53], v13, s[40:43], s39 offen offset:32
    s_waitcnt lgkmcnt(10)
    v_pk_add_f32 v[64:65], v[64:65], v[68:69]
    v_pk_add_f32 v[66:67], v[66:67], v[70:71]
    s_waitcnt lgkmcnt(8)
    v_pk_add_f32 v[72:73], v[72:73], v[76:77]
    v_pk_add_f32 v[74:75], v[74:75], v[78:79]
    v_pk_add_f32 v[64:65], v[64:65], v[72:73]
    v_pk_add_f32 v[66:67], v[66:67], v[74:75]
    v_cvt_pk_bf16_f32 v68, v64, v65
    v_cvt_pk_bf16_f32 v69, v66, v67
    v_lshlrev_b32 v64, 16, v68
    v_and_b32 v65, 0xffff0000, v68
    v_lshlrev_b32 v66, 16, v69
    v_and_b32 v67, 0xffff0000, v69
    v_pk_add_f32 v[64:65], v[64:65], v[120:121]
    v_pk_add_f32 v[66:67], v[66:67], v[122:123]
    v_cvt_pk_bf16_f32 v68, v64, v65
    v_cvt_pk_bf16_f32 v69, v66, v67
    buffer_store_dwordx2 v[68:69], v13, s[40:43], s39 offen offset:64
    s_waitcnt lgkmcnt(6)
    v_pk_add_f32 v[80:81], v[80:81], v[84:85]
    v_pk_add_f32 v[82:83], v[82:83], v[86:87]
    s_waitcnt lgkmcnt(4)
    v_pk_add_f32 v[88:89], v[88:89], v[92:93]
    v_pk_add_f32 v[90:91], v[90:91], v[94:95]
    v_pk_add_f32 v[80:81], v[80:81], v[88:89]
    v_pk_add_f32 v[82:83], v[82:83], v[90:91]
    v_cvt_pk_bf16_f32 v84, v80, v81
    v_cvt_pk_bf16_f32 v85, v82, v83
    v_lshlrev_b32 v80, 16, v84
    v_and_b32 v81, 0xffff0000, v84
    v_lshlrev_b32 v82, 16, v85
    v_and_b32 v83, 0xffff0000, v85
    v_pk_add_f32 v[80:81], v[80:81], v[124:125]
    v_pk_add_f32 v[82:83], v[82:83], v[126:127]
    v_cvt_pk_bf16_f32 v84, v80, v81
    v_cvt_pk_bf16_f32 v85, v82, v83
    buffer_store_dwordx2 v[84:85], v13, s[40:43], s39 offen offset:96
    s_waitcnt lgkmcnt(2)
    v_pk_add_f32 v[96:97], v[96:97], v[100:101]
    v_pk_add_f32 v[98:99], v[98:99], v[102:103]
    s_waitcnt lgkmcnt(0)
    v_pk_add_f32 v[104:105], v[104:105], v[108:109]
    v_pk_add_f32 v[106:107], v[106:107], v[110:111]
    v_pk_add_f32 v[96:97], v[96:97], v[104:105]
    v_pk_add_f32 v[98:99], v[98:99], v[106:107]
    v_cvt_pk_bf16_f32 v100, v96, v97
    v_cvt_pk_bf16_f32 v101, v98, v99
    v_lshlrev_b32 v96, 16, v100
    v_and_b32 v97, 0xffff0000, v100
    v_lshlrev_b32 v98, 16, v101
    v_and_b32 v99, 0xffff0000, v101
    v_pk_add_f32 v[96:97], v[96:97], v[128:129]
    v_pk_add_f32 v[98:99], v[98:99], v[130:131]
    v_cvt_pk_bf16_f32 v100, v96, v97
    v_cvt_pk_bf16_f32 v101, v98, v99
    buffer_store_dwordx2 v[100:101], v13, s[40:43], s39 offen offset:128
km_end:
    s_endpgm
text_end:
    s_endpgm
.section .rodata,"a"
.p2align 6
.amdhsa_kernel sequential_preLN__linear_attn_block__geglu_ffn__prompt_kernel
  .amdhsa_next_free_vgpr 512
  .amdhsa_next_free_sgpr 76
  .amdhsa_accum_offset 256
  .amdhsa_group_segment_fixed_size 0
  .amdhsa_kernarg_size 80
  .amdhsa_user_sgpr_count 2
  .amdhsa_user_sgpr_kernarg_segment_ptr 1
  .amdhsa_system_sgpr_workgroup_id_x 1
  .amdhsa_float_denorm_mode_32 3
.end_amdhsa_kernel
```
